```python
import torch

def _softmax(x, axis=-1):
    return torch.softmax(x, dim=axis)
def _gelu(x):
    return torch.nn.functional.gelu(x, approximate="tanh")
def _silu(x):
    return torch.nn.functional.silu(x)
def _sigmoid(x):
    return torch.sigmoid(x)
def _layernorm(x, axis=-1, eps=1e-5):
    m = x.mean(dim=axis, keepdim=True)
    v = x.var(dim=axis, keepdim=True, unbiased=False)
    return (x - m) / torch.sqrt(v + eps)
def _scatter_add(tgt, idx, src, axis=0):
    return tgt.clone().index_add_(axis, idx, src)
def _segment_sum(src, seg, n):
    out = torch.zeros((n,) + src.shape[1:], dtype=src.dtype)
    return out.index_add_(0, seg, src)
def _pad(x, pw):
    flat = tuple(v for pair in reversed(pw) for v in pair)
    return torch.nn.functional.pad(x, flat)

kernel_name = 'concat_heads__gqa_block_cached__mha_block_cached__near_ridge'

def setup_inputs():

    _w = (lambda a: (lambda t: t.to(torch.bfloat16) if t.is_floating_point() else t)(torch.as_tensor(a)))
    def _A_setup():
        B, Sq, D = 8, 64, 576
        Hq, Hkv, Sk, Dh = 32, 16, 512, 128
        assert Hq % Hkv == 0, (Hq, Hkv)
        return {
            "x": _w((lambda *s: torch.randn(*s, dtype=torch.bfloat16) * 0.8)(B, Sq, D)),
            "k_cache": _w((lambda *s: torch.randn(*s, dtype=torch.bfloat16) * 0.8)(B, Hkv, Sk, Dh)),
            "v_cache": _w((lambda *s: torch.randn(*s, dtype=torch.bfloat16) * 0.05)(B, Hkv, Sk, Dh)),
            "wq": _w((lambda *s: torch.randn(*s, dtype=torch.bfloat16) * 0.8)(D, Hq * Dh) * (D ** -0.5)),
            "wo": _w((lambda *s: torch.randn(*s, dtype=torch.bfloat16) * 0.05)(Hq * Dh, D) * ((Hq * Dh) ** -0.5)),
        }
    _A_in = _A_setup()

    def _B_setup():
        B, Sq, D = 8, 64, 576
        H, Sk, Dh = 32, 512, 128
        return {
            "x": _w((lambda *s: torch.randn(*s, dtype=torch.bfloat16) * 0.8)(B, Sq, D)),
            "k_cache": _w((lambda *s: torch.randn(*s, dtype=torch.bfloat16) * 0.8)(B, H, Sk, Dh)),
            "v_cache": _w((lambda *s: torch.randn(*s, dtype=torch.bfloat16) * 0.05)(B, H, Sk, Dh)),
            "wq": _w((lambda *s: torch.randn(*s, dtype=torch.bfloat16) * 0.8)(D, H * Dh) * (D ** -0.5)),
            "wo": _w((lambda *s: torch.randn(*s, dtype=torch.bfloat16) * 0.05)(H * Dh, D) * ((H * Dh) ** -0.5)),
        }
    _B_in = _B_setup()

    return {
        "A_x": _A_in["x"],
        "A_k_cache": _A_in["k_cache"],
        "A_v_cache": _A_in["v_cache"],
        "A_wq": _A_in["wq"],
        "A_wo": _A_in["wo"],
        "B_x": _B_in["x"],
        "B_k_cache": _B_in["k_cache"],
        "B_v_cache": _B_in["v_cache"],
        "B_wq": _B_in["wq"],
        "B_wo": _B_in["wo"],
    }

def reference(A_x, A_k_cache, A_v_cache, A_wq, A_wo, B_x, B_k_cache, B_v_cache, B_wq, B_wo):
    def _A_ref(x, k_cache, v_cache, wq, wo):
        B, Sq, D = x.shape
        Hq, Dh = 32, 128
        Hkv = k_cache.shape[1]
        rep = Hq // Hkv
        q = (lambda x, *d: x.permute(*d))((x @ wq).reshape(B, Sq, Hq, Dh), 0, 2, 1, 3)
        k = (lambda x, n, axis: torch.repeat_interleave(x, n, dim=axis))(k_cache, rep, axis=1)
        v = (lambda x, n, axis: torch.repeat_interleave(x, n, dim=axis))(v_cache, rep, axis=1)
        scores = torch.einsum("bhqd,bhkd->bhqk", q, k) * (Dh ** -0.5)
        p = _softmax(scores, axis=-1)
        o = torch.einsum("bhqk,bhkd->bhqd", p, v)
        return (lambda x, *d: x.permute(*d))(o, 0, 2, 1, 3).reshape(B, Sq, Hq * Dh) @ wo

    def _B_ref(x, k_cache, v_cache, wq, wo):
        B, Sq, D = x.shape
        H, Dh = 32, 128
        q = (lambda x, *d: x.permute(*d))((x @ wq).reshape(B, Sq, H, Dh), 0, 2, 1, 3)
        scores = torch.einsum("bhqd,bhkd->bhqk", q, k_cache) * (Dh ** -0.5)
        p = _softmax(scores, axis=-1)
        o = torch.einsum("bhqk,bhkd->bhqd", p, v_cache)
        return (lambda x, *d: x.permute(*d))(o, 0, 2, 1, 3).reshape(B, Sq, H * Dh) @ wo

    a = _A_ref(A_x, A_k_cache, A_v_cache, A_wq, A_wo)
    b = _B_ref(B_x, B_k_cache, B_v_cache, B_wq, B_wo)
    return torch.concatenate([a, b], axis=-1)
```

```asm
; @launch grid=(256,1,1) block=(512,1,1) lds=163840
.amdgcn_target "amdgcn-amd-amdhsa--gfx950"
.text
.globl concat_heads__gqa_block_cached__mha_block_cached__near_ridge_kernel
.p2align 8
.type concat_heads__gqa_block_cached__mha_block_cached__near_ridge_kernel,@function
concat_heads__gqa_block_cached__mha_block_cached__near_ridge_kernel:
    s_cmp_ge_u32 s2, 256
    s_cbranch_scc1 L_exit
    s_load_dwordx2 s[84:85], s[0:1], 40
    s_load_dwordx2 s[88:89], s[0:1], 64
    s_load_dwordx16 s[36:51], s[0:1], 0
    s_load_dwordx8 s[52:59], s[0:1], 64
    s_load_dwordx2 s[60:61], s[0:1], 96
    v_lshrrev_b32 v1, 6, v0
    v_and_b32 v0, 63, v0
    v_readfirstlane_b32 s4, v1
    s_getpc_b64 s[78:79]
    s_and_b32 s3, s2, 0xf8
    v_add_u32 v1, s3, v1
    v_and_b32 v2, 1, v0
    v_lshl_or_b32 v1, v1, 1, v2
    v_min_u32 v1, 330, v1
    v_lshlrev_b32 v1, 7, v1
    global_load_dword v13, v1, s[78:79]
    s_bfe_u32 s7, s2, 0x10003
    s_lshr_b32 s68, s2, 5
    s_bfe_u32 s80, s2, 0x10004
    s_and_b32 s67, s2, 7
    s_lshl1_add_u32 s67, s67, s80
    s_mov_b32 s86, 589824
    s_mov_b32 s90, 4718592
    s_mov_b32 s87, 0x20000
    s_mov_b32 s91, 0x20000
    s_mul_i32 s66, s68, 73728
    s_lshl_b32 s33, s67, 9
    v_min_u32 v9, 35, v0
    v_lshrrev_b32 v12, 2, v0
    s_cmp_eq_u32 s7, 0
    s_cbranch_scc0 L_notouch
    v_lshlrev_b32 v9, 7, v9
    s_lshl3_add_u32 s3, s80, s4
    s_mul_i32 s3, s3, 4608
    s_add_u32 s81, s66, s3
    v_min_u32 v68, 8, v12
    v_and_b32 v69, 3, v0
    v_lshlrev_b32 v69, 7, v69
    v_lshl_or_b32 v12, v68, 13, v69
    s_lshl3_add_u32 s3, s68, s4
    s_mul_i32 s3, s3, 73728
    s_add_u32 s82, s33, s3
    s_waitcnt lgkmcnt(0)
    buffer_load_dword v13, v9, s[84:87], s81 offen
    buffer_load_dword v13, v12, s[88:91], s82 offen
L_notouch:
    s_and_b32 s5, s4, 1
    s_lshl_b32 s62, s4, 11
    s_lshl_b32 s69, s4, 10
    v_lshrrev_b32 v64, 4, v0
    v_lshrrev_b32 v66, 3, v0
    v_and_b32 v67, 7, v0
    v_lshrrev_b32 v70, 5, v0
    v_xor_b32 v68, v67, v64
    v_lshlrev_b32 v68, 4, v68
    s_lshl_b32 s3, s5, 6
    v_xor_b32 v68, s3, v68
    v_mul_u32_u24 v69, 1152, v66
    v_add_u32 v8, v69, v68
    v_and_b32 v68, 31, v0
    v_lshlrev_b32 v69, 2, v70
    v_xor_b32 v68, v68, v69
    v_lshlrev_b32 v68, 4, v68
    v_lshl_or_b32 v6, v70, 13, v68
    v_xor_b32 v7, 128, v6
    s_mul_i32 s83, s4, 9216
    s_add_u32 s32, s66, s83
    s_lshl_b32 s3, s4, 15
    s_add_u32 s33, s33, s3
    s_cmp_eq_u32 s7, 0
    s_cselect_b32 s80, s68, 0
    s_lshl_b32 s3, s80, 19
    s_add_u32 s33, s33, s3
    s_lshl_b32 s3, s80, 7
    s_add_u32 s32, s32, s3
    s_sub_u32 s76, s33, 4718592
    s_sub_u32 s77, s32, 1152
    s_waitcnt lgkmcnt(0)
    s_cmp_eq_u32 s7, 0
    s_cbranch_scc1 L_nofirst
    s_add_u32 m0, s69, 147456
    s_add_u32 s65, s33, 16384
    buffer_load_dwordx4 v8, s[84:87], s32 offen lds
    s_add_u32 m0, s62, 98304
    s_nop 0
    buffer_load_dwordx4 v6, s[88:91], s33 offen lds
    s_add_u32 m0, s62, 99328
    s_nop 0
    buffer_load_dwordx4 v7, s[88:91], s65 offen lds
L_nofirst:
    s_cmp_eq_u32 s7, 0
    s_cselect_b64 s[8:9], s[36:37], s[46:47]
    s_cselect_b64 s[20:21], s[42:43], s[52:53]
    s_cselect_b64 s[12:13], s[38:39], s[48:49]
    s_cselect_b64 s[16:17], s[40:41], s[50:51]
    s_cselect_b64 s[24:25], s[44:45], s[54:55]
    s_mov_b32 s10, 589824
    s_mov_b32 s22, 4718592
    s_lshl_b32 s14, 0x1000000, s7
    s_mov_b32 s11, 0x20000
    s_mov_b32 s15, 0x20000
    s_mov_b32 s19, 0x20000
    s_mov_b32 s23, 0x20000
    s_mov_b32 s27, 0x20000
    s_mov_b32 s31, 0x20000
    v_and_b32 v65, 15, v0
    v_lshlrev_b32 v68, 1, v64
    v_xor_b32 v68, v68, v65
    v_lshlrev_b32 v68, 4, v68
    v_lshl_or_b32 v4, v64, 8, v68
    v_xor_b32 v5, 128, v4
    s_lshl4_add_u32 s75, s68, s67
    s_add_u32 s65, s7, 17
    s_lshl_b32 s34, s75, s65
    s_add_u32 s34, s34, s62
    s_cmp_eq_u32 s7, 0
    s_cbranch_scc1 L_branchA
    s_barrier
    s_add_u32 m0, s62, 114688
    s_add_u32 s65, s33, 262144
    buffer_load_dwordx4 v6, s[20:23], s65 offen lds
    s_add_u32 m0, s62, 115712
    s_add_u32 s65, s33, 278528
    buffer_load_dwordx4 v7, s[20:23], s65 offen lds
    s_barrier
    s_add_u32 m0, s69, 155648
    s_add_u32 s65, s32, 128
    buffer_load_dwordx4 v8, s[8:11], s65 offen lds
    s_add_u32 m0, s62, 131072
    s_add_u32 s65, s33, 524288
    buffer_load_dwordx4 v6, s[20:23], s65 offen lds
    s_add_u32 m0, s62, 132096
    s_add_u32 s65, s33, 540672
    buffer_load_dwordx4 v7, s[20:23], s65 offen lds
    s_bfe_u32 s6, s4, 0x10001
    s_lshr_b32 s72, s4, 2
    s_mov_b32 s63, 0x3e0293ee
    s_mov_b32 s18, s14
    s_mov_b32 s26, 4718592
    s_mov_b64 s[28:29], s[60:61]
    s_mov_b32 s30, 0x10000000
    s_mul_i32 s35, s67, 294912
    s_add_u32 s35, s35, s83
    s_lshl_b32 s65, s7, 7
    s_add_u32 s3, s75, s65
    s_mul_i32 s64, s3, 73728
    s_lshl_b32 s65, s72, 9
    s_add_u32 s64, s64, s65
    s_lshl_b32 s65, s5, 8
    s_add_u32 s64, s64, s65
    s_mul_i32 s65, s6, 36864
    s_add_u32 s64, s64, s65
    v_and_b32 v96, 31, v0
    v_lshrrev_b32 v97, 5, v0
    v_bfe_u32 v98, v0, 2, 2
    v_and_b32 v99, 3, v0
    v_bfe_u32 v102, v0, 4, 1
    v_lshlrev_b32 v100, 3, v99
    v_lshl_or_b32 v100, v102, 5, v100
    v_lshl_or_b32 v100, v98, 6, v100
    v_lshl_or_b32 v100, v98, 9, v100
    v_lshl_or_b32 v100, v97, 12, v100
    s_lshl_b32 s3, s72, 8
    s_lshl_b32 s65, s5, 7
    s_add_u32 s3, s3, s65
    v_xor_b32 v100, s3, v100
    v_add_u32 v16, 98304, v100
    v_xor_b32 v17, 64, v16
    v_bfe_u32 v100, v96, 1, 3
    v_xor_b32 v100, v100, v97
    v_lshlrev_b32 v100, 4, v100
    v_lshl_or_b32 v100, v96, 7, v100
    s_lshl_b32 s3, s6, 12
    s_add_u32 s3, s3, 147456
    v_add_u32 v18, s3, v100
    v_xor_b32 v19, 32, v18
    v_xor_b32 v20, 64, v18
    v_xor_b32 v21, 96, v18
    v_and_b32 v100, 7, v0
    v_lshlrev_b32 v100, 1, v100
    v_lshrrev_b32 v101, 4, v0
    v_xor_b32 v100, v100, v101
    v_lshlrev_b32 v100, 4, v100
    v_and_b32 v96, 15, v0
    v_lshl_or_b32 v100, v96, 8, v100
    s_mul_i32 s74, s7, s72
    s_lshl_b32 s74, s74, 14
    v_add_u32 v28, s74, v100
    v_xor_b32 v29, 64, v28
    v_xor_b32 v30, 128, v28
    v_xor_b32 v31, 192, v28
    v_lshlrev_b32 v10, 4, v0
    s_lshl_b32 s3, s4, 12
    s_add_u32 s3, s3, 131072
    v_add_u32 v14, s3, v10
    v_lshlrev_b32 v100, 4, v96
    v_lshl_or_b32 v100, v101, 9, v100
    s_lshr_b32 s3, s4, 1
    s_lshl_b32 s3, s3, 13
    s_lshl_b32 s65, s5, 8
    s_add_u32 s3, s3, s65
    s_add_u32 s3, s3, 131072
    v_add_u32 v15, s3, v100
    s_waitcnt vmcnt(5)
    s_barrier
    ds_read_b128 v[64:67], v18 offset:0
    ds_read_b64_tr_b16 v[68:69], v16 offset:0
    ds_read_b64_tr_b16 v[70:71], v16 offset:2048
    ds_read_b64_tr_b16 v[72:73], v17 offset:0
    ds_read_b64_tr_b16 v[74:75], v17 offset:2048
    ds_read_b128 v[76:79], v19 offset:0
    ds_read_b64_tr_b16 v[80:81], v16 offset:8192
    ds_read_b64_tr_b16 v[82:83], v16 offset:10240
    ds_read_b64_tr_b16 v[84:85], v17 offset:8192
    ds_read_b64_tr_b16 v[86:87], v17 offset:10240
    s_waitcnt lgkmcnt(0)
    s_waitcnt vmcnt(3)
    s_barrier
    v_mfma_f32_32x32x16_bf16 v[224:239], v[68:71], v[64:67], 0
    ds_read_b128 v[96:99], v20 offset:0
    ds_read_b64_tr_b16 v[100:101], v16 offset:16384
    ds_read_b64_tr_b16 v[102:103], v16 offset:18432
    ds_read_b64_tr_b16 v[104:105], v17 offset:16384
    ds_read_b64_tr_b16 v[106:107], v17 offset:18432
    s_add_u32 m0, s62, 98304
    s_add_u32 s65, s33, 786432
    buffer_load_dwordx4 v6, s[20:23], s65 offen lds
    v_mfma_f32_32x32x16_bf16 v[240:255], v[72:75], v[64:67], 0
    ds_read_b128 v[108:111], v21 offset:0
    ds_read_b64_tr_b16 v[112:113], v16 offset:24576
    ds_read_b64_tr_b16 v[114:115], v16 offset:26624
    ds_read_b64_tr_b16 v[116:117], v17 offset:24576
    ds_read_b64_tr_b16 v[118:119], v17 offset:26624
    v_mfma_f32_32x32x16_bf16 v[224:239], v[80:83], v[76:79], v[224:239]
    s_add_u32 m0, s62, 99328
    s_add_u32 s65, s33, 802816
    buffer_load_dwordx4 v7, s[20:23], s65 offen lds
    v_mfma_f32_32x32x16_bf16 v[240:255], v[84:87], v[76:79], v[240:255]
    s_waitcnt lgkmcnt(0)
    s_waitcnt vmcnt(2)
    s_barrier
    v_mfma_f32_32x32x16_bf16 v[224:239], v[100:103], v[96:99], v[224:239]
    ds_read_b128 v[64:67], v18 offset:8192
    ds_read_b64_tr_b16 v[68:69], v16 offset:32768
    ds_read_b64_tr_b16 v[70:71], v16 offset:34816
    ds_read_b64_tr_b16 v[72:73], v17 offset:32768
    ds_read_b64_tr_b16 v[74:75], v17 offset:34816
    s_add_u32 m0, s69, 147456
    s_add_u32 s65, s32, 256
    buffer_load_dwordx4 v8, s[8:11], s65 offen lds
    v_mfma_f32_32x32x16_bf16 v[240:255], v[104:107], v[96:99], v[240:255]
    ds_read_b128 v[76:79], v19 offset:8192
    ds_read_b64_tr_b16 v[80:81], v16 offset:40960
    ds_read_b64_tr_b16 v[82:83], v16 offset:43008
    ds_read_b64_tr_b16 v[84:85], v17 offset:40960
    ds_read_b64_tr_b16 v[86:87], v17 offset:43008
    s_add_u32 m0, s62, 114688
    s_add_u32 s65, s33, 1048576
    buffer_load_dwordx4 v6, s[20:23], s65 offen lds
    v_mfma_f32_32x32x16_bf16 v[224:239], v[112:115], v[108:111], v[224:239]
    s_add_u32 m0, s62, 115712
    s_add_u32 s65, s33, 1064960
    buffer_load_dwordx4 v7, s[20:23], s65 offen lds
    v_mfma_f32_32x32x16_bf16 v[240:255], v[116:119], v[108:111], v[240:255]
    s_waitcnt lgkmcnt(0)
    s_waitcnt vmcnt(3)
    s_barrier
    v_mfma_f32_32x32x16_bf16 v[224:239], v[68:71], v[64:67], v[224:239]
    ds_read_b128 v[96:99], v20 offset:8192
    ds_read_b64_tr_b16 v[100:101], v16 offset:0
    ds_read_b64_tr_b16 v[102:103], v16 offset:2048
    ds_read_b64_tr_b16 v[104:105], v17 offset:0
    ds_read_b64_tr_b16 v[106:107], v17 offset:2048
    s_add_u32 m0, s62, 131072
    s_add_u32 s65, s33, 1310720
    buffer_load_dwordx4 v6, s[20:23], s65 offen lds
    v_mfma_f32_32x32x16_bf16 v[240:255], v[72:75], v[64:67], v[240:255]
    ds_read_b128 v[108:111], v21 offset:8192
    ds_read_b64_tr_b16 v[112:113], v16 offset:8192
    ds_read_b64_tr_b16 v[114:115], v16 offset:10240
    ds_read_b64_tr_b16 v[116:117], v17 offset:8192
    ds_read_b64_tr_b16 v[118:119], v17 offset:10240
    v_mfma_f32_32x32x16_bf16 v[224:239], v[80:83], v[76:79], v[224:239]
    s_add_u32 m0, s62, 132096
    s_add_u32 s65, s33, 1327104
    buffer_load_dwordx4 v7, s[20:23], s65 offen lds
    v_mfma_f32_32x32x16_bf16 v[240:255], v[84:87], v[76:79], v[240:255]
    s_waitcnt lgkmcnt(0)
    s_waitcnt vmcnt(2)
    s_barrier
    v_mfma_f32_32x32x16_bf16 v[224:239], v[100:103], v[96:99], v[224:239]
    ds_read_b128 v[64:67], v18 offset:0
    ds_read_b64_tr_b16 v[68:69], v16 offset:16384
    ds_read_b64_tr_b16 v[70:71], v16 offset:18432
    ds_read_b64_tr_b16 v[72:73], v17 offset:16384
    ds_read_b64_tr_b16 v[74:75], v17 offset:18432
    s_add_u32 m0, s69, 155648
    s_add_u32 s65, s32, 384
    buffer_load_dwordx4 v8, s[8:11], s65 offen lds
    v_mfma_f32_32x32x16_bf16 v[240:255], v[104:107], v[96:99], v[240:255]
    ds_read_b128 v[76:79], v19 offset:0
    ds_read_b64_tr_b16 v[80:81], v16 offset:24576
    ds_read_b64_tr_b16 v[82:83], v16 offset:26624
    ds_read_b64_tr_b16 v[84:85], v17 offset:24576
    ds_read_b64_tr_b16 v[86:87], v17 offset:26624
    s_add_u32 m0, s62, 98304
    s_add_u32 s65, s33, 1572864
    buffer_load_dwordx4 v6, s[20:23], s65 offen lds
    v_mfma_f32_32x32x16_bf16 v[224:239], v[112:115], v[108:111], v[224:239]
    s_add_u32 m0, s62, 99328
    s_add_u32 s65, s33, 1589248
    buffer_load_dwordx4 v7, s[20:23], s65 offen lds
    v_mfma_f32_32x32x16_bf16 v[240:255], v[116:119], v[108:111], v[240:255]
    s_waitcnt lgkmcnt(0)
    s_waitcnt vmcnt(3)
    s_barrier
    v_mfma_f32_32x32x16_bf16 v[224:239], v[68:71], v[64:67], v[224:239]
    ds_read_b128 v[96:99], v20 offset:0
    ds_read_b64_tr_b16 v[100:101], v16 offset:32768
    ds_read_b64_tr_b16 v[102:103], v16 offset:34816
    ds_read_b64_tr_b16 v[104:105], v17 offset:32768
    ds_read_b64_tr_b16 v[106:107], v17 offset:34816
    s_add_u32 m0, s62, 114688
    s_add_u32 s65, s33, 1835008
    buffer_load_dwordx4 v6, s[20:23], s65 offen lds
    v_mfma_f32_32x32x16_bf16 v[240:255], v[72:75], v[64:67], v[240:255]
    ds_read_b128 v[108:111], v21 offset:0
    ds_read_b64_tr_b16 v[112:113], v16 offset:40960
    ds_read_b64_tr_b16 v[114:115], v16 offset:43008
    ds_read_b64_tr_b16 v[116:117], v17 offset:40960
    ds_read_b64_tr_b16 v[118:119], v17 offset:43008
    v_mfma_f32_32x32x16_bf16 v[224:239], v[80:83], v[76:79], v[224:239]
    s_add_u32 m0, s62, 115712
    s_add_u32 s65, s33, 1851392
    buffer_load_dwordx4 v7, s[20:23], s65 offen lds
    v_mfma_f32_32x32x16_bf16 v[240:255], v[84:87], v[76:79], v[240:255]
    s_waitcnt lgkmcnt(0)
    s_waitcnt vmcnt(2)
    s_barrier
    v_mfma_f32_32x32x16_bf16 v[224:239], v[100:103], v[96:99], v[224:239]
    ds_read_b128 v[64:67], v18 offset:8192
    ds_read_b64_tr_b16 v[68:69], v16 offset:0
    ds_read_b64_tr_b16 v[70:71], v16 offset:2048
    ds_read_b64_tr_b16 v[72:73], v17 offset:0
    ds_read_b64_tr_b16 v[74:75], v17 offset:2048
    s_add_u32 m0, s69, 147456
    s_add_u32 s65, s32, 512
    buffer_load_dwordx4 v8, s[8:11], s65 offen lds
    v_mfma_f32_32x32x16_bf16 v[240:255], v[104:107], v[96:99], v[240:255]
    ds_read_b128 v[76:79], v19 offset:8192
    ds_read_b64_tr_b16 v[80:81], v16 offset:8192
    ds_read_b64_tr_b16 v[82:83], v16 offset:10240
    ds_read_b64_tr_b16 v[84:85], v17 offset:8192
    ds_read_b64_tr_b16 v[86:87], v17 offset:10240
    s_add_u32 m0, s62, 131072
    s_add_u32 s65, s33, 2097152
    buffer_load_dwordx4 v6, s[20:23], s65 offen lds
    v_mfma_f32_32x32x16_bf16 v[224:239], v[112:115], v[108:111], v[224:239]
    s_add_u32 m0, s62, 132096
    s_add_u32 s65, s33, 2113536
    buffer_load_dwordx4 v7, s[20:23], s65 offen lds
    v_mfma_f32_32x32x16_bf16 v[240:255], v[116:119], v[108:111], v[240:255]
    s_waitcnt lgkmcnt(0)
    s_waitcnt vmcnt(3)
    s_barrier
    v_mfma_f32_32x32x16_bf16 v[224:239], v[68:71], v[64:67], v[224:239]
    ds_read_b128 v[96:99], v20 offset:8192
    ds_read_b64_tr_b16 v[100:101], v16 offset:16384
    ds_read_b64_tr_b16 v[102:103], v16 offset:18432
    ds_read_b64_tr_b16 v[104:105], v17 offset:16384
    ds_read_b64_tr_b16 v[106:107], v17 offset:18432
    s_add_u32 m0, s62, 98304
    s_add_u32 s65, s33, 2359296
    buffer_load_dwordx4 v6, s[20:23], s65 offen lds
    v_mfma_f32_32x32x16_bf16 v[240:255], v[72:75], v[64:67], v[240:255]
    ds_read_b128 v[108:111], v21 offset:8192
    ds_read_b64_tr_b16 v[112:113], v16 offset:24576
    ds_read_b64_tr_b16 v[114:115], v16 offset:26624
    ds_read_b64_tr_b16 v[116:117], v17 offset:24576
    ds_read_b64_tr_b16 v[118:119], v17 offset:26624
    v_mfma_f32_32x32x16_bf16 v[224:239], v[80:83], v[76:79], v[224:239]
    s_add_u32 m0, s62, 99328
    s_add_u32 s65, s33, 2375680
    buffer_load_dwordx4 v7, s[20:23], s65 offen lds
    v_mfma_f32_32x32x16_bf16 v[240:255], v[84:87], v[76:79], v[240:255]
    s_waitcnt lgkmcnt(0)
    s_waitcnt vmcnt(2)
    s_barrier
    v_mfma_f32_32x32x16_bf16 v[224:239], v[100:103], v[96:99], v[224:239]
    ds_read_b128 v[64:67], v18 offset:0
    ds_read_b64_tr_b16 v[68:69], v16 offset:32768
    ds_read_b64_tr_b16 v[70:71], v16 offset:34816
    ds_read_b64_tr_b16 v[72:73], v17 offset:32768
    ds_read_b64_tr_b16 v[74:75], v17 offset:34816
    s_add_u32 m0, s69, 155648
    s_add_u32 s65, s32, 640
    buffer_load_dwordx4 v8, s[8:11], s65 offen lds
    v_mfma_f32_32x32x16_bf16 v[240:255], v[104:107], v[96:99], v[240:255]
    ds_read_b128 v[76:79], v19 offset:0
    ds_read_b64_tr_b16 v[80:81], v16 offset:40960
    ds_read_b64_tr_b16 v[82:83], v16 offset:43008
    ds_read_b64_tr_b16 v[84:85], v17 offset:40960
    ds_read_b64_tr_b16 v[86:87], v17 offset:43008
    s_add_u32 m0, s62, 114688
    s_add_u32 s65, s33, 2621440
    buffer_load_dwordx4 v6, s[20:23], s65 offen lds
    v_mfma_f32_32x32x16_bf16 v[224:239], v[112:115], v[108:111], v[224:239]
    s_add_u32 m0, s62, 115712
    s_add_u32 s65, s33, 2637824
    buffer_load_dwordx4 v7, s[20:23], s65 offen lds
    v_mfma_f32_32x32x16_bf16 v[240:255], v[116:119], v[108:111], v[240:255]
    s_waitcnt lgkmcnt(0)
    s_waitcnt vmcnt(3)
    s_barrier
    v_mfma_f32_32x32x16_bf16 v[224:239], v[68:71], v[64:67], v[224:239]
    ds_read_b128 v[96:99], v20 offset:0
    ds_read_b64_tr_b16 v[100:101], v16 offset:0
    ds_read_b64_tr_b16 v[102:103], v16 offset:2048
    ds_read_b64_tr_b16 v[104:105], v17 offset:0
    ds_read_b64_tr_b16 v[106:107], v17 offset:2048
    s_add_u32 m0, s62, 131072
    s_add_u32 s65, s33, 2883584
    buffer_load_dwordx4 v6, s[20:23], s65 offen lds
    v_mfma_f32_32x32x16_bf16 v[240:255], v[72:75], v[64:67], v[240:255]
    ds_read_b128 v[108:111], v21 offset:0
    ds_read_b64_tr_b16 v[112:113], v16 offset:8192
    ds_read_b64_tr_b16 v[114:115], v16 offset:10240
    ds_read_b64_tr_b16 v[116:117], v17 offset:8192
    ds_read_b64_tr_b16 v[118:119], v17 offset:10240
    v_mfma_f32_32x32x16_bf16 v[224:239], v[80:83], v[76:79], v[224:239]
    s_add_u32 m0, s62, 132096
    s_add_u32 s65, s33, 2899968
    buffer_load_dwordx4 v7, s[20:23], s65 offen lds
    v_mfma_f32_32x32x16_bf16 v[240:255], v[84:87], v[76:79], v[240:255]
    s_waitcnt lgkmcnt(0)
    s_waitcnt vmcnt(2)
    s_barrier
    v_mfma_f32_32x32x16_bf16 v[224:239], v[100:103], v[96:99], v[224:239]
    ds_read_b128 v[64:67], v18 offset:8192
    ds_read_b64_tr_b16 v[68:69], v16 offset:16384
    ds_read_b64_tr_b16 v[70:71], v16 offset:18432
    ds_read_b64_tr_b16 v[72:73], v17 offset:16384
    ds_read_b64_tr_b16 v[74:75], v17 offset:18432
    s_add_u32 m0, s69, 147456
    s_add_u32 s65, s32, 768
    buffer_load_dwordx4 v8, s[8:11], s65 offen lds
    v_mfma_f32_32x32x16_bf16 v[240:255], v[104:107], v[96:99], v[240:255]
    ds_read_b128 v[76:79], v19 offset:8192
    ds_read_b64_tr_b16 v[80:81], v16 offset:24576
    ds_read_b64_tr_b16 v[82:83], v16 offset:26624
    ds_read_b64_tr_b16 v[84:85], v17 offset:24576
    ds_read_b64_tr_b16 v[86:87], v17 offset:26624
    s_add_u32 m0, s62, 98304
    s_add_u32 s65, s33, 3145728
    buffer_load_dwordx4 v6, s[20:23], s65 offen lds
    v_mfma_f32_32x32x16_bf16 v[224:239], v[112:115], v[108:111], v[224:239]
    s_add_u32 m0, s62, 99328
    s_add_u32 s65, s33, 3162112
    buffer_load_dwordx4 v7, s[20:23], s65 offen lds
    v_mfma_f32_32x32x16_bf16 v[240:255], v[116:119], v[108:111], v[240:255]
    s_waitcnt lgkmcnt(0)
    s_waitcnt vmcnt(3)
    s_barrier
    v_mfma_f32_32x32x16_bf16 v[224:239], v[68:71], v[64:67], v[224:239]
    ds_read_b128 v[96:99], v20 offset:8192
    ds_read_b64_tr_b16 v[100:101], v16 offset:32768
    ds_read_b64_tr_b16 v[102:103], v16 offset:34816
    ds_read_b64_tr_b16 v[104:105], v17 offset:32768
    ds_read_b64_tr_b16 v[106:107], v17 offset:34816
    s_add_u32 m0, s62, 114688
    s_add_u32 s65, s33, 3407872
    buffer_load_dwordx4 v6, s[20:23], s65 offen lds
    v_mfma_f32_32x32x16_bf16 v[240:255], v[72:75], v[64:67], v[240:255]
    ds_read_b128 v[108:111], v21 offset:8192
    ds_read_b64_tr_b16 v[112:113], v16 offset:40960
    ds_read_b64_tr_b16 v[114:115], v16 offset:43008
    ds_read_b64_tr_b16 v[116:117], v17 offset:40960
    ds_read_b64_tr_b16 v[118:119], v17 offset:43008
    v_mfma_f32_32x32x16_bf16 v[224:239], v[80:83], v[76:79], v[224:239]
    s_add_u32 m0, s62, 115712
    s_add_u32 s65, s33, 3424256
    buffer_load_dwordx4 v7, s[20:23], s65 offen lds
    v_mfma_f32_32x32x16_bf16 v[240:255], v[84:87], v[76:79], v[240:255]
    s_waitcnt lgkmcnt(0)
    s_waitcnt vmcnt(2)
    s_barrier
    v_mfma_f32_32x32x16_bf16 v[224:239], v[100:103], v[96:99], v[224:239]
    ds_read_b128 v[64:67], v18 offset:0
    ds_read_b64_tr_b16 v[68:69], v16 offset:0
    ds_read_b64_tr_b16 v[70:71], v16 offset:2048
    ds_read_b64_tr_b16 v[72:73], v17 offset:0
    ds_read_b64_tr_b16 v[74:75], v17 offset:2048
    s_add_u32 m0, s69, 155648
    s_add_u32 s65, s32, 896
    buffer_load_dwordx4 v8, s[8:11], s65 offen lds
    v_mfma_f32_32x32x16_bf16 v[240:255], v[104:107], v[96:99], v[240:255]
    ds_read_b128 v[76:79], v19 offset:0
    ds_read_b64_tr_b16 v[80:81], v16 offset:8192
    ds_read_b64_tr_b16 v[82:83], v16 offset:10240
    ds_read_b64_tr_b16 v[84:85], v17 offset:8192
    ds_read_b64_tr_b16 v[86:87], v17 offset:10240
    s_add_u32 m0, s62, 131072
    s_add_u32 s65, s33, 3670016
    buffer_load_dwordx4 v6, s[20:23], s65 offen lds
    v_mfma_f32_32x32x16_bf16 v[224:239], v[112:115], v[108:111], v[224:239]
    s_add_u32 m0, s62, 132096
    s_add_u32 s65, s33, 3686400
    buffer_load_dwordx4 v7, s[20:23], s65 offen lds
    v_mfma_f32_32x32x16_bf16 v[240:255], v[116:119], v[108:111], v[240:255]
    s_waitcnt lgkmcnt(0)
    s_waitcnt vmcnt(3)
    s_barrier
    v_mfma_f32_32x32x16_bf16 v[224:239], v[68:71], v[64:67], v[224:239]
    ds_read_b128 v[96:99], v20 offset:0
    ds_read_b64_tr_b16 v[100:101], v16 offset:16384
    ds_read_b64_tr_b16 v[102:103], v16 offset:18432
    ds_read_b64_tr_b16 v[104:105], v17 offset:16384
    ds_read_b64_tr_b16 v[106:107], v17 offset:18432
    s_add_u32 m0, s62, 98304
    s_add_u32 s65, s33, 3932160
    buffer_load_dwordx4 v6, s[20:23], s65 offen lds
    v_mfma_f32_32x32x16_bf16 v[240:255], v[72:75], v[64:67], v[240:255]
    ds_read_b128 v[108:111], v21 offset:0
    ds_read_b64_tr_b16 v[112:113], v16 offset:24576
    ds_read_b64_tr_b16 v[114:115], v16 offset:26624
    ds_read_b64_tr_b16 v[116:117], v17 offset:24576
    ds_read_b64_tr_b16 v[118:119], v17 offset:26624
    v_mfma_f32_32x32x16_bf16 v[224:239], v[80:83], v[76:79], v[224:239]
    s_add_u32 m0, s62, 99328
    s_add_u32 s65, s33, 3948544
    buffer_load_dwordx4 v7, s[20:23], s65 offen lds
    v_mfma_f32_32x32x16_bf16 v[240:255], v[84:87], v[76:79], v[240:255]
    s_waitcnt lgkmcnt(0)
    s_waitcnt vmcnt(2)
    s_barrier
    v_mfma_f32_32x32x16_bf16 v[224:239], v[100:103], v[96:99], v[224:239]
    ds_read_b128 v[64:67], v18 offset:8192
    ds_read_b64_tr_b16 v[68:69], v16 offset:32768
    ds_read_b64_tr_b16 v[70:71], v16 offset:34816
    ds_read_b64_tr_b16 v[72:73], v17 offset:32768
    ds_read_b64_tr_b16 v[74:75], v17 offset:34816
    s_add_u32 m0, s69, 147456
    s_add_u32 s65, s32, 1024
    buffer_load_dwordx4 v8, s[8:11], s65 offen lds
    v_mfma_f32_32x32x16_bf16 v[240:255], v[104:107], v[96:99], v[240:255]
    ds_read_b128 v[76:79], v19 offset:8192
    ds_read_b64_tr_b16 v[80:81], v16 offset:40960
    ds_read_b64_tr_b16 v[82:83], v16 offset:43008
    ds_read_b64_tr_b16 v[84:85], v17 offset:40960
    ds_read_b64_tr_b16 v[86:87], v17 offset:43008
    s_add_u32 m0, s62, 114688
    s_add_u32 s65, s33, 4194304
    buffer_load_dwordx4 v6, s[20:23], s65 offen lds
    v_mfma_f32_32x32x16_bf16 v[224:239], v[112:115], v[108:111], v[224:239]
    s_add_u32 m0, s62, 115712
    s_add_u32 s65, s33, 4210688
    buffer_load_dwordx4 v7, s[20:23], s65 offen lds
    v_mfma_f32_32x32x16_bf16 v[240:255], v[116:119], v[108:111], v[240:255]
    s_waitcnt lgkmcnt(0)
    s_waitcnt vmcnt(3)
    s_barrier
    v_mfma_f32_32x32x16_bf16 v[224:239], v[68:71], v[64:67], v[224:239]
    ds_read_b128 v[96:99], v20 offset:8192
    ds_read_b64_tr_b16 v[100:101], v16 offset:0
    ds_read_b64_tr_b16 v[102:103], v16 offset:2048
    ds_read_b64_tr_b16 v[104:105], v17 offset:0
    ds_read_b64_tr_b16 v[106:107], v17 offset:2048
    s_add_u32 m0, s62, 131072
    s_add_u32 s65, s33, 4456448
    buffer_load_dwordx4 v6, s[20:23], s65 offen lds
    v_mfma_f32_32x32x16_bf16 v[240:255], v[72:75], v[64:67], v[240:255]
    ds_read_b128 v[108:111], v21 offset:8192
    ds_read_b64_tr_b16 v[112:113], v16 offset:8192
    ds_read_b64_tr_b16 v[114:115], v16 offset:10240
    ds_read_b64_tr_b16 v[116:117], v17 offset:8192
    ds_read_b64_tr_b16 v[118:119], v17 offset:10240
    v_mfma_f32_32x32x16_bf16 v[224:239], v[80:83], v[76:79], v[224:239]
    s_add_u32 m0, s62, 132096
    s_add_u32 s65, s33, 4472832
    buffer_load_dwordx4 v7, s[20:23], s65 offen lds
    v_mfma_f32_32x32x16_bf16 v[240:255], v[84:87], v[76:79], v[240:255]
    s_waitcnt lgkmcnt(0)
    s_waitcnt vmcnt(2)
    s_barrier
    v_mfma_f32_32x32x16_bf16 v[224:239], v[100:103], v[96:99], v[224:239]
    ds_read_b128 v[64:67], v18 offset:0
    ds_read_b64_tr_b16 v[68:69], v16 offset:16384
    ds_read_b64_tr_b16 v[70:71], v16 offset:18432
    ds_read_b64_tr_b16 v[72:73], v17 offset:16384
    ds_read_b64_tr_b16 v[74:75], v17 offset:18432
    s_add_u32 m0, s62, 0
    s_add_u32 s65, s34, 0
    buffer_load_dwordx4 v4, s[12:15], s65 offen nt lds
    v_mfma_f32_32x32x16_bf16 v[240:255], v[104:107], v[96:99], v[240:255]
    ds_read_b128 v[76:79], v19 offset:0
    ds_read_b64_tr_b16 v[80:81], v16 offset:24576
    ds_read_b64_tr_b16 v[82:83], v16 offset:26624
    ds_read_b64_tr_b16 v[84:85], v17 offset:24576
    ds_read_b64_tr_b16 v[86:87], v17 offset:26624
    buffer_load_dwordx4 v5, s[12:15], s65 offen offset:1024 nt lds
    v_mfma_f32_32x32x16_bf16 v[224:239], v[112:115], v[108:111], v[224:239]
    s_add_u32 m0, s62, 16384
    s_add_u32 s65, s34, 131072
    buffer_load_dwordx4 v4, s[12:15], s65 offen nt lds
    v_mfma_f32_32x32x16_bf16 v[240:255], v[116:119], v[108:111], v[240:255]
    buffer_load_dwordx4 v5, s[12:15], s65 offen offset:1024 nt lds
    s_waitcnt lgkmcnt(0)
    s_waitcnt vmcnt(4)
    s_barrier
    v_mfma_f32_32x32x16_bf16 v[224:239], v[68:71], v[64:67], v[224:239]
    ds_read_b128 v[96:99], v20 offset:0
    ds_read_b64_tr_b16 v[100:101], v16 offset:32768
    ds_read_b64_tr_b16 v[102:103], v16 offset:34816
    ds_read_b64_tr_b16 v[104:105], v17 offset:32768
    ds_read_b64_tr_b16 v[106:107], v17 offset:34816
    s_add_u32 m0, s62, 32768
    s_add_u32 s65, s34, 16384
    buffer_load_dwordx4 v4, s[12:15], s65 offen nt lds
    v_mfma_f32_32x32x16_bf16 v[240:255], v[72:75], v[64:67], v[240:255]
    ds_read_b128 v[108:111], v21 offset:0
    ds_read_b64_tr_b16 v[112:113], v16 offset:40960
    ds_read_b64_tr_b16 v[114:115], v16 offset:43008
    ds_read_b64_tr_b16 v[116:117], v17 offset:40960
    ds_read_b64_tr_b16 v[118:119], v17 offset:43008
    buffer_load_dwordx4 v5, s[12:15], s65 offen offset:1024 nt lds
    v_mfma_f32_32x32x16_bf16 v[224:239], v[80:83], v[76:79], v[224:239]
    s_add_u32 m0, s62, 49152
    s_add_u32 s65, s34, 147456
    buffer_load_dwordx4 v4, s[12:15], s65 offen nt lds
    v_mfma_f32_32x32x16_bf16 v[240:255], v[84:87], v[76:79], v[240:255]
    buffer_load_dwordx4 v5, s[12:15], s65 offen offset:1024 nt lds
    s_waitcnt lgkmcnt(0)
    s_waitcnt vmcnt(4)
    s_barrier
    v_mfma_f32_32x32x16_bf16 v[224:239], v[100:103], v[96:99], v[224:239]
    ds_read_b128 v[64:67], v28 offset:0
    ds_read_b128 v[68:71], v29 offset:0
    ds_read_b128 v[72:75], v30 offset:0
    ds_read_b128 v[76:79], v31 offset:0
    s_add_u32 m0, s62, 65536
    s_add_u32 s65, s34, 32768
    buffer_load_dwordx4 v4, s[12:15], s65 offen nt lds
    v_mfma_f32_32x32x16_bf16 v[240:255], v[104:107], v[96:99], v[240:255]
    ds_read_b128 v[80:83], v28 offset:4096
    ds_read_b128 v[84:87], v29 offset:4096
    ds_read_b128 v[88:91], v30 offset:4096
    ds_read_b128 v[92:95], v31 offset:4096
    buffer_load_dwordx4 v5, s[12:15], s65 offen offset:1024 nt lds
    v_mfma_f32_32x32x16_bf16 v[224:239], v[112:115], v[108:111], v[224:239]
    s_add_u32 m0, s62, 81920
    s_add_u32 s65, s34, 163840
    buffer_load_dwordx4 v4, s[12:15], s65 offen nt lds
    v_mfma_f32_32x32x16_bf16 v[240:255], v[116:119], v[108:111], v[240:255]
    buffer_load_dwordx4 v5, s[12:15], s65 offen offset:1024 nt lds
    ds_read_b128 v[96:99], v28 offset:8192
    ds_read_b128 v[100:103], v29 offset:8192
    ds_read_b128 v[104:107], v30 offset:8192
    ds_read_b128 v[108:111], v31 offset:8192
    ds_read_b128 v[112:115], v28 offset:12288
    ds_read_b128 v[116:119], v29 offset:12288
    ds_read_b128 v[120:123], v30 offset:12288
    s_waitcnt lgkmcnt(12)
    ds_read_b128 v[124:127], v31 offset:12288
    v_cvt_pk_bf16_f32 v32, v224, v225
    v_cvt_pk_bf16_f32 v33, v226, v227
    v_cvt_pk_bf16_f32 v34, v228, v229
    v_cvt_pk_bf16_f32 v35, v230, v231
    v_cvt_pk_bf16_f32 v36, v232, v233
    v_cvt_pk_bf16_f32 v37, v234, v235
    v_cvt_pk_bf16_f32 v38, v236, v237
    v_cvt_pk_bf16_f32 v39, v238, v239
    v_cvt_pk_bf16_f32 v40, v240, v241
    v_cvt_pk_bf16_f32 v41, v242, v243
    v_cvt_pk_bf16_f32 v42, v244, v245
    v_cvt_pk_bf16_f32 v43, v246, v247
    v_cvt_pk_bf16_f32 v44, v248, v249
    v_cvt_pk_bf16_f32 v45, v250, v251
    v_cvt_pk_bf16_f32 v46, v252, v253
    v_cvt_pk_bf16_f32 v47, v254, v255
    v_permlane32_swap_b32 v32, v34
    v_permlane32_swap_b32 v33, v35
    v_permlane32_swap_b32 v36, v38
    v_permlane32_swap_b32 v37, v39
    v_permlane32_swap_b32 v40, v42
    v_permlane32_swap_b32 v41, v43
    v_permlane32_swap_b32 v44, v46
    v_permlane32_swap_b32 v45, v47
    ds_write_b128 v14, v[32:35] offset:0
    ds_write_b128 v14, v[36:39] offset:1024
    s_waitcnt lgkmcnt(12)
    ds_write_b128 v14, v[40:43] offset:2048
    ds_write_b128 v14, v[44:47] offset:3072
    s_waitcnt lgkmcnt(0)
    s_waitcnt vmcnt(4)
    s_barrier
    ds_read_b128 v[32:35], v15 offset:0
    ds_read_b128 v[36:39], v15 offset:2048
    ds_read_b128 v[40:43], v15 offset:4096
    ds_read_b128 v[44:47], v15 offset:6144
    ds_read_b128 v[48:51], v28 offset:32768
    ds_read_b128 v[52:55], v29 offset:32768
    ds_read_b128 v[56:59], v30 offset:32768
    ds_read_b128 v[60:63], v31 offset:32768
    s_waitcnt lgkmcnt(4)
    v_mfma_f32_16x16x32_bf16 v[128:131], v[64:67], v[32:35], 0
    ds_read_b128 v[64:67], v28 offset:36864
    s_add_u32 m0, s62, 0
    s_add_u32 s65, s34, 49152
    buffer_load_dwordx4 v4, s[12:15], s65 offen nt lds
    v_mfma_f32_16x16x32_bf16 v[128:131], v[68:71], v[36:39], v[128:131]
    ds_read_b128 v[68:71], v29 offset:36864
    v_mfma_f32_16x16x32_bf16 v[128:131], v[72:75], v[40:43], v[128:131]
    ds_read_b128 v[72:75], v30 offset:36864
    v_mfma_f32_16x16x32_bf16 v[128:131], v[76:79], v[44:47], v[128:131]
    ds_read_b128 v[76:79], v31 offset:36864
    v_mfma_f32_16x16x32_bf16 v[132:135], v[80:83], v[32:35], 0
    ds_read_b128 v[80:83], v28 offset:40960
    buffer_load_dwordx4 v5, s[12:15], s65 offen offset:1024 nt lds
    v_mfma_f32_16x16x32_bf16 v[132:135], v[84:87], v[36:39], v[132:135]
    ds_read_b128 v[84:87], v29 offset:40960
    v_mfma_f32_16x16x32_bf16 v[132:135], v[88:91], v[40:43], v[132:135]
    ds_read_b128 v[88:91], v30 offset:40960
    v_mfma_f32_16x16x32_bf16 v[132:135], v[92:95], v[44:47], v[132:135]
    ds_read_b128 v[92:95], v31 offset:40960
    v_mfma_f32_16x16x32_bf16 v[136:139], v[96:99], v[32:35], 0
    ds_read_b128 v[96:99], v28 offset:45056
    s_add_u32 m0, s62, 16384
    s_add_u32 s65, s34, 180224
    buffer_load_dwordx4 v4, s[12:15], s65 offen nt lds
    v_mfma_f32_16x16x32_bf16 v[136:139], v[100:103], v[36:39], v[136:139]
    ds_read_b128 v[100:103], v29 offset:45056
    v_mfma_f32_16x16x32_bf16 v[136:139], v[104:107], v[40:43], v[136:139]
    ds_read_b128 v[104:107], v30 offset:45056
    v_mfma_f32_16x16x32_bf16 v[136:139], v[108:111], v[44:47], v[136:139]
    s_waitcnt lgkmcnt(12)
    ds_read_b128 v[108:111], v31 offset:45056
    v_mfma_f32_16x16x32_bf16 v[140:143], v[112:115], v[32:35], 0
    buffer_load_dwordx4 v5, s[12:15], s65 offen offset:1024 nt lds
    v_mfma_f32_16x16x32_bf16 v[140:143], v[116:119], v[36:39], v[140:143]
    v_mfma_f32_16x16x32_bf16 v[140:143], v[120:123], v[40:43], v[140:143]
    v_mfma_f32_16x16x32_bf16 v[140:143], v[124:127], v[44:47], v[140:143]
    s_waitcnt lgkmcnt(0)
    s_waitcnt vmcnt(4)
    s_barrier
    v_add_u32 v28, 0x10000, v28
    v_add_u32 v29, 0x10000, v29
    v_add_u32 v30, 0x10000, v30
    v_add_u32 v31, 0x10000, v31
    ds_read_b128 v[112:115], v28 offset:0
    ds_read_b128 v[116:119], v29 offset:0
    ds_read_b128 v[120:123], v30 offset:0
    ds_read_b128 v[124:127], v31 offset:0
    v_mfma_f32_16x16x32_bf16 v[144:147], v[48:51], v[32:35], 0
    ds_read_b128 v[48:51], v28 offset:4096
    s_add_u32 m0, s62, 32768
    s_add_u32 s65, s34, 65536
    buffer_load_dwordx4 v4, s[12:15], s65 offen nt lds
    v_max_f32 v1, v128, v129
    v_mfma_f32_16x16x32_bf16 v[144:147], v[52:55], v[36:39], v[144:147]
    ds_read_b128 v[52:55], v29 offset:4096
    v_max3_f32 v1, v1, v130, v131
    v_mfma_f32_16x16x32_bf16 v[144:147], v[56:59], v[40:43], v[144:147]
    ds_read_b128 v[56:59], v30 offset:4096
    v_max3_f32 v1, v1, v132, v133
    v_mfma_f32_16x16x32_bf16 v[144:147], v[60:63], v[44:47], v[144:147]
    ds_read_b128 v[60:63], v31 offset:4096
    v_max3_f32 v1, v1, v134, v135
    v_max3_f32 v1, v1, v136, v137
    v_mfma_f32_16x16x32_bf16 v[148:151], v[64:67], v[32:35], 0
    ds_read_b128 v[64:67], v28 offset:8192
    buffer_load_dwordx4 v5, s[12:15], s65 offen offset:1024 nt lds
    v_max3_f32 v1, v1, v138, v139
    v_mfma_f32_16x16x32_bf16 v[148:151], v[68:71], v[36:39], v[148:151]
    ds_read_b128 v[68:71], v29 offset:8192
    v_max3_f32 v1, v1, v140, v141
    v_mfma_f32_16x16x32_bf16 v[148:151], v[72:75], v[40:43], v[148:151]
    ds_read_b128 v[72:75], v30 offset:8192
    v_max3_f32 v1, v1, v142, v143
    v_mfma_f32_16x16x32_bf16 v[148:151], v[76:79], v[44:47], v[148:151]
    ds_read_b128 v[76:79], v31 offset:8192
    v_lshrrev_b32 v12, 4, v0
    v_lshlrev_b32 v2, 2, v12
    v_mfma_f32_16x16x32_bf16 v[152:155], v[80:83], v[32:35], 0
    ds_read_b128 v[80:83], v28 offset:12288
    s_add_u32 m0, s62, 49152
    s_add_u32 s65, s34, 196608
    buffer_load_dwordx4 v4, s[12:15], s65 offen nt lds
    v_xor_b32 v2, v2, v0
    v_mfma_f32_16x16x32_bf16 v[152:155], v[84:87], v[36:39], v[152:155]
    ds_read_b128 v[84:87], v29 offset:12288
    v_and_b32 v2, 15, v2
    v_mfma_f32_16x16x32_bf16 v[152:155], v[88:91], v[40:43], v[152:155]
    ds_read_b128 v[88:91], v30 offset:12288
    v_lshlrev_b32 v2, 4, v2
    v_mfma_f32_16x16x32_bf16 v[152:155], v[92:95], v[44:47], v[152:155]
    s_waitcnt lgkmcnt(12)
    ds_read_b128 v[92:95], v31 offset:12288
    s_lshl_b32 s3, s5, 5
    v_xor_b32 v2, s3, v2
    v_mfma_f32_16x16x32_bf16 v[156:159], v[96:99], v[32:35], 0
    buffer_load_dwordx4 v5, s[12:15], s65 offen offset:1024 nt lds
    v_bfe_u32 v14, v2, 7, 1
    v_mfma_f32_16x16x32_bf16 v[156:159], v[100:103], v[36:39], v[156:159]
    v_mul_u32_u24 v12, 1152, v12
    v_mfma_f32_16x16x32_bf16 v[156:159], v[104:107], v[40:43], v[156:159]
    v_add_u32 v6, v12, v2
    v_mfma_f32_16x16x32_bf16 v[156:159], v[108:111], v[44:47], v[156:159]
    v_xor_b32 v2, 16, v6
    v_add_u32 v7, 3584, v2
    s_waitcnt lgkmcnt(0)
    s_waitcnt vmcnt(4)
    s_barrier
    v_add_u32 v28, 0xffff0000, v28
    v_add_u32 v29, 0xffff0000, v29
    v_add_u32 v30, 0xffff0000, v30
    v_add_u32 v31, 0xffff0000, v31
    ds_read_b128 v[96:99], v28 offset:0
    ds_read_b128 v[100:103], v29 offset:0
    ds_read_b128 v[104:107], v30 offset:0
    ds_read_b128 v[108:111], v31 offset:0
    v_mfma_f32_16x16x32_bf16 v[160:163], v[112:115], v[32:35], 0
    ds_read_b128 v[112:115], v28 offset:4096
    s_add_u32 m0, s62, 65536
    s_add_u32 s65, s34, 81920
    buffer_load_dwordx4 v4, s[12:15], s65 offen nt lds
    v_max3_f32 v1, v1, v144, v145
    v_mfma_f32_16x16x32_bf16 v[160:163], v[116:119], v[36:39], v[160:163]
    ds_read_b128 v[116:119], v29 offset:4096
    v_max3_f32 v1, v1, v146, v147
    v_mfma_f32_16x16x32_bf16 v[160:163], v[120:123], v[40:43], v[160:163]
    ds_read_b128 v[120:123], v30 offset:4096
    v_max3_f32 v1, v1, v148, v149
    v_max3_f32 v1, v1, v150, v151
    v_mfma_f32_16x16x32_bf16 v[160:163], v[124:127], v[44:47], v[160:163]
    ds_read_b128 v[124:127], v31 offset:4096
    v_max3_f32 v1, v1, v152, v153
    v_mfma_f32_16x16x32_bf16 v[164:167], v[48:51], v[32:35], 0
    ds_read_b128 v[48:51], v28 offset:8192
    buffer_load_dwordx4 v5, s[12:15], s65 offen offset:1024 nt lds
    v_max3_f32 v1, v1, v154, v155
    v_mfma_f32_16x16x32_bf16 v[164:167], v[52:55], v[36:39], v[164:167]
    ds_read_b128 v[52:55], v29 offset:8192
    v_max3_f32 v1, v1, v156, v157
    v_max3_f32 v1, v1, v158, v159
    v_mfma_f32_16x16x32_bf16 v[164:167], v[56:59], v[40:43], v[164:167]
    ds_read_b128 v[56:59], v30 offset:8192
    v_and_b32 v2, 3, v0
    v_mfma_f32_16x16x32_bf16 v[164:167], v[60:63], v[44:47], v[164:167]
    ds_read_b128 v[60:63], v31 offset:8192
    v_lshlrev_b32 v2, 3, v2
    v_bfe_u32 v12, v0, 2, 3
    v_mfma_f32_16x16x32_bf16 v[168:171], v[64:67], v[32:35], 0
    ds_read_b128 v[64:67], v28 offset:12288
    s_add_u32 m0, s62, 81920
    s_add_u32 s65, s34, 212992
    buffer_load_dwordx4 v4, s[12:15], s65 offen nt lds
    v_lshl_or_b32 v2, v12, 5, v2
    v_mfma_f32_16x16x32_bf16 v[168:171], v[68:71], v[36:39], v[168:171]
    ds_read_b128 v[68:71], v29 offset:12288
    v_lshrrev_b32 v12, 2, v0
    v_mfma_f32_16x16x32_bf16 v[168:171], v[72:75], v[40:43], v[168:171]
    ds_read_b128 v[72:75], v30 offset:12288
    v_lshl_or_b32 v2, v12, 8, v2
    v_add_u32 v16, s74, v2
    v_mfma_f32_16x16x32_bf16 v[168:171], v[76:79], v[44:47], v[168:171]
    s_waitcnt lgkmcnt(12)
    ds_read_b128 v[76:79], v31 offset:12288
    v_xor_b32 v17, 32, v16
    v_mfma_f32_16x16x32_bf16 v[172:175], v[80:83], v[32:35], 0
    buffer_load_dwordx4 v5, s[12:15], s65 offen offset:1024 nt lds
    v_xor_b32 v18, 64, v16
    v_mfma_f32_16x16x32_bf16 v[172:175], v[84:87], v[36:39], v[172:175]
    v_xor_b32 v19, 96, v16
    v_xor_b32 v20, 128, v16
    v_mfma_f32_16x16x32_bf16 v[172:175], v[88:91], v[40:43], v[172:175]
    v_xor_b32 v21, 160, v16
    v_mfma_f32_16x16x32_bf16 v[172:175], v[92:95], v[44:47], v[172:175]
    v_xor_b32 v22, 192, v16
    v_xor_b32 v23, 224, v16
    s_waitcnt lgkmcnt(0)
    s_waitcnt vmcnt(4)
    s_barrier
    ds_read_b128 v[80:83], v28 offset:32768
    ds_read_b128 v[84:87], v29 offset:32768
    ds_read_b128 v[88:91], v30 offset:32768
    ds_read_b128 v[92:95], v31 offset:32768
    v_mfma_f32_16x16x32_bf16 v[176:179], v[96:99], v[32:35], 0
    ds_read_b128 v[96:99], v28 offset:36864
    s_add_u32 m0, s62, 0
    s_add_u32 s65, s34, 98304
    buffer_load_dwordx4 v4, s[12:15], s65 offen nt lds
    v_max3_f32 v1, v1, v160, v161
    v_max3_f32 v1, v1, v162, v163
    v_mfma_f32_16x16x32_bf16 v[176:179], v[100:103], v[36:39], v[176:179]
    ds_read_b128 v[100:103], v29 offset:36864
    v_max3_f32 v1, v1, v164, v165
    v_max3_f32 v1, v1, v166, v167
    v_mfma_f32_16x16x32_bf16 v[176:179], v[104:107], v[40:43], v[176:179]
    ds_read_b128 v[104:107], v30 offset:36864
    v_max3_f32 v1, v1, v168, v169
    v_max3_f32 v1, v1, v170, v171
    v_mfma_f32_16x16x32_bf16 v[176:179], v[108:111], v[44:47], v[176:179]
    ds_read_b128 v[108:111], v31 offset:36864
    v_max3_f32 v1, v1, v172, v173
    v_max3_f32 v1, v1, v174, v175
    v_and_b32 v2, 3, v0
    v_mfma_f32_16x16x32_bf16 v[180:183], v[112:115], v[32:35], 0
    ds_read_b128 v[112:115], v28 offset:40960
    buffer_load_dwordx4 v5, s[12:15], s65 offen offset:1024 nt lds
    v_lshlrev_b32 v2, 3, v2
    v_bfe_u32 v12, v0, 4, 1
    v_mfma_f32_16x16x32_bf16 v[180:183], v[116:119], v[36:39], v[180:183]
    ds_read_b128 v[116:119], v29 offset:40960
    v_lshl_or_b32 v2, v12, 5, v2
    v_bfe_u32 v12, v0, 2, 2
    v_mfma_f32_16x16x32_bf16 v[180:183], v[120:123], v[40:43], v[180:183]
    ds_read_b128 v[120:123], v30 offset:40960
    v_lshl_or_b32 v2, v12, 6, v2
    v_lshl_or_b32 v2, v12, 8, v2
    v_lshrrev_b32 v12, 5, v0
    v_mfma_f32_16x16x32_bf16 v[180:183], v[124:127], v[44:47], v[180:183]
    ds_read_b128 v[124:127], v31 offset:40960
    v_lshl_or_b32 v2, v12, 10, v2
    v_lshlrev_b32 v12, 4, v12
    v_mfma_f32_16x16x32_bf16 v[184:187], v[48:51], v[32:35], 0
    ds_read_b128 v[48:51], v28 offset:45056
    s_add_u32 m0, s62, 16384
    s_add_u32 s65, s34, 229376
    buffer_load_dwordx4 v4, s[12:15], s65 offen nt lds
    v_xor_b32 v2, v2, v12
    s_lshl_b32 s3, s72, 7
    v_mfma_f32_16x16x32_bf16 v[184:187], v[52:55], v[36:39], v[184:187]
    ds_read_b128 v[52:55], v29 offset:45056
    s_lshl_b32 s75, s5, 6
    s_add_u32 s3, s3, s75
    v_xor_b32 v24, s3, v2
    v_mfma_f32_16x16x32_bf16 v[184:187], v[56:59], v[40:43], v[184:187]
    ds_read_b128 v[56:59], v30 offset:45056
    v_xor_b32 v25, 2080, v24
    v_and_b32 v2, 15, v0
    v_mfma_f32_16x16x32_bf16 v[184:187], v[60:63], v[44:47], v[184:187]
    s_waitcnt lgkmcnt(12)
    ds_read_b128 v[60:63], v31 offset:45056
    v_lshlrev_b32 v2, 4, v2
    v_lshl_or_b32 v2, v12, 4, v2
    v_mfma_f32_16x16x32_bf16 v[188:191], v[64:67], v[32:35], 0
    buffer_load_dwordx4 v5, s[12:15], s65 offen offset:1024 nt lds
    v_bfe_u32 v12, v0, 4, 1
    v_lshl_or_b32 v2, v12, 10, v2
    s_lshl_b32 s3, s6, 11
    v_mfma_f32_16x16x32_bf16 v[188:191], v[68:71], v[36:39], v[188:191]
    s_add_u32 s3, s3, 65536
    v_add_u32 v26, s3, v2
    v_mfma_f32_16x16x32_bf16 v[188:191], v[72:75], v[40:43], v[188:191]
    s_lshl_b32 s3, s72, 14
    s_and_b32 s75, s69, 3072
    v_mfma_f32_16x16x32_bf16 v[188:191], v[76:79], v[44:47], v[188:191]
    s_add_u32 s3, s3, s75
    s_add_u32 s3, s3, 65536
    v_add_u32 v27, s3, v10
    s_waitcnt lgkmcnt(0)
    s_waitcnt vmcnt(4)
    s_barrier
    v_add_u32 v28, 0x10000, v28
    v_add_u32 v29, 0x10000, v29
    v_add_u32 v30, 0x10000, v30
    v_add_u32 v31, 0x10000, v31
    ds_read_b128 v[64:67], v28 offset:0
    ds_read_b128 v[68:71], v29 offset:0
    ds_read_b128 v[72:75], v30 offset:0
    ds_read_b128 v[76:79], v31 offset:0
    v_mfma_f32_16x16x32_bf16 v[192:195], v[80:83], v[32:35], 0
    ds_read_b128 v[80:83], v28 offset:4096
    s_add_u32 m0, s62, 32768
    s_add_u32 s65, s34, 114688
    buffer_load_dwordx4 v4, s[12:15], s65 offen nt lds
    v_mfma_f32_16x16x32_bf16 v[192:195], v[84:87], v[36:39], v[192:195]
    ds_read_b128 v[84:87], v29 offset:4096
    v_max3_f32 v1, v1, v176, v177
    v_mfma_f32_16x16x32_bf16 v[192:195], v[88:91], v[40:43], v[192:195]
    ds_read_b128 v[88:91], v30 offset:4096
    v_mfma_f32_16x16x32_bf16 v[192:195], v[92:95], v[44:47], v[192:195]
    ds_read_b128 v[92:95], v31 offset:4096
    v_max3_f32 v1, v1, v178, v179
    v_mfma_f32_16x16x32_bf16 v[196:199], v[96:99], v[32:35], 0
    ds_read_b128 v[96:99], v28 offset:8192
    buffer_load_dwordx4 v5, s[12:15], s65 offen offset:1024 nt lds
    v_mfma_f32_16x16x32_bf16 v[196:199], v[100:103], v[36:39], v[196:199]
    ds_read_b128 v[100:103], v29 offset:8192
    v_max3_f32 v1, v1, v180, v181
    v_mfma_f32_16x16x32_bf16 v[196:199], v[104:107], v[40:43], v[196:199]
    ds_read_b128 v[104:107], v30 offset:8192
    v_mfma_f32_16x16x32_bf16 v[196:199], v[108:111], v[44:47], v[196:199]
    ds_read_b128 v[108:111], v31 offset:8192
    v_max3_f32 v1, v1, v182, v183
    v_mfma_f32_16x16x32_bf16 v[200:203], v[112:115], v[32:35], 0
    ds_read_b128 v[112:115], v28 offset:12288
    s_add_u32 m0, s62, 49152
    s_add_u32 s65, s34, 245760
    buffer_load_dwordx4 v4, s[12:15], s65 offen nt lds
    v_mfma_f32_16x16x32_bf16 v[200:203], v[116:119], v[36:39], v[200:203]
    ds_read_b128 v[116:119], v29 offset:12288
    v_max3_f32 v1, v1, v184, v185
    v_mfma_f32_16x16x32_bf16 v[200:203], v[120:123], v[40:43], v[200:203]
    ds_read_b128 v[120:123], v30 offset:12288
    v_mfma_f32_16x16x32_bf16 v[200:203], v[124:127], v[44:47], v[200:203]
    s_waitcnt lgkmcnt(12)
    ds_read_b128 v[124:127], v31 offset:12288
    v_max3_f32 v1, v1, v186, v187
    v_mfma_f32_16x16x32_bf16 v[204:207], v[48:51], v[32:35], 0
    buffer_load_dwordx4 v5, s[12:15], s65 offen offset:1024 nt lds
    v_mfma_f32_16x16x32_bf16 v[204:207], v[52:55], v[36:39], v[204:207]
    v_max3_f32 v1, v1, v188, v189
    v_mfma_f32_16x16x32_bf16 v[204:207], v[56:59], v[40:43], v[204:207]
    v_mfma_f32_16x16x32_bf16 v[204:207], v[60:63], v[44:47], v[204:207]
    v_max3_f32 v1, v1, v190, v191
    s_waitcnt lgkmcnt(0)
    s_waitcnt vmcnt(4)
    s_barrier
    v_add_u32 v28, 0xffff0000, v28
    v_add_u32 v29, 0xffff0000, v29
    v_add_u32 v30, 0xffff0000, v30
    v_add_u32 v31, 0xffff0000, v31
    ds_read_b128 v[48:51], v28 offset:0
    ds_read_b128 v[52:55], v29 offset:0
    ds_read_b128 v[56:59], v30 offset:0
    ds_read_b128 v[60:63], v31 offset:0
    v_mfma_f32_16x16x32_bf16 v[208:211], v[64:67], v[32:35], 0
    ds_read_b128 v[64:67], v28 offset:4096
    s_add_u32 m0, s62, 65536
    s_add_u32 s65, s34, 0
    buffer_load_dwordx4 v4, s[16:19], s65 offen nt lds
    v_mfma_f32_16x16x32_bf16 v[208:211], v[68:71], v[36:39], v[208:211]
    ds_read_b128 v[68:71], v29 offset:4096
    v_max3_f32 v1, v1, v192, v193
    v_mfma_f32_16x16x32_bf16 v[208:211], v[72:75], v[40:43], v[208:211]
    ds_read_b128 v[72:75], v30 offset:4096
    v_mfma_f32_16x16x32_bf16 v[208:211], v[76:79], v[44:47], v[208:211]
    ds_read_b128 v[76:79], v31 offset:4096
    v_max3_f32 v1, v1, v194, v195
    v_mfma_f32_16x16x32_bf16 v[212:215], v[80:83], v[32:35], 0
    ds_read_b128 v[80:83], v28 offset:8192
    buffer_load_dwordx4 v5, s[16:19], s65 offen offset:1024 nt lds
    v_mfma_f32_16x16x32_bf16 v[212:215], v[84:87], v[36:39], v[212:215]
    ds_read_b128 v[84:87], v29 offset:8192
    v_max3_f32 v1, v1, v196, v197
    v_mfma_f32_16x16x32_bf16 v[212:215], v[88:91], v[40:43], v[212:215]
    ds_read_b128 v[88:91], v30 offset:8192
    v_mfma_f32_16x16x32_bf16 v[212:215], v[92:95], v[44:47], v[212:215]
    ds_read_b128 v[92:95], v31 offset:8192
    v_max3_f32 v1, v1, v198, v199
    v_mfma_f32_16x16x32_bf16 v[216:219], v[96:99], v[32:35], 0
    ds_read_b128 v[96:99], v28 offset:12288
    s_add_u32 m0, s62, 81920
    s_add_u32 s65, s34, 131072
    buffer_load_dwordx4 v4, s[16:19], s65 offen nt lds
    v_mfma_f32_16x16x32_bf16 v[216:219], v[100:103], v[36:39], v[216:219]
    ds_read_b128 v[100:103], v29 offset:12288
    v_max3_f32 v1, v1, v200, v201
    v_mfma_f32_16x16x32_bf16 v[216:219], v[104:107], v[40:43], v[216:219]
    ds_read_b128 v[104:107], v30 offset:12288
    v_mfma_f32_16x16x32_bf16 v[216:219], v[108:111], v[44:47], v[216:219]
    s_waitcnt lgkmcnt(12)
    ds_read_b128 v[108:111], v31 offset:12288
    v_max3_f32 v1, v1, v202, v203
    v_mfma_f32_16x16x32_bf16 v[220:223], v[112:115], v[32:35], 0
    buffer_load_dwordx4 v5, s[16:19], s65 offen offset:1024 nt lds
    v_mfma_f32_16x16x32_bf16 v[220:223], v[116:119], v[36:39], v[220:223]
    v_max3_f32 v1, v1, v204, v205
    v_mfma_f32_16x16x32_bf16 v[220:223], v[120:123], v[40:43], v[220:223]
    v_mfma_f32_16x16x32_bf16 v[220:223], v[124:127], v[44:47], v[220:223]
    v_max3_f32 v1, v1, v206, v207
    s_waitcnt lgkmcnt(0)
    s_waitcnt vmcnt(4)
    s_barrier
    ds_read_b128 v[112:115], v28 offset:32768
    ds_read_b128 v[116:119], v29 offset:32768
    ds_read_b128 v[120:123], v30 offset:32768
    ds_read_b128 v[124:127], v31 offset:32768
    v_mfma_f32_16x16x32_bf16 v[224:227], v[48:51], v[32:35], 0
    ds_read_b128 v[48:51], v28 offset:36864
    s_add_u32 m0, s62, 0
    s_add_u32 s65, s34, 16384
    buffer_load_dwordx4 v4, s[16:19], s65 offen nt lds
    v_mfma_f32_16x16x32_bf16 v[224:227], v[52:55], v[36:39], v[224:227]
    ds_read_b128 v[52:55], v29 offset:36864
    v_max3_f32 v1, v1, v208, v209
    v_mfma_f32_16x16x32_bf16 v[224:227], v[56:59], v[40:43], v[224:227]
    ds_read_b128 v[56:59], v30 offset:36864
    v_mfma_f32_16x16x32_bf16 v[224:227], v[60:63], v[44:47], v[224:227]
    ds_read_b128 v[60:63], v31 offset:36864
    v_max3_f32 v1, v1, v210, v211
    v_mfma_f32_16x16x32_bf16 v[228:231], v[64:67], v[32:35], 0
    ds_read_b128 v[64:67], v28 offset:40960
    buffer_load_dwordx4 v5, s[16:19], s65 offen offset:1024 nt lds
    v_mfma_f32_16x16x32_bf16 v[228:231], v[68:71], v[36:39], v[228:231]
    ds_read_b128 v[68:71], v29 offset:40960
    v_max3_f32 v1, v1, v212, v213
    v_mfma_f32_16x16x32_bf16 v[228:231], v[72:75], v[40:43], v[228:231]
    ds_read_b128 v[72:75], v30 offset:40960
    v_mfma_f32_16x16x32_bf16 v[228:231], v[76:79], v[44:47], v[228:231]
    ds_read_b128 v[76:79], v31 offset:40960
    v_max3_f32 v1, v1, v214, v215
    v_mfma_f32_16x16x32_bf16 v[232:235], v[80:83], v[32:35], 0
    ds_read_b128 v[80:83], v28 offset:45056
    s_add_u32 m0, s62, 16384
    s_add_u32 s65, s34, 147456
    buffer_load_dwordx4 v4, s[16:19], s65 offen nt lds
    v_mfma_f32_16x16x32_bf16 v[232:235], v[84:87], v[36:39], v[232:235]
    ds_read_b128 v[84:87], v29 offset:45056
    v_max3_f32 v1, v1, v216, v217
    v_mfma_f32_16x16x32_bf16 v[232:235], v[88:91], v[40:43], v[232:235]
    ds_read_b128 v[88:91], v30 offset:45056
    v_mfma_f32_16x16x32_bf16 v[232:235], v[92:95], v[44:47], v[232:235]
    s_waitcnt lgkmcnt(12)
    ds_read_b128 v[92:95], v31 offset:45056
    v_max3_f32 v1, v1, v218, v219
    v_mfma_f32_16x16x32_bf16 v[236:239], v[96:99], v[32:35], 0
    buffer_load_dwordx4 v5, s[16:19], s65 offen offset:1024 nt lds
    v_mfma_f32_16x16x32_bf16 v[236:239], v[100:103], v[36:39], v[236:239]
    v_max3_f32 v1, v1, v220, v221
    v_mfma_f32_16x16x32_bf16 v[236:239], v[104:107], v[40:43], v[236:239]
    v_mfma_f32_16x16x32_bf16 v[236:239], v[108:111], v[44:47], v[236:239]
    v_max3_f32 v1, v1, v222, v223
    s_waitcnt lgkmcnt(0)
    v_mfma_f32_16x16x32_bf16 v[240:243], v[112:115], v[32:35], 0
    v_max3_f32 v1, v1, v224, v225
    v_mfma_f32_16x16x32_bf16 v[240:243], v[116:119], v[36:39], v[240:243]
    v_max3_f32 v1, v1, v226, v227
    v_mfma_f32_16x16x32_bf16 v[240:243], v[120:123], v[40:43], v[240:243]
    v_max3_f32 v1, v1, v228, v229
    v_mfma_f32_16x16x32_bf16 v[240:243], v[124:127], v[44:47], v[240:243]
    v_max3_f32 v1, v1, v230, v231
    v_mfma_f32_16x16x32_bf16 v[244:247], v[48:51], v[32:35], 0
    v_max3_f32 v1, v1, v232, v233
    v_mfma_f32_16x16x32_bf16 v[244:247], v[52:55], v[36:39], v[244:247]
    v_max3_f32 v1, v1, v234, v235
    v_mfma_f32_16x16x32_bf16 v[244:247], v[56:59], v[40:43], v[244:247]
    v_max3_f32 v1, v1, v236, v237
    v_mfma_f32_16x16x32_bf16 v[244:247], v[60:63], v[44:47], v[244:247]
    v_max3_f32 v1, v1, v238, v239
    v_mfma_f32_16x16x32_bf16 v[248:251], v[64:67], v[32:35], 0
    v_mfma_f32_16x16x32_bf16 v[248:251], v[68:71], v[36:39], v[248:251]
    v_mfma_f32_16x16x32_bf16 v[248:251], v[72:75], v[40:43], v[248:251]
    v_mfma_f32_16x16x32_bf16 v[248:251], v[76:79], v[44:47], v[248:251]
    v_mfma_f32_16x16x32_bf16 v[252:255], v[80:83], v[32:35], 0
    v_mfma_f32_16x16x32_bf16 v[252:255], v[84:87], v[36:39], v[252:255]
    v_mfma_f32_16x16x32_bf16 v[252:255], v[88:91], v[40:43], v[252:255]
    v_mfma_f32_16x16x32_bf16 v[252:255], v[92:95], v[44:47], v[252:255]
    v_max3_f32 v1, v1, v240, v241
    v_max3_f32 v1, v1, v242, v243
    v_max3_f32 v1, v1, v244, v245
    v_max3_f32 v1, v1, v246, v247
    v_max3_f32 v1, v1, v248, v249
    v_max3_f32 v1, v1, v250, v251
    s_nop 1
    v_max3_f32 v1, v1, v252, v253
    v_max3_f32 v1, v1, v254, v255
    v_mov_b32 v2, v1
    s_nop 1
    v_permlane16_swap_b32 v1, v2
    v_max_f32 v1, v1, v2
    v_mov_b32 v2, v1
    s_nop 1
    v_permlane32_swap_b32 v1, v2
    v_max_f32 v1, v1, v2
    v_mul_f32 v2, s63, v1
    v_fma_f32 v128, v128, s63, -v2
    v_fma_f32 v129, v129, s63, -v2
    v_fma_f32 v130, v130, s63, -v2
    v_fma_f32 v131, v131, s63, -v2
    v_exp_f32 v128, v128
    v_exp_f32 v129, v129
    v_exp_f32 v130, v130
    v_exp_f32 v131, v131
    v_fma_f32 v132, v132, s63, -v2
    v_fma_f32 v133, v133, s63, -v2
    v_fma_f32 v134, v134, s63, -v2
    v_fma_f32 v135, v135, s63, -v2
    v_exp_f32 v132, v132
    v_exp_f32 v133, v133
    v_exp_f32 v134, v134
    v_exp_f32 v135, v135
    v_cvt_pk_bf16_f32 v128, v128, v129
    v_cvt_pk_bf16_f32 v129, v130, v131
    v_fma_f32 v136, v136, s63, -v2
    v_fma_f32 v137, v137, s63, -v2
    v_fma_f32 v138, v138, s63, -v2
    v_fma_f32 v139, v139, s63, -v2
    v_exp_f32 v136, v136
    v_exp_f32 v137, v137
    v_exp_f32 v138, v138
    v_exp_f32 v139, v139
    v_cvt_pk_bf16_f32 v130, v132, v133
    v_cvt_pk_bf16_f32 v131, v134, v135
    v_fma_f32 v140, v140, s63, -v2
    v_fma_f32 v141, v141, s63, -v2
    v_fma_f32 v142, v142, s63, -v2
    v_fma_f32 v143, v143, s63, -v2
    v_exp_f32 v140, v140
    v_exp_f32 v141, v141
    v_exp_f32 v142, v142
    v_exp_f32 v143, v143
    v_cvt_pk_bf16_f32 v132, v136, v137
    v_cvt_pk_bf16_f32 v133, v138, v139
    v_cvt_pk_bf16_f32 v134, v140, v141
    v_cvt_pk_bf16_f32 v135, v142, v143
    v_mov_b32 v140, 0x3f803f80
    v_mov_b32 v141, 0x3f803f80
    v_mov_b32 v142, 0x3f803f80
    v_mov_b32 v143, 0x3f803f80
    v_add_u32 v16, 0x10000, v16
    v_add_u32 v17, 0x10000, v17
    v_add_u32 v18, 0x10000, v18
    v_add_u32 v19, 0x10000, v19
    v_add_u32 v20, 0x10000, v20
    v_add_u32 v21, 0x10000, v21
    v_add_u32 v22, 0x10000, v22
    v_add_u32 v23, 0x10000, v23
    s_waitcnt vmcnt(4)
    s_barrier
    ds_read_b64_tr_b16 v[64:65], v16 offset:0
    ds_read_b64_tr_b16 v[66:67], v16 offset:4096
    ds_read_b64_tr_b16 v[68:69], v17 offset:0
    ds_read_b64_tr_b16 v[70:71], v17 offset:4096
    ds_read_b64_tr_b16 v[72:73], v18 offset:0
    ds_read_b64_tr_b16 v[74:75], v18 offset:4096
    ds_read_b64_tr_b16 v[76:77], v19 offset:0
    ds_read_b64_tr_b16 v[78:79], v19 offset:4096
    ds_read_b64_tr_b16 v[80:81], v20 offset:0
    ds_read_b64_tr_b16 v[82:83], v20 offset:4096
    ds_read_b64_tr_b16 v[84:85], v21 offset:0
    ds_read_b64_tr_b16 v[86:87], v21 offset:4096
    ds_read_b64_tr_b16 v[88:89], v22 offset:0
    ds_read_b64_tr_b16 v[90:91], v22 offset:4096
    v_fma_f32 v144, v144, s63, -v2
    v_fma_f32 v145, v145, s63, -v2
    v_fma_f32 v146, v146, s63, -v2
    v_fma_f32 v147, v147, s63, -v2
    v_mfma_f32_16x16x32_bf16 v[136:139], v[140:143], v[128:131], 0
    s_mov_b64 s[84:85], s[58:59]
    s_mov_b32 s86, 256
    s_mov_b32 s87, 0x20000
    s_lshl_b32 s70, s7, 3
    s_add_u32 s70, s70, s68
    s_lshl_b32 s73, s70, 12
    s_add_u32 s73, s73, 0x1400000
    s_lshl_b32 s71, s67, 8
    s_add_u32 s71, s71, s73
    s_lshl_b32 s82, s70, 4
    v_min_u32 v29, 1, v0
    v_lshlrev_b32 v29, 30, v29
    v_mov_b32 v28, 0
    buffer_atomic_add v28, v29, s[28:31], s71 offen sc0 sc1
    v_exp_f32 v144, v144
    v_exp_f32 v145, v145
    v_mfma_f32_16x16x32_bf16 v[136:139], v[140:143], v[132:135], v[136:139]
    v_exp_f32 v146, v146
    v_exp_f32 v147, v147
    s_waitcnt lgkmcnt(10)
    v_mfma_f32_16x16x32_bf16 v[32:35], v[64:67], v[128:131], 0
    ds_read_b64_tr_b16 v[92:93], v23 offset:0
    ds_read_b64_tr_b16 v[94:95], v23 offset:4096
    ds_read_b64_tr_b16 v[96:97], v16 offset:8192
    ds_read_b64_tr_b16 v[98:99], v16 offset:12288
    s_add_u32 m0, s62, 32768
    s_add_u32 s65, s34, 32768
    buffer_load_dwordx4 v4, s[16:19], s65 offen nt lds
    v_fma_f32 v148, v148, s63, -v2
    v_fma_f32 v149, v149, s63, -v2
    v_mfma_f32_16x16x32_bf16 v[36:39], v[68:71], v[128:131], 0
    v_fma_f32 v150, v150, s63, -v2
    v_fma_f32 v151, v151, s63, -v2
    s_waitcnt lgkmcnt(10)
    v_mfma_f32_16x16x32_bf16 v[40:43], v[72:75], v[128:131], 0
    ds_read_b64_tr_b16 v[100:101], v17 offset:8192
    ds_read_b64_tr_b16 v[102:103], v17 offset:12288
    ds_read_b64_tr_b16 v[104:105], v18 offset:8192
    ds_read_b64_tr_b16 v[106:107], v18 offset:12288
    buffer_load_dwordx4 v5, s[16:19], s65 offen offset:1024 nt lds
    v_exp_f32 v148, v148
    v_exp_f32 v149, v149
    v_mfma_f32_16x16x32_bf16 v[44:47], v[76:79], v[128:131], 0
    v_exp_f32 v150, v150
    v_exp_f32 v151, v151
    s_waitcnt lgkmcnt(10)
    v_mfma_f32_16x16x32_bf16 v[48:51], v[80:83], v[128:131], 0
    ds_read_b64_tr_b16 v[108:109], v19 offset:8192
    ds_read_b64_tr_b16 v[110:111], v19 offset:12288
    ds_read_b64_tr_b16 v[112:113], v20 offset:8192
    ds_read_b64_tr_b16 v[114:115], v20 offset:12288
    v_cvt_pk_bf16_f32 v144, v144, v145
    v_cvt_pk_bf16_f32 v145, v146, v147
    v_mfma_f32_16x16x32_bf16 v[52:55], v[84:87], v[128:131], 0
    s_add_u32 m0, s62, 49152
    s_add_u32 s65, s34, 163840
    buffer_load_dwordx4 v4, s[16:19], s65 offen nt lds
    v_fma_f32 v152, v152, s63, -v2
    v_fma_f32 v153, v153, s63, -v2
    s_waitcnt lgkmcnt(10)
    v_mfma_f32_16x16x32_bf16 v[56:59], v[88:91], v[128:131], 0
    ds_read_b64_tr_b16 v[116:117], v21 offset:8192
    ds_read_b64_tr_b16 v[118:119], v21 offset:12288
    ds_read_b64_tr_b16 v[120:121], v22 offset:8192
    ds_read_b64_tr_b16 v[122:123], v22 offset:12288
    v_fma_f32 v154, v154, s63, -v2
    v_fma_f32 v155, v155, s63, -v2
    v_mfma_f32_16x16x32_bf16 v[60:63], v[92:95], v[128:131], 0
    buffer_load_dwordx4 v5, s[16:19], s65 offen offset:1024 nt lds
    v_exp_f32 v152, v152
    v_exp_f32 v153, v153
    s_waitcnt lgkmcnt(10)
    v_mfma_f32_16x16x32_bf16 v[32:35], v[96:99], v[132:135], v[32:35]
    ds_read_b64_tr_b16 v[124:125], v23 offset:8192
    ds_read_b64_tr_b16 v[126:127], v23 offset:12288
    v_exp_f32 v154, v154
    v_exp_f32 v155, v155
    v_mfma_f32_16x16x32_bf16 v[36:39], v[100:103], v[132:135], v[36:39]
    v_cvt_pk_bf16_f32 v146, v148, v149
    v_cvt_pk_bf16_f32 v147, v150, v151
    s_waitcnt lgkmcnt(8)
    v_mfma_f32_16x16x32_bf16 v[40:43], v[104:107], v[132:135], v[40:43]
    v_fma_f32 v156, v156, s63, -v2
    v_fma_f32 v157, v157, s63, -v2
    v_mfma_f32_16x16x32_bf16 v[44:47], v[108:111], v[132:135], v[44:47]
    v_fma_f32 v158, v158, s63, -v2
    v_fma_f32 v159, v159, s63, -v2
    s_waitcnt lgkmcnt(4)
    v_mfma_f32_16x16x32_bf16 v[48:51], v[112:115], v[132:135], v[48:51]
    v_exp_f32 v156, v156
    v_exp_f32 v157, v157
    v_mfma_f32_16x16x32_bf16 v[52:55], v[116:119], v[132:135], v[52:55]
    v_exp_f32 v158, v158
    v_exp_f32 v159, v159
    s_waitcnt lgkmcnt(0)
    v_mfma_f32_16x16x32_bf16 v[56:59], v[120:123], v[132:135], v[56:59]
    v_cvt_pk_bf16_f32 v148, v152, v153
    v_cvt_pk_bf16_f32 v149, v154, v155
    v_mfma_f32_16x16x32_bf16 v[60:63], v[124:127], v[132:135], v[60:63]
    v_cvt_pk_bf16_f32 v150, v156, v157
    v_cvt_pk_bf16_f32 v151, v158, v159
    v_add_u32 v16, 0xffff0000, v16
    v_add_u32 v17, 0xffff0000, v17
    v_add_u32 v18, 0xffff0000, v18
    v_add_u32 v19, 0xffff0000, v19
    v_add_u32 v20, 0xffff0000, v20
    v_add_u32 v21, 0xffff0000, v21
    v_add_u32 v22, 0xffff0000, v22
    v_add_u32 v23, 0xffff0000, v23
    s_waitcnt vmcnt(4)
    s_barrier
    ds_read_b64_tr_b16 v[64:65], v16 offset:0
    ds_read_b64_tr_b16 v[66:67], v16 offset:4096
    ds_read_b64_tr_b16 v[68:69], v17 offset:0
    ds_read_b64_tr_b16 v[70:71], v17 offset:4096
    ds_read_b64_tr_b16 v[72:73], v18 offset:0
    ds_read_b64_tr_b16 v[74:75], v18 offset:4096
    ds_read_b64_tr_b16 v[76:77], v19 offset:0
    ds_read_b64_tr_b16 v[78:79], v19 offset:4096
    ds_read_b64_tr_b16 v[80:81], v20 offset:0
    ds_read_b64_tr_b16 v[82:83], v20 offset:4096
    ds_read_b64_tr_b16 v[84:85], v21 offset:0
    ds_read_b64_tr_b16 v[86:87], v21 offset:4096
    ds_read_b64_tr_b16 v[88:89], v22 offset:0
    ds_read_b64_tr_b16 v[90:91], v22 offset:4096
    v_fma_f32 v160, v160, s63, -v2
    v_fma_f32 v161, v161, s63, -v2
    v_fma_f32 v162, v162, s63, -v2
    v_fma_f32 v163, v163, s63, -v2
    v_mfma_f32_16x16x32_bf16 v[136:139], v[140:143], v[144:147], v[136:139]
    s_add_u32 m0, s62, 65536
    s_add_u32 s65, s34, 49152
    buffer_load_dwordx4 v4, s[16:19], s65 offen nt lds
    v_exp_f32 v160, v160
    v_exp_f32 v161, v161
    v_mfma_f32_16x16x32_bf16 v[136:139], v[140:143], v[148:151], v[136:139]
    v_exp_f32 v162, v162
    v_exp_f32 v163, v163
    s_waitcnt lgkmcnt(10)
    v_mfma_f32_16x16x32_bf16 v[32:35], v[64:67], v[144:147], v[32:35]
    ds_read_b64_tr_b16 v[92:93], v23 offset:0
    ds_read_b64_tr_b16 v[94:95], v23 offset:4096
    ds_read_b64_tr_b16 v[96:97], v16 offset:8192
    ds_read_b64_tr_b16 v[98:99], v16 offset:12288
    v_fma_f32 v164, v164, s63, -v2
    v_fma_f32 v165, v165, s63, -v2
    v_mfma_f32_16x16x32_bf16 v[36:39], v[68:71], v[144:147], v[36:39]
    buffer_load_dwordx4 v5, s[16:19], s65 offen offset:1024 nt lds
    v_fma_f32 v166, v166, s63, -v2
    v_fma_f32 v167, v167, s63, -v2
    s_waitcnt lgkmcnt(10)
    v_mfma_f32_16x16x32_bf16 v[40:43], v[72:75], v[144:147], v[40:43]
    ds_read_b64_tr_b16 v[100:101], v17 offset:8192
    ds_read_b64_tr_b16 v[102:103], v17 offset:12288
    ds_read_b64_tr_b16 v[104:105], v18 offset:8192
    ds_read_b64_tr_b16 v[106:107], v18 offset:12288
    v_exp_f32 v164, v164
    v_exp_f32 v165, v165
    v_mfma_f32_16x16x32_bf16 v[44:47], v[76:79], v[144:147], v[44:47]
    v_exp_f32 v166, v166
    v_exp_f32 v167, v167
    s_waitcnt lgkmcnt(10)
    v_mfma_f32_16x16x32_bf16 v[48:51], v[80:83], v[144:147], v[48:51]
    ds_read_b64_tr_b16 v[108:109], v19 offset:8192
    ds_read_b64_tr_b16 v[110:111], v19 offset:12288
    ds_read_b64_tr_b16 v[112:113], v20 offset:8192
    ds_read_b64_tr_b16 v[114:115], v20 offset:12288
    s_add_u32 m0, s62, 81920
    s_add_u32 s65, s34, 180224
    buffer_load_dwordx4 v4, s[16:19], s65 offen nt lds
    v_cvt_pk_bf16_f32 v160, v160, v161
    v_cvt_pk_bf16_f32 v161, v162, v163
    v_mfma_f32_16x16x32_bf16 v[52:55], v[84:87], v[144:147], v[52:55]
    v_fma_f32 v168, v168, s63, -v2
    v_fma_f32 v169, v169, s63, -v2
    s_waitcnt lgkmcnt(10)
    v_mfma_f32_16x16x32_bf16 v[56:59], v[88:91], v[144:147], v[56:59]
    ds_read_b64_tr_b16 v[116:117], v21 offset:8192
    ds_read_b64_tr_b16 v[118:119], v21 offset:12288
    ds_read_b64_tr_b16 v[120:121], v22 offset:8192
    ds_read_b64_tr_b16 v[122:123], v22 offset:12288
    v_fma_f32 v170, v170, s63, -v2
    v_fma_f32 v171, v171, s63, -v2
    v_mfma_f32_16x16x32_bf16 v[60:63], v[92:95], v[144:147], v[60:63]
    buffer_load_dwordx4 v5, s[16:19], s65 offen offset:1024 nt lds
    v_exp_f32 v168, v168
    v_exp_f32 v169, v169
    s_waitcnt lgkmcnt(10)
    v_mfma_f32_16x16x32_bf16 v[32:35], v[96:99], v[148:151], v[32:35]
    ds_read_b64_tr_b16 v[124:125], v23 offset:8192
    ds_read_b64_tr_b16 v[126:127], v23 offset:12288
    v_exp_f32 v170, v170
    v_exp_f32 v171, v171
    v_mfma_f32_16x16x32_bf16 v[36:39], v[100:103], v[148:151], v[36:39]
    v_cvt_pk_bf16_f32 v162, v164, v165
    v_cvt_pk_bf16_f32 v163, v166, v167
    s_waitcnt lgkmcnt(8)
    v_mfma_f32_16x16x32_bf16 v[40:43], v[104:107], v[148:151], v[40:43]
    v_fma_f32 v172, v172, s63, -v2
    v_fma_f32 v173, v173, s63, -v2
    v_mfma_f32_16x16x32_bf16 v[44:47], v[108:111], v[148:151], v[44:47]
    v_fma_f32 v174, v174, s63, -v2
    v_fma_f32 v175, v175, s63, -v2
    s_waitcnt lgkmcnt(4)
    v_mfma_f32_16x16x32_bf16 v[48:51], v[112:115], v[148:151], v[48:51]
    v_exp_f32 v172, v172
    v_exp_f32 v173, v173
    v_mfma_f32_16x16x32_bf16 v[52:55], v[116:119], v[148:151], v[52:55]
    v_exp_f32 v174, v174
    v_exp_f32 v175, v175
    s_waitcnt lgkmcnt(0)
    v_mfma_f32_16x16x32_bf16 v[56:59], v[120:123], v[148:151], v[56:59]
    v_cvt_pk_bf16_f32 v164, v168, v169
    v_cvt_pk_bf16_f32 v165, v170, v171
    v_mfma_f32_16x16x32_bf16 v[60:63], v[124:127], v[148:151], v[60:63]
    v_cvt_pk_bf16_f32 v166, v172, v173
    v_cvt_pk_bf16_f32 v167, v174, v175
    s_add_u32 m0, s62, 98304
    s_add_u32 s65, s35, 0
    buffer_load_dwordx4 v6, s[24:27], s65 offen lds
    buffer_load_dwordx4 v7, s[24:27], s65 offen offset:1024 lds
    s_add_u32 m0, s62, 114688
    s_add_u32 s65, s35, 73728
    buffer_load_dwordx4 v6, s[24:27], s65 offen lds
    buffer_load_dwordx4 v7, s[24:27], s65 offen offset:1024 lds
    s_waitcnt vmcnt(8)
    s_barrier
    ds_read_b64_tr_b16 v[64:65], v16 offset:32768
    ds_read_b64_tr_b16 v[66:67], v16 offset:36864
    ds_read_b64_tr_b16 v[68:69], v17 offset:32768
    ds_read_b64_tr_b16 v[70:71], v17 offset:36864
    ds_read_b64_tr_b16 v[72:73], v18 offset:32768
    ds_read_b64_tr_b16 v[74:75], v18 offset:36864
    ds_read_b64_tr_b16 v[76:77], v19 offset:32768
    ds_read_b64_tr_b16 v[78:79], v19 offset:36864
    ds_read_b64_tr_b16 v[80:81], v20 offset:32768
    ds_read_b64_tr_b16 v[82:83], v20 offset:36864
    ds_read_b64_tr_b16 v[84:85], v21 offset:32768
    ds_read_b64_tr_b16 v[86:87], v21 offset:36864
    ds_read_b64_tr_b16 v[88:89], v22 offset:32768
    ds_read_b64_tr_b16 v[90:91], v22 offset:36864
    v_fma_f32 v176, v176, s63, -v2
    v_fma_f32 v177, v177, s63, -v2
    v_fma_f32 v178, v178, s63, -v2
    v_fma_f32 v179, v179, s63, -v2
    v_mfma_f32_16x16x32_bf16 v[136:139], v[140:143], v[160:163], v[136:139]
    s_add_u32 m0, s62, 0
    s_add_u32 s65, s34, 65536
    buffer_load_dwordx4 v4, s[16:19], s65 offen nt lds
    v_exp_f32 v176, v176
    v_exp_f32 v177, v177
    v_mfma_f32_16x16x32_bf16 v[136:139], v[140:143], v[164:167], v[136:139]
    v_exp_f32 v178, v178
    v_exp_f32 v179, v179
    s_waitcnt lgkmcnt(10)
    v_mfma_f32_16x16x32_bf16 v[32:35], v[64:67], v[160:163], v[32:35]
    ds_read_b64_tr_b16 v[92:93], v23 offset:32768
    ds_read_b64_tr_b16 v[94:95], v23 offset:36864
    ds_read_b64_tr_b16 v[96:97], v16 offset:40960
    ds_read_b64_tr_b16 v[98:99], v16 offset:45056
    v_fma_f32 v180, v180, s63, -v2
    v_fma_f32 v181, v181, s63, -v2
    v_mfma_f32_16x16x32_bf16 v[36:39], v[68:71], v[160:163], v[36:39]
    buffer_load_dwordx4 v5, s[16:19], s65 offen offset:1024 nt lds
    v_fma_f32 v182, v182, s63, -v2
    v_fma_f32 v183, v183, s63, -v2
    s_waitcnt lgkmcnt(10)
    v_mfma_f32_16x16x32_bf16 v[40:43], v[72:75], v[160:163], v[40:43]
    ds_read_b64_tr_b16 v[100:101], v17 offset:40960
    ds_read_b64_tr_b16 v[102:103], v17 offset:45056
    ds_read_b64_tr_b16 v[104:105], v18 offset:40960
    ds_read_b64_tr_b16 v[106:107], v18 offset:45056
    v_exp_f32 v180, v180
    v_exp_f32 v181, v181
    v_mfma_f32_16x16x32_bf16 v[44:47], v[76:79], v[160:163], v[44:47]
    v_exp_f32 v182, v182
    v_exp_f32 v183, v183
    s_waitcnt lgkmcnt(10)
    v_mfma_f32_16x16x32_bf16 v[48:51], v[80:83], v[160:163], v[48:51]
    ds_read_b64_tr_b16 v[108:109], v19 offset:40960
    ds_read_b64_tr_b16 v[110:111], v19 offset:45056
    ds_read_b64_tr_b16 v[112:113], v20 offset:40960
    ds_read_b64_tr_b16 v[114:115], v20 offset:45056
    s_add_u32 m0, s62, 16384
    s_add_u32 s65, s34, 196608
    buffer_load_dwordx4 v4, s[16:19], s65 offen nt lds
    v_cvt_pk_bf16_f32 v176, v176, v177
    v_cvt_pk_bf16_f32 v177, v178, v179
    v_mfma_f32_16x16x32_bf16 v[52:55], v[84:87], v[160:163], v[52:55]
    v_fma_f32 v184, v184, s63, -v2
    v_fma_f32 v185, v185, s63, -v2
    s_waitcnt lgkmcnt(10)
    v_mfma_f32_16x16x32_bf16 v[56:59], v[88:91], v[160:163], v[56:59]
    ds_read_b64_tr_b16 v[116:117], v21 offset:40960
    ds_read_b64_tr_b16 v[118:119], v21 offset:45056
    ds_read_b64_tr_b16 v[120:121], v22 offset:40960
    ds_read_b64_tr_b16 v[122:123], v22 offset:45056
    v_fma_f32 v186, v186, s63, -v2
    v_fma_f32 v187, v187, s63, -v2
    v_mfma_f32_16x16x32_bf16 v[60:63], v[92:95], v[160:163], v[60:63]
    buffer_load_dwordx4 v5, s[16:19], s65 offen offset:1024 nt lds
    v_exp_f32 v184, v184
    v_exp_f32 v185, v185
    s_waitcnt lgkmcnt(10)
    v_mfma_f32_16x16x32_bf16 v[32:35], v[96:99], v[164:167], v[32:35]
    ds_read_b64_tr_b16 v[124:125], v23 offset:40960
    ds_read_b64_tr_b16 v[126:127], v23 offset:45056
    v_exp_f32 v186, v186
    v_exp_f32 v187, v187
    v_mfma_f32_16x16x32_bf16 v[36:39], v[100:103], v[164:167], v[36:39]
    v_cvt_pk_bf16_f32 v178, v180, v181
    v_cvt_pk_bf16_f32 v179, v182, v183
    s_waitcnt lgkmcnt(8)
    v_mfma_f32_16x16x32_bf16 v[40:43], v[104:107], v[164:167], v[40:43]
    v_fma_f32 v188, v188, s63, -v2
    v_fma_f32 v189, v189, s63, -v2
    v_mfma_f32_16x16x32_bf16 v[44:47], v[108:111], v[164:167], v[44:47]
    v_fma_f32 v190, v190, s63, -v2
    v_fma_f32 v191, v191, s63, -v2
    s_waitcnt lgkmcnt(4)
    v_mfma_f32_16x16x32_bf16 v[48:51], v[112:115], v[164:167], v[48:51]
    v_exp_f32 v188, v188
    v_exp_f32 v189, v189
    v_mfma_f32_16x16x32_bf16 v[52:55], v[116:119], v[164:167], v[52:55]
    v_exp_f32 v190, v190
    v_exp_f32 v191, v191
    s_waitcnt lgkmcnt(0)
    v_mfma_f32_16x16x32_bf16 v[56:59], v[120:123], v[164:167], v[56:59]
    v_cvt_pk_bf16_f32 v180, v184, v185
    v_cvt_pk_bf16_f32 v181, v186, v187
    v_mfma_f32_16x16x32_bf16 v[60:63], v[124:127], v[164:167], v[60:63]
    v_cvt_pk_bf16_f32 v182, v188, v189
    v_cvt_pk_bf16_f32 v183, v190, v191
    s_add_u32 m0, s62, 131072
    s_add_u32 s65, s35, 147456
    buffer_load_dwordx4 v6, s[24:27], s65 offen lds
    buffer_load_dwordx4 v7, s[24:27], s65 offen offset:1024 lds
    s_add_u32 m0, s62, 147456
    s_add_u32 s65, s35, 221184
    buffer_load_dwordx4 v6, s[24:27], s65 offen lds
    buffer_load_dwordx4 v7, s[24:27], s65 offen offset:1024 lds
    v_add_u32 v16, 0x10000, v16
    v_add_u32 v17, 0x10000, v17
    v_add_u32 v18, 0x10000, v18
    v_add_u32 v19, 0x10000, v19
    v_add_u32 v20, 0x10000, v20
    v_add_u32 v21, 0x10000, v21
    v_add_u32 v22, 0x10000, v22
    v_add_u32 v23, 0x10000, v23
    s_waitcnt vmcnt(12)
    s_barrier
    ds_read_b64_tr_b16 v[64:65], v16 offset:0
    ds_read_b64_tr_b16 v[66:67], v16 offset:4096
    ds_read_b64_tr_b16 v[68:69], v17 offset:0
    ds_read_b64_tr_b16 v[70:71], v17 offset:4096
    ds_read_b64_tr_b16 v[72:73], v18 offset:0
    ds_read_b64_tr_b16 v[74:75], v18 offset:4096
    ds_read_b64_tr_b16 v[76:77], v19 offset:0
    ds_read_b64_tr_b16 v[78:79], v19 offset:4096
    ds_read_b64_tr_b16 v[80:81], v20 offset:0
    ds_read_b64_tr_b16 v[82:83], v20 offset:4096
    ds_read_b64_tr_b16 v[84:85], v21 offset:0
    ds_read_b64_tr_b16 v[86:87], v21 offset:4096
    ds_read_b64_tr_b16 v[88:89], v22 offset:0
    ds_read_b64_tr_b16 v[90:91], v22 offset:4096
    v_fma_f32 v192, v192, s63, -v2
    v_fma_f32 v193, v193, s63, -v2
    v_fma_f32 v194, v194, s63, -v2
    v_fma_f32 v195, v195, s63, -v2
    v_mfma_f32_16x16x32_bf16 v[136:139], v[140:143], v[176:179], v[136:139]
    s_add_u32 m0, s62, 32768
    s_add_u32 s65, s34, 81920
    buffer_load_dwordx4 v4, s[16:19], s65 offen nt lds
    v_exp_f32 v192, v192
    v_exp_f32 v193, v193
    v_mfma_f32_16x16x32_bf16 v[136:139], v[140:143], v[180:183], v[136:139]
    v_exp_f32 v194, v194
    v_exp_f32 v195, v195
    s_waitcnt lgkmcnt(10)
    v_mfma_f32_16x16x32_bf16 v[32:35], v[64:67], v[176:179], v[32:35]
    ds_read_b64_tr_b16 v[92:93], v23 offset:0
    ds_read_b64_tr_b16 v[94:95], v23 offset:4096
    ds_read_b64_tr_b16 v[96:97], v16 offset:8192
    ds_read_b64_tr_b16 v[98:99], v16 offset:12288
    v_fma_f32 v196, v196, s63, -v2
    v_fma_f32 v197, v197, s63, -v2
    v_mfma_f32_16x16x32_bf16 v[36:39], v[68:71], v[176:179], v[36:39]
    buffer_load_dwordx4 v5, s[16:19], s65 offen offset:1024 nt lds
    v_fma_f32 v198, v198, s63, -v2
    v_fma_f32 v199, v199, s63, -v2
    s_waitcnt lgkmcnt(10)
    v_mfma_f32_16x16x32_bf16 v[40:43], v[72:75], v[176:179], v[40:43]
    ds_read_b64_tr_b16 v[100:101], v17 offset:8192
    ds_read_b64_tr_b16 v[102:103], v17 offset:12288
    ds_read_b64_tr_b16 v[104:105], v18 offset:8192
    ds_read_b64_tr_b16 v[106:107], v18 offset:12288
    v_exp_f32 v196, v196
    v_exp_f32 v197, v197
    v_mfma_f32_16x16x32_bf16 v[44:47], v[76:79], v[176:179], v[44:47]
    v_exp_f32 v198, v198
    v_exp_f32 v199, v199
    s_waitcnt lgkmcnt(10)
    v_mfma_f32_16x16x32_bf16 v[48:51], v[80:83], v[176:179], v[48:51]
    ds_read_b64_tr_b16 v[108:109], v19 offset:8192
    ds_read_b64_tr_b16 v[110:111], v19 offset:12288
    ds_read_b64_tr_b16 v[112:113], v20 offset:8192
    ds_read_b64_tr_b16 v[114:115], v20 offset:12288
    s_add_u32 m0, s62, 49152
    s_add_u32 s65, s34, 212992
    buffer_load_dwordx4 v4, s[16:19], s65 offen nt lds
    v_cvt_pk_bf16_f32 v192, v192, v193
    v_cvt_pk_bf16_f32 v193, v194, v195
    v_mfma_f32_16x16x32_bf16 v[52:55], v[84:87], v[176:179], v[52:55]
    v_fma_f32 v200, v200, s63, -v2
    v_fma_f32 v201, v201, s63, -v2
    s_waitcnt lgkmcnt(10)
    v_mfma_f32_16x16x32_bf16 v[56:59], v[88:91], v[176:179], v[56:59]
    ds_read_b64_tr_b16 v[116:117], v21 offset:8192
    ds_read_b64_tr_b16 v[118:119], v21 offset:12288
    ds_read_b64_tr_b16 v[120:121], v22 offset:8192
    ds_read_b64_tr_b16 v[122:123], v22 offset:12288
    v_fma_f32 v202, v202, s63, -v2
    v_fma_f32 v203, v203, s63, -v2
    v_mfma_f32_16x16x32_bf16 v[60:63], v[92:95], v[176:179], v[60:63]
    buffer_load_dwordx4 v5, s[16:19], s65 offen offset:1024 nt lds
    v_exp_f32 v200, v200
    v_exp_f32 v201, v201
    s_waitcnt lgkmcnt(10)
    v_mfma_f32_16x16x32_bf16 v[32:35], v[96:99], v[180:183], v[32:35]
    ds_read_b64_tr_b16 v[124:125], v23 offset:8192
    ds_read_b64_tr_b16 v[126:127], v23 offset:12288
    v_exp_f32 v202, v202
    v_exp_f32 v203, v203
    v_mfma_f32_16x16x32_bf16 v[36:39], v[100:103], v[180:183], v[36:39]
    v_cvt_pk_bf16_f32 v194, v196, v197
    v_cvt_pk_bf16_f32 v195, v198, v199
    s_waitcnt lgkmcnt(8)
    v_mfma_f32_16x16x32_bf16 v[40:43], v[104:107], v[180:183], v[40:43]
    v_fma_f32 v204, v204, s63, -v2
    v_fma_f32 v205, v205, s63, -v2
    v_mfma_f32_16x16x32_bf16 v[44:47], v[108:111], v[180:183], v[44:47]
    v_fma_f32 v206, v206, s63, -v2
    v_fma_f32 v207, v207, s63, -v2
    s_waitcnt lgkmcnt(4)
    v_mfma_f32_16x16x32_bf16 v[48:51], v[112:115], v[180:183], v[48:51]
    v_exp_f32 v204, v204
    v_exp_f32 v205, v205
    v_mfma_f32_16x16x32_bf16 v[52:55], v[116:119], v[180:183], v[52:55]
    v_exp_f32 v206, v206
    v_exp_f32 v207, v207
    s_waitcnt lgkmcnt(0)
    v_mfma_f32_16x16x32_bf16 v[56:59], v[120:123], v[180:183], v[56:59]
    v_cvt_pk_bf16_f32 v196, v200, v201
    v_cvt_pk_bf16_f32 v197, v202, v203
    v_mfma_f32_16x16x32_bf16 v[60:63], v[124:127], v[180:183], v[60:63]
    v_cvt_pk_bf16_f32 v198, v204, v205
    v_cvt_pk_bf16_f32 v199, v206, v207
    v_add_u32 v16, 0xffff0000, v16
    v_add_u32 v17, 0xffff0000, v17
    v_add_u32 v18, 0xffff0000, v18
    v_add_u32 v19, 0xffff0000, v19
    v_add_u32 v20, 0xffff0000, v20
    v_add_u32 v21, 0xffff0000, v21
    v_add_u32 v22, 0xffff0000, v22
    v_add_u32 v23, 0xffff0000, v23
    s_waitcnt vmcnt(8)
    s_barrier
    v_add_u32 v24, 0x18000, v24
    v_add_u32 v25, 0x18000, v25
    ds_read_b64_tr_b16 v[64:65], v16 offset:0
    ds_read_b64_tr_b16 v[66:67], v16 offset:4096
    ds_read_b64_tr_b16 v[68:69], v17 offset:0
    ds_read_b64_tr_b16 v[70:71], v17 offset:4096
    ds_read_b64_tr_b16 v[72:73], v18 offset:0
    ds_read_b64_tr_b16 v[74:75], v18 offset:4096
    ds_read_b64_tr_b16 v[76:77], v19 offset:0
    ds_read_b64_tr_b16 v[78:79], v19 offset:4096
    ds_read_b64_tr_b16 v[80:81], v20 offset:0
    ds_read_b64_tr_b16 v[82:83], v20 offset:4096
    ds_read_b64_tr_b16 v[84:85], v21 offset:0
    ds_read_b64_tr_b16 v[86:87], v21 offset:4096
    ds_read_b64_tr_b16 v[88:89], v22 offset:0
    ds_read_b64_tr_b16 v[90:91], v22 offset:4096
    v_fma_f32 v208, v208, s63, -v2
    v_fma_f32 v209, v209, s63, -v2
    v_fma_f32 v210, v210, s63, -v2
    v_fma_f32 v211, v211, s63, -v2
    v_mfma_f32_16x16x32_bf16 v[136:139], v[140:143], v[192:195], v[136:139]
    s_add_u32 m0, s62, 65536
    s_add_u32 s65, s34, 98304
    buffer_load_dwordx4 v4, s[16:19], s65 offen nt lds
    v_exp_f32 v208, v208
    v_exp_f32 v209, v209
    v_mfma_f32_16x16x32_bf16 v[136:139], v[140:143], v[196:199], v[136:139]
    v_exp_f32 v210, v210
    v_exp_f32 v211, v211
    s_waitcnt lgkmcnt(10)
    v_mfma_f32_16x16x32_bf16 v[32:35], v[64:67], v[192:195], v[32:35]
    ds_read_b64_tr_b16 v[92:93], v23 offset:0
    ds_read_b64_tr_b16 v[94:95], v23 offset:4096
    ds_read_b64_tr_b16 v[96:97], v16 offset:8192
    ds_read_b64_tr_b16 v[98:99], v16 offset:12288
    buffer_load_dwordx4 v5, s[16:19], s65 offen offset:1024 nt lds
    v_fma_f32 v212, v212, s63, -v2
    v_fma_f32 v213, v213, s63, -v2
    v_mfma_f32_16x16x32_bf16 v[36:39], v[68:71], v[192:195], v[36:39]
    v_fma_f32 v214, v214, s63, -v2
    v_fma_f32 v215, v215, s63, -v2
    s_waitcnt lgkmcnt(10)
    v_mfma_f32_16x16x32_bf16 v[40:43], v[72:75], v[192:195], v[40:43]
    ds_read_b64_tr_b16 v[100:101], v17 offset:8192
    ds_read_b64_tr_b16 v[102:103], v17 offset:12288
    ds_read_b64_tr_b16 v[104:105], v18 offset:8192
    ds_read_b64_tr_b16 v[106:107], v18 offset:12288
    s_add_u32 m0, s62, 81920
    s_add_u32 s65, s34, 229376
    buffer_load_dwordx4 v4, s[16:19], s65 offen nt lds
    v_exp_f32 v212, v212
    v_exp_f32 v213, v213
    v_mfma_f32_16x16x32_bf16 v[44:47], v[76:79], v[192:195], v[44:47]
    v_exp_f32 v214, v214
    v_exp_f32 v215, v215
    s_waitcnt lgkmcnt(10)
    v_mfma_f32_16x16x32_bf16 v[48:51], v[80:83], v[192:195], v[48:51]
    ds_read_b64_tr_b16 v[108:109], v19 offset:8192
    ds_read_b64_tr_b16 v[110:111], v19 offset:12288
    ds_read_b64_tr_b16 v[112:113], v20 offset:8192
    ds_read_b64_tr_b16 v[114:115], v20 offset:12288
    v_cvt_pk_bf16_f32 v208, v208, v209
    v_cvt_pk_bf16_f32 v209, v210, v211
    v_mfma_f32_16x16x32_bf16 v[52:55], v[84:87], v[192:195], v[52:55]
    buffer_load_dwordx4 v5, s[16:19], s65 offen offset:1024 nt lds
    v_fma_f32 v216, v216, s63, -v2
    v_fma_f32 v217, v217, s63, -v2
    s_waitcnt lgkmcnt(10)
    v_mfma_f32_16x16x32_bf16 v[56:59], v[88:91], v[192:195], v[56:59]
    ds_read_b64_tr_b16 v[116:117], v21 offset:8192
    ds_read_b64_tr_b16 v[118:119], v21 offset:12288
    ds_read_b64_tr_b16 v[120:121], v22 offset:8192
    ds_read_b64_tr_b16 v[122:123], v22 offset:12288
    v_fma_f32 v218, v218, s63, -v2
    v_fma_f32 v219, v219, s63, -v2
    v_mfma_f32_16x16x32_bf16 v[60:63], v[92:95], v[192:195], v[60:63]
    s_cmp_eq_u32 s4, 0
    s_cbranch_scc0 na_1
    v_lshlrev_b32 v11, 8, v0
    v_mov_b32 v30, 1
    buffer_atomic_add v30, v11, s[84:87], s82 offen sc1
na_1:
    v_exp_f32 v216, v216
    v_exp_f32 v217, v217
    s_waitcnt lgkmcnt(10)
    v_mfma_f32_16x16x32_bf16 v[32:35], v[96:99], v[196:199], v[32:35]
    ds_read_b64_tr_b16 v[124:125], v23 offset:8192
    ds_read_b64_tr_b16 v[126:127], v23 offset:12288
    ds_read_b64_tr_b16 v[144:145], v24 offset:0
    ds_read_b64_tr_b16 v[146:147], v24 offset:4096
    ds_read_b64_tr_b16 v[148:149], v25 offset:0
    s_waitcnt lgkmcnt(12)
    ds_read_b64_tr_b16 v[150:151], v25 offset:4096
    ds_read_b64_tr_b16 v[152:153], v24 offset:8192
    ds_read_b64_tr_b16 v[154:155], v24 offset:12288
    s_waitcnt lgkmcnt(12)
    ds_read_b64_tr_b16 v[156:157], v25 offset:8192
    ds_read_b64_tr_b16 v[158:159], v25 offset:12288
    ds_read_b64_tr_b16 v[160:161], v24 offset:16384
    s_waitcnt lgkmcnt(12)
    ds_read_b64_tr_b16 v[162:163], v24 offset:20480
    ds_read_b64_tr_b16 v[164:165], v25 offset:16384
    v_exp_f32 v218, v218
    v_exp_f32 v219, v219
    v_mfma_f32_16x16x32_bf16 v[36:39], v[100:103], v[196:199], v[36:39]
    ds_read_b64_tr_b16 v[166:167], v25 offset:20480
    v_cvt_pk_bf16_f32 v210, v212, v213
    v_cvt_pk_bf16_f32 v211, v214, v215
    v_mfma_f32_16x16x32_bf16 v[40:43], v[104:107], v[196:199], v[40:43]
    s_waitcnt lgkmcnt(12)
    ds_read_b64_tr_b16 v[168:169], v24 offset:24576
    v_fma_f32 v220, v220, s63, -v2
    v_fma_f32 v221, v221, s63, -v2
    v_mfma_f32_16x16x32_bf16 v[44:47], v[108:111], v[196:199], v[44:47]
    ds_read_b64_tr_b16 v[170:171], v24 offset:28672
    v_fma_f32 v222, v222, s63, -v2
    v_fma_f32 v223, v223, s63, -v2
    v_mfma_f32_16x16x32_bf16 v[48:51], v[112:115], v[196:199], v[48:51]
    ds_read_b64_tr_b16 v[172:173], v25 offset:24576
    v_exp_f32 v220, v220
    v_exp_f32 v221, v221
    v_mfma_f32_16x16x32_bf16 v[52:55], v[116:119], v[196:199], v[52:55]
    s_waitcnt lgkmcnt(12)
    ds_read_b64_tr_b16 v[174:175], v25 offset:28672
    v_exp_f32 v222, v222
    v_exp_f32 v223, v223
    v_mfma_f32_16x16x32_bf16 v[56:59], v[120:123], v[196:199], v[56:59]
    v_cvt_pk_bf16_f32 v212, v216, v217
    v_cvt_pk_bf16_f32 v213, v218, v219
    v_mfma_f32_16x16x32_bf16 v[60:63], v[124:127], v[196:199], v[60:63]
    v_cvt_pk_bf16_f32 v214, v220, v221
    v_cvt_pk_bf16_f32 v215, v222, v223
    s_waitcnt lgkmcnt(0)
    s_waitcnt vmcnt(4)
    s_barrier
    ds_read_b64_tr_b16 v[64:65], v16 offset:32768
    ds_read_b64_tr_b16 v[66:67], v16 offset:36864
    ds_read_b64_tr_b16 v[68:69], v17 offset:32768
    ds_read_b64_tr_b16 v[70:71], v17 offset:36864
    ds_read_b64_tr_b16 v[72:73], v18 offset:32768
    ds_read_b64_tr_b16 v[74:75], v18 offset:36864
    ds_read_b64_tr_b16 v[76:77], v19 offset:32768
    ds_read_b64_tr_b16 v[78:79], v19 offset:36864
    ds_read_b64_tr_b16 v[80:81], v20 offset:32768
    ds_read_b64_tr_b16 v[82:83], v20 offset:36864
    ds_read_b64_tr_b16 v[84:85], v21 offset:32768
    ds_read_b64_tr_b16 v[86:87], v21 offset:36864
    ds_read_b64_tr_b16 v[88:89], v22 offset:32768
    ds_read_b64_tr_b16 v[90:91], v22 offset:36864
    v_fma_f32 v224, v224, s63, -v2
    v_fma_f32 v225, v225, s63, -v2
    v_fma_f32 v226, v226, s63, -v2
    v_fma_f32 v227, v227, s63, -v2
    v_mfma_f32_16x16x32_bf16 v[136:139], v[140:143], v[208:211], v[136:139]
    s_add_u32 m0, s62, 0
    s_add_u32 s65, s34, 114688
    buffer_load_dwordx4 v4, s[16:19], s65 offen nt lds
    v_exp_f32 v224, v224
    v_exp_f32 v225, v225
    v_mfma_f32_16x16x32_bf16 v[136:139], v[140:143], v[212:215], v[136:139]
    v_exp_f32 v226, v226
    v_exp_f32 v227, v227
    s_waitcnt lgkmcnt(10)
    v_mfma_f32_16x16x32_bf16 v[32:35], v[64:67], v[208:211], v[32:35]
    ds_read_b64_tr_b16 v[92:93], v23 offset:32768
    ds_read_b64_tr_b16 v[94:95], v23 offset:36864
    ds_read_b64_tr_b16 v[96:97], v16 offset:40960
    ds_read_b64_tr_b16 v[98:99], v16 offset:45056
    v_fma_f32 v228, v228, s63, -v2
    v_fma_f32 v229, v229, s63, -v2
    v_mfma_f32_16x16x32_bf16 v[36:39], v[68:71], v[208:211], v[36:39]
    buffer_load_dwordx4 v5, s[16:19], s65 offen offset:1024 nt lds
    v_fma_f32 v230, v230, s63, -v2
    v_fma_f32 v231, v231, s63, -v2
    s_waitcnt lgkmcnt(10)
    v_mfma_f32_16x16x32_bf16 v[40:43], v[72:75], v[208:211], v[40:43]
    ds_read_b64_tr_b16 v[100:101], v17 offset:40960
    ds_read_b64_tr_b16 v[102:103], v17 offset:45056
    ds_read_b64_tr_b16 v[104:105], v18 offset:40960
    ds_read_b64_tr_b16 v[106:107], v18 offset:45056
    v_exp_f32 v228, v228
    v_exp_f32 v229, v229
    v_mfma_f32_16x16x32_bf16 v[44:47], v[76:79], v[208:211], v[44:47]
    v_exp_f32 v230, v230
    v_exp_f32 v231, v231
    s_waitcnt lgkmcnt(10)
    v_mfma_f32_16x16x32_bf16 v[48:51], v[80:83], v[208:211], v[48:51]
    ds_read_b64_tr_b16 v[108:109], v19 offset:40960
    ds_read_b64_tr_b16 v[110:111], v19 offset:45056
    ds_read_b64_tr_b16 v[112:113], v20 offset:40960
    ds_read_b64_tr_b16 v[114:115], v20 offset:45056
    s_add_u32 m0, s62, 16384
    s_add_u32 s65, s34, 245760
    buffer_load_dwordx4 v4, s[16:19], s65 offen nt lds
    v_cvt_pk_bf16_f32 v224, v224, v225
    v_cvt_pk_bf16_f32 v225, v226, v227
    v_mfma_f32_16x16x32_bf16 v[52:55], v[84:87], v[208:211], v[52:55]
    v_fma_f32 v232, v232, s63, -v2
    v_fma_f32 v233, v233, s63, -v2
    s_waitcnt lgkmcnt(10)
    v_mfma_f32_16x16x32_bf16 v[56:59], v[88:91], v[208:211], v[56:59]
    ds_read_b64_tr_b16 v[116:117], v21 offset:40960
    ds_read_b64_tr_b16 v[118:119], v21 offset:45056
    ds_read_b64_tr_b16 v[120:121], v22 offset:40960
    ds_read_b64_tr_b16 v[122:123], v22 offset:45056
    v_fma_f32 v234, v234, s63, -v2
    v_fma_f32 v235, v235, s63, -v2
    v_mfma_f32_16x16x32_bf16 v[60:63], v[92:95], v[208:211], v[60:63]
    buffer_load_dwordx4 v5, s[16:19], s65 offen offset:1024 nt lds
    v_exp_f32 v232, v232
    v_exp_f32 v233, v233
    s_waitcnt lgkmcnt(10)
    v_mfma_f32_16x16x32_bf16 v[32:35], v[96:99], v[212:215], v[32:35]
    ds_read_b64_tr_b16 v[124:125], v23 offset:40960
    ds_read_b64_tr_b16 v[126:127], v23 offset:45056
    ds_read_b64_tr_b16 v[176:177], v24 offset:32768
    ds_read_b64_tr_b16 v[178:179], v24 offset:36864
    ds_read_b64_tr_b16 v[180:181], v25 offset:32768
    s_waitcnt lgkmcnt(12)
    ds_read_b64_tr_b16 v[182:183], v25 offset:36864
    ds_read_b64_tr_b16 v[184:185], v24 offset:40960
    ds_read_b64_tr_b16 v[186:187], v24 offset:45056
    s_waitcnt lgkmcnt(12)
    ds_read_b64_tr_b16 v[188:189], v25 offset:40960
    ds_read_b64_tr_b16 v[190:191], v25 offset:45056
    ds_read_b64_tr_b16 v[192:193], v24 offset:49152
    s_waitcnt lgkmcnt(12)
    ds_read_b64_tr_b16 v[194:195], v24 offset:53248
    ds_read_b64_tr_b16 v[196:197], v25 offset:49152
    v_exp_f32 v234, v234
    v_exp_f32 v235, v235
    v_mfma_f32_16x16x32_bf16 v[36:39], v[100:103], v[212:215], v[36:39]
    ds_read_b64_tr_b16 v[198:199], v25 offset:53248
    v_cvt_pk_bf16_f32 v226, v228, v229
    v_cvt_pk_bf16_f32 v227, v230, v231
    v_mfma_f32_16x16x32_bf16 v[40:43], v[104:107], v[212:215], v[40:43]
    s_waitcnt lgkmcnt(12)
    ds_read_b64_tr_b16 v[200:201], v24 offset:57344
    v_fma_f32 v236, v236, s63, -v2
    v_fma_f32 v237, v237, s63, -v2
    v_mfma_f32_16x16x32_bf16 v[44:47], v[108:111], v[212:215], v[44:47]
    ds_read_b64_tr_b16 v[202:203], v24 offset:61440
    v_fma_f32 v238, v238, s63, -v2
    v_fma_f32 v239, v239, s63, -v2
    v_mfma_f32_16x16x32_bf16 v[48:51], v[112:115], v[212:215], v[48:51]
    ds_read_b64_tr_b16 v[204:205], v25 offset:57344
    v_exp_f32 v236, v236
    v_exp_f32 v237, v237
    v_mfma_f32_16x16x32_bf16 v[52:55], v[116:119], v[212:215], v[52:55]
    s_waitcnt lgkmcnt(12)
    ds_read_b64_tr_b16 v[206:207], v25 offset:61440
    v_exp_f32 v238, v238
    v_exp_f32 v239, v239
    v_mfma_f32_16x16x32_bf16 v[56:59], v[120:123], v[212:215], v[56:59]
    v_cvt_pk_bf16_f32 v228, v232, v233
    v_cvt_pk_bf16_f32 v229, v234, v235
    v_mfma_f32_16x16x32_bf16 v[60:63], v[124:127], v[212:215], v[60:63]
    v_cvt_pk_bf16_f32 v230, v236, v237
    v_cvt_pk_bf16_f32 v231, v238, v239
    v_add_u32 v16, 0x10000, v16
    v_add_u32 v17, 0x10000, v17
    v_add_u32 v18, 0x10000, v18
    v_add_u32 v19, 0x10000, v19
    v_add_u32 v20, 0x10000, v20
    v_add_u32 v21, 0x10000, v21
    v_add_u32 v22, 0x10000, v22
    v_add_u32 v23, 0x10000, v23
    s_waitcnt lgkmcnt(0)
    s_waitcnt vmcnt(4)
    s_barrier
    ds_read_b64_tr_b16 v[64:65], v16 offset:0
    ds_read_b64_tr_b16 v[66:67], v16 offset:4096
    ds_read_b64_tr_b16 v[68:69], v17 offset:0
    ds_read_b64_tr_b16 v[70:71], v17 offset:4096
    ds_read_b64_tr_b16 v[72:73], v18 offset:0
    ds_read_b64_tr_b16 v[74:75], v18 offset:4096
    ds_read_b64_tr_b16 v[76:77], v19 offset:0
    ds_read_b64_tr_b16 v[78:79], v19 offset:4096
    ds_read_b64_tr_b16 v[80:81], v20 offset:0
    ds_read_b64_tr_b16 v[82:83], v20 offset:4096
    ds_read_b64_tr_b16 v[84:85], v21 offset:0
    ds_read_b64_tr_b16 v[86:87], v21 offset:4096
    ds_read_b64_tr_b16 v[88:89], v22 offset:0
    ds_read_b64_tr_b16 v[90:91], v22 offset:4096
    v_fma_f32 v240, v240, s63, -v2
    v_fma_f32 v241, v241, s63, -v2
    v_fma_f32 v242, v242, s63, -v2
    v_fma_f32 v243, v243, s63, -v2
    v_mfma_f32_16x16x32_bf16 v[136:139], v[140:143], v[224:227], v[136:139]
    s_add_u32 m0, s62, 32768
    s_add_u32 s65, s35, 256
    buffer_load_dwordx4 v6, s[24:27], s65 offen lds
    v_exp_f32 v240, v240
    v_exp_f32 v241, v241
    v_mfma_f32_16x16x32_bf16 v[136:139], v[140:143], v[228:231], v[136:139]
    v_exp_f32 v242, v242
    v_exp_f32 v243, v243
    s_waitcnt lgkmcnt(10)
    v_mfma_f32_16x16x32_bf16 v[32:35], v[64:67], v[224:227], v[32:35]
    ds_read_b64_tr_b16 v[92:93], v23 offset:0
    ds_read_b64_tr_b16 v[94:95], v23 offset:4096
    ds_read_b64_tr_b16 v[96:97], v16 offset:8192
    ds_read_b64_tr_b16 v[98:99], v16 offset:12288
    v_fma_f32 v244, v244, s63, -v2
    v_fma_f32 v245, v245, s63, -v2
    v_mfma_f32_16x16x32_bf16 v[36:39], v[68:71], v[224:227], v[36:39]
    buffer_load_dwordx4 v7, s[24:27], s65 offen offset:1024 lds
    v_fma_f32 v246, v246, s63, -v2
    v_fma_f32 v247, v247, s63, -v2
    s_waitcnt lgkmcnt(10)
    v_mfma_f32_16x16x32_bf16 v[40:43], v[72:75], v[224:227], v[40:43]
    ds_read_b64_tr_b16 v[100:101], v17 offset:8192
    ds_read_b64_tr_b16 v[102:103], v17 offset:12288
    ds_read_b64_tr_b16 v[104:105], v18 offset:8192
    ds_read_b64_tr_b16 v[106:107], v18 offset:12288
    v_exp_f32 v244, v244
    v_exp_f32 v245, v245
    v_mfma_f32_16x16x32_bf16 v[44:47], v[76:79], v[224:227], v[44:47]
    v_exp_f32 v246, v246
    v_exp_f32 v247, v247
    s_waitcnt lgkmcnt(10)
    v_mfma_f32_16x16x32_bf16 v[48:51], v[80:83], v[224:227], v[48:51]
    ds_read_b64_tr_b16 v[108:109], v19 offset:8192
    ds_read_b64_tr_b16 v[110:111], v19 offset:12288
    ds_read_b64_tr_b16 v[112:113], v20 offset:8192
    ds_read_b64_tr_b16 v[114:115], v20 offset:12288
    s_add_u32 m0, s62, 49152
    s_add_u32 s65, s35, 73984
    buffer_load_dwordx4 v6, s[24:27], s65 offen lds
    v_cvt_pk_bf16_f32 v240, v240, v241
    v_cvt_pk_bf16_f32 v241, v242, v243
    v_mfma_f32_16x16x32_bf16 v[52:55], v[84:87], v[224:227], v[52:55]
    v_fma_f32 v248, v248, s63, -v2
    v_fma_f32 v249, v249, s63, -v2
    s_waitcnt lgkmcnt(10)
    v_mfma_f32_16x16x32_bf16 v[56:59], v[88:91], v[224:227], v[56:59]
    ds_read_b64_tr_b16 v[116:117], v21 offset:8192
    ds_read_b64_tr_b16 v[118:119], v21 offset:12288
    ds_read_b64_tr_b16 v[120:121], v22 offset:8192
    ds_read_b64_tr_b16 v[122:123], v22 offset:12288
    v_fma_f32 v250, v250, s63, -v2
    v_fma_f32 v251, v251, s63, -v2
    v_mfma_f32_16x16x32_bf16 v[60:63], v[92:95], v[224:227], v[60:63]
    buffer_load_dwordx4 v7, s[24:27], s65 offen offset:1024 lds
    v_exp_f32 v248, v248
    v_exp_f32 v249, v249
    s_waitcnt lgkmcnt(10)
    v_mfma_f32_16x16x32_bf16 v[32:35], v[96:99], v[228:231], v[32:35]
    ds_read_b64_tr_b16 v[124:125], v23 offset:8192
    ds_read_b64_tr_b16 v[126:127], v23 offset:12288
    v_exp_f32 v250, v250
    v_exp_f32 v251, v251
    v_mfma_f32_16x16x32_bf16 v[36:39], v[100:103], v[228:231], v[36:39]
    v_cvt_pk_bf16_f32 v242, v244, v245
    v_cvt_pk_bf16_f32 v243, v246, v247
    s_waitcnt lgkmcnt(8)
    v_mfma_f32_16x16x32_bf16 v[40:43], v[104:107], v[228:231], v[40:43]
    v_fma_f32 v252, v252, s63, -v2
    v_fma_f32 v253, v253, s63, -v2
    v_mfma_f32_16x16x32_bf16 v[44:47], v[108:111], v[228:231], v[44:47]
    v_fma_f32 v254, v254, s63, -v2
    v_fma_f32 v255, v255, s63, -v2
    s_waitcnt lgkmcnt(4)
    v_mfma_f32_16x16x32_bf16 v[48:51], v[112:115], v[228:231], v[48:51]
    v_exp_f32 v252, v252
    v_exp_f32 v253, v253
    v_mfma_f32_16x16x32_bf16 v[52:55], v[116:119], v[228:231], v[52:55]
    v_exp_f32 v254, v254
    v_exp_f32 v255, v255
    s_waitcnt lgkmcnt(0)
    v_mfma_f32_16x16x32_bf16 v[56:59], v[120:123], v[228:231], v[56:59]
    v_cvt_pk_bf16_f32 v244, v248, v249
    v_cvt_pk_bf16_f32 v245, v250, v251
    v_mfma_f32_16x16x32_bf16 v[60:63], v[124:127], v[228:231], v[60:63]
    v_cvt_pk_bf16_f32 v246, v252, v253
    v_cvt_pk_bf16_f32 v247, v254, v255
    v_add_u32 v16, 0xffff0000, v16
    v_add_u32 v17, 0xffff0000, v17
    v_add_u32 v18, 0xffff0000, v18
    v_add_u32 v19, 0xffff0000, v19
    v_add_u32 v20, 0xffff0000, v20
    v_add_u32 v21, 0xffff0000, v21
    v_add_u32 v22, 0xffff0000, v22
    v_add_u32 v23, 0xffff0000, v23
    s_waitcnt vmcnt(4)
    s_barrier
    ds_read_b64_tr_b16 v[64:65], v16 offset:0
    ds_read_b64_tr_b16 v[66:67], v16 offset:4096
    ds_read_b64_tr_b16 v[68:69], v17 offset:0
    ds_read_b64_tr_b16 v[70:71], v17 offset:4096
    ds_read_b64_tr_b16 v[72:73], v18 offset:0
    ds_read_b64_tr_b16 v[74:75], v18 offset:4096
    ds_read_b64_tr_b16 v[76:77], v19 offset:0
    ds_read_b64_tr_b16 v[78:79], v19 offset:4096
    ds_read_b64_tr_b16 v[80:81], v16 offset:8192
    ds_read_b64_tr_b16 v[82:83], v16 offset:12288
    ds_read_b64_tr_b16 v[84:85], v17 offset:8192
    ds_read_b64_tr_b16 v[86:87], v17 offset:12288
    ds_read_b64_tr_b16 v[88:89], v18 offset:8192
    ds_read_b64_tr_b16 v[90:91], v18 offset:12288
    v_mfma_f32_16x16x32_bf16 v[136:139], v[140:143], v[240:243], v[136:139]
    s_add_u32 m0, s62, 98304
    s_add_u32 s65, s35, 147712
    buffer_load_dwordx4 v6, s[24:27], s65 offen lds
    v_mfma_f32_16x16x32_bf16 v[136:139], v[140:143], v[244:247], v[136:139]
    s_waitcnt lgkmcnt(10)
    v_mfma_f32_16x16x32_bf16 v[32:35], v[64:67], v[240:243], v[32:35]
    ds_read_b64_tr_b16 v[92:93], v19 offset:8192
    ds_read_b64_tr_b16 v[94:95], v19 offset:12288
    ds_read_b64_tr_b16 v[96:97], v20 offset:0
    ds_read_b64_tr_b16 v[98:99], v20 offset:4096
    v_mfma_f32_16x16x32_bf16 v[36:39], v[68:71], v[240:243], v[36:39]
    buffer_load_dwordx4 v7, s[24:27], s65 offen offset:1024 lds
    s_waitcnt lgkmcnt(10)
    v_mfma_f32_16x16x32_bf16 v[40:43], v[72:75], v[240:243], v[40:43]
    ds_read_b64_tr_b16 v[100:101], v21 offset:0
    ds_read_b64_tr_b16 v[102:103], v21 offset:4096
    ds_read_b64_tr_b16 v[104:105], v22 offset:0
    ds_read_b64_tr_b16 v[106:107], v22 offset:4096
    v_mfma_f32_16x16x32_bf16 v[44:47], v[76:79], v[240:243], v[44:47]
    s_waitcnt lgkmcnt(10)
    v_mfma_f32_16x16x32_bf16 v[32:35], v[80:83], v[244:247], v[32:35]
    ds_read_b64_tr_b16 v[108:109], v23 offset:0
    ds_read_b64_tr_b16 v[110:111], v23 offset:4096
    ds_read_b64_tr_b16 v[112:113], v20 offset:8192
    ds_read_b64_tr_b16 v[114:115], v20 offset:12288
    s_add_u32 m0, s62, 114688
    s_add_u32 s65, s35, 221440
    buffer_load_dwordx4 v6, s[24:27], s65 offen lds
    v_rcp_f32 v2, v136
    v_mfma_f32_16x16x32_bf16 v[36:39], v[84:87], v[244:247], v[36:39]
    s_waitcnt lgkmcnt(10)
    v_mfma_f32_16x16x32_bf16 v[40:43], v[88:91], v[244:247], v[40:43]
    ds_read_b64_tr_b16 v[116:117], v21 offset:8192
    ds_read_b64_tr_b16 v[118:119], v21 offset:12288
    ds_read_b64_tr_b16 v[120:121], v22 offset:8192
    ds_read_b64_tr_b16 v[122:123], v22 offset:12288
    v_mfma_f32_16x16x32_bf16 v[44:47], v[92:95], v[244:247], v[44:47]
    buffer_load_dwordx4 v7, s[24:27], s65 offen offset:1024 lds
    s_waitcnt lgkmcnt(10)
    v_mfma_f32_16x16x32_bf16 v[48:51], v[96:99], v[240:243], v[48:51]
    ds_read_b64_tr_b16 v[124:125], v23 offset:8192
    ds_read_b64_tr_b16 v[126:127], v23 offset:12288
    v_mfma_f32_16x16x32_bf16 v[52:55], v[100:103], v[240:243], v[52:55]
    s_waitcnt lgkmcnt(8)
    v_mfma_f32_16x16x32_bf16 v[56:59], v[104:107], v[240:243], v[56:59]
    v_mul_f32 v32, v2, v32
    v_mul_f32 v33, v2, v33
    v_mul_f32 v34, v2, v34
    v_mul_f32 v35, v2, v35
    v_mfma_f32_16x16x32_bf16 v[60:63], v[108:111], v[240:243], v[60:63]
    v_mul_f32 v36, v2, v36
    v_mul_f32 v37, v2, v37
    v_mul_f32 v38, v2, v38
    v_mul_f32 v39, v2, v39
    s_waitcnt lgkmcnt(4)
    v_mfma_f32_16x16x32_bf16 v[48:51], v[112:115], v[244:247], v[48:51]
    v_cvt_pk_bf16_f32 v32, v32, v33
    v_cvt_pk_bf16_f32 v33, v34, v35
    v_cvt_pk_bf16_f32 v34, v36, v37
    v_cvt_pk_bf16_f32 v35, v38, v39
    ds_write_b128 v27, v[32:35] offset:0
    v_mfma_f32_16x16x32_bf16 v[52:55], v[116:119], v[244:247], v[52:55]
    v_mul_f32 v40, v2, v40
    v_mul_f32 v41, v2, v41
    v_mul_f32 v42, v2, v42
    v_mul_f32 v43, v2, v43
    s_waitcnt lgkmcnt(1)
    v_mfma_f32_16x16x32_bf16 v[56:59], v[120:123], v[244:247], v[56:59]
    v_mul_f32 v44, v2, v44
    v_mul_f32 v45, v2, v45
    v_mul_f32 v46, v2, v46
    v_mul_f32 v47, v2, v47
    v_mfma_f32_16x16x32_bf16 v[60:63], v[124:127], v[244:247], v[60:63]
    v_cvt_pk_bf16_f32 v40, v40, v41
    v_cvt_pk_bf16_f32 v41, v42, v43
    v_cvt_pk_bf16_f32 v42, v44, v45
    v_cvt_pk_bf16_f32 v43, v46, v47
    ds_write_b128 v27, v[40:43] offset:4096
    v_pk_mul_f32 v[48:49], v[48:49], v[2:3] op_sel_hi:[1,0]
    v_pk_mul_f32 v[50:51], v[50:51], v[2:3] op_sel_hi:[1,0]
    v_pk_mul_f32 v[52:53], v[52:53], v[2:3] op_sel_hi:[1,0]
    v_pk_mul_f32 v[54:55], v[54:55], v[2:3] op_sel_hi:[1,0]
    v_cvt_pk_bf16_f32 v48, v48, v49
    v_cvt_pk_bf16_f32 v49, v50, v51
    v_cvt_pk_bf16_f32 v50, v52, v53
    v_cvt_pk_bf16_f32 v51, v54, v55
    ds_write_b128 v27, v[48:51] offset:8192
    v_pk_mul_f32 v[56:57], v[56:57], v[2:3] op_sel_hi:[1,0]
    v_pk_mul_f32 v[58:59], v[58:59], v[2:3] op_sel_hi:[1,0]
    v_pk_mul_f32 v[60:61], v[60:61], v[2:3] op_sel_hi:[1,0]
    v_pk_mul_f32 v[62:63], v[62:63], v[2:3] op_sel_hi:[1,0]
    v_cvt_pk_bf16_f32 v56, v56, v57
    v_cvt_pk_bf16_f32 v57, v58, v59
    v_cvt_pk_bf16_f32 v58, v60, v61
    v_cvt_pk_bf16_f32 v59, v62, v63
    ds_write_b128 v27, v[56:59] offset:12288
    s_add_u32 m0, s62, 131072
    s_add_u32 s65, s35, 512
    buffer_load_dwordx4 v6, s[24:27], s65 offen lds
    buffer_load_dwordx4 v7, s[24:27], s65 offen offset:1024 lds
    s_add_u32 m0, s62, 147456
    s_add_u32 s65, s35, 74240
    buffer_load_dwordx4 v6, s[24:27], s65 offen lds
    buffer_load_dwordx4 v7, s[24:27], s65 offen offset:1024 lds
    s_waitcnt lgkmcnt(0)
    s_barrier
    ds_read_b128 v[208:211], v26 offset:0
    ds_read_b128 v[212:215], v26 offset:512
    ds_read_b128 v[216:219], v26 offset:4096
    ds_read_b128 v[220:223], v26 offset:4608
    ds_read_b128 v[224:227], v26 offset:8192
    ds_read_b128 v[228:231], v26 offset:8704
    ds_read_b128 v[232:235], v26 offset:12288
    ds_read_b128 v[236:239], v26 offset:12800
    v_mul_u32_u24 v14, 147328, v14
    v_add_u32 v4, v14, v6
    v_add_u32 v5, v14, v7
    v_bfe_u32 v1, v0, 2, 3
    s_waitcnt lgkmcnt(6)
    v_mfma_f32_32x32x16_bf16 v[32:47], v[144:147], v[208:211], 0
    ds_read_b128 v[240:243], v26 offset:16384
    ds_read_b128 v[244:247], v26 offset:16896
    s_add_u32 m0, s62, 0
    s_add_u32 s65, s35, 147968
    buffer_load_dwordx4 v6, s[24:27], s65 offen lds
    v_mfma_f32_32x32x16_bf16 v[32:47], v[148:151], v[212:215], v[32:47]
    ds_read_b128 v[248:251], v26 offset:20480
    v_mul_u32_u24 v1, 4608, v1
    s_waitcnt lgkmcnt(7)
    v_mfma_f32_32x32x16_bf16 v[32:47], v[152:155], v[216:219], v[32:47]
    ds_read_b128 v[252:255], v26 offset:20992
    buffer_load_dwordx4 v7, s[24:27], s65 offen offset:1024 lds
    v_mfma_f32_32x32x16_bf16 v[32:47], v[156:159], v[220:223], v[32:47]
    ds_read_b128 v[128:131], v26 offset:24576
    v_lshrrev_b32 v2, 5, v0
    s_waitcnt lgkmcnt(7)
    v_mfma_f32_32x32x16_bf16 v[32:47], v[160:163], v[224:227], v[32:47]
    ds_read_b128 v[132:135], v26 offset:25088
    s_add_u32 m0, s62, 16384
    s_add_u32 s65, s35, 221696
    buffer_load_dwordx4 v6, s[24:27], s65 offen lds
    v_lshl_add_u32 v1, v2, 6, v1
    v_mfma_f32_32x32x16_bf16 v[32:47], v[164:167], v[228:231], v[32:47]
    ds_read_b128 v[136:139], v26 offset:28672
    s_waitcnt lgkmcnt(7)
    v_mfma_f32_32x32x16_bf16 v[32:47], v[168:171], v[232:235], v[32:47]
    ds_read_b128 v[140:143], v26 offset:29184
    buffer_load_dwordx4 v7, s[24:27], s65 offen offset:1024 lds
    v_and_b32 v2, 3, v0
    v_mfma_f32_32x32x16_bf16 v[32:47], v[172:175], v[236:239], v[32:47]
    v_lshl_add_u32 v1, v2, 4, v1
    s_waitcnt lgkmcnt(0)
    s_waitcnt vmcnt(12)
    s_barrier
    v_add_u32 v24, 0xffff0000, v24
    v_add_u32 v25, 0xffff0000, v25
    v_mfma_f32_32x32x16_bf16 v[32:47], v[176:179], v[240:243], v[32:47]
    ds_read_b64_tr_b16 v[64:65], v24 offset:0
    ds_read_b64_tr_b16 v[66:67], v24 offset:4096
    ds_read_b64_tr_b16 v[68:69], v25 offset:0
    ds_read_b64_tr_b16 v[70:71], v25 offset:4096
    s_add_u32 m0, s62, 65536
    s_add_u32 s65, s35, 768
    buffer_load_dwordx4 v6, s[24:27], s65 offen lds
    v_mfma_f32_32x32x16_bf16 v[32:47], v[180:183], v[244:247], v[32:47]
    ds_read_b64_tr_b16 v[72:73], v24 offset:8192
    ds_read_b64_tr_b16 v[74:75], v24 offset:12288
    ds_read_b64_tr_b16 v[76:77], v25 offset:8192
    buffer_load_dwordx4 v7, s[24:27], s65 offen offset:1024 lds
    v_mfma_f32_32x32x16_bf16 v[32:47], v[184:187], v[248:251], v[32:47]
    ds_read_b64_tr_b16 v[78:79], v25 offset:12288
    ds_read_b64_tr_b16 v[80:81], v24 offset:16384
    ds_read_b64_tr_b16 v[82:83], v24 offset:20480
    v_mfma_f32_32x32x16_bf16 v[32:47], v[188:191], v[252:255], v[32:47]
    ds_read_b64_tr_b16 v[84:85], v25 offset:16384
    ds_read_b64_tr_b16 v[86:87], v25 offset:20480
    ds_read_b64_tr_b16 v[88:89], v24 offset:24576
    s_add_u32 m0, s62, 81920
    s_add_u32 s65, s35, 74496
    buffer_load_dwordx4 v6, s[24:27], s65 offen lds
    v_mfma_f32_32x32x16_bf16 v[32:47], v[192:195], v[128:131], v[32:47]
    ds_read_b64_tr_b16 v[90:91], v24 offset:28672
    ds_read_b64_tr_b16 v[92:93], v25 offset:24576
    s_waitcnt lgkmcnt(12)
    ds_read_b64_tr_b16 v[94:95], v25 offset:28672
    buffer_load_dwordx4 v7, s[24:27], s65 offen offset:1024 lds
    v_mfma_f32_32x32x16_bf16 v[32:47], v[196:199], v[132:135], v[32:47]
    v_mfma_f32_32x32x16_bf16 v[32:47], v[200:203], v[136:139], v[32:47]
    buffer_load_dword v8, off, s[84:87], s82 sc1
    v_mfma_f32_32x32x16_bf16 v[32:47], v[204:207], v[140:143], v[32:47]
    s_waitcnt lgkmcnt(0)
    s_waitcnt vmcnt(13)
    s_barrier
    v_add_u32 v24, 0x10000, v24
    v_add_u32 v25, 0x10000, v25
    v_mfma_f32_32x32x16_bf16 v[48:63], v[64:67], v[208:211], 0
    ds_read_b64_tr_b16 v[96:97], v24 offset:0
    ds_read_b64_tr_b16 v[98:99], v24 offset:4096
    ds_read_b64_tr_b16 v[100:101], v25 offset:0
    ds_read_b64_tr_b16 v[102:103], v25 offset:4096
    s_add_u32 m0, s62, 32768
    s_add_u32 s65, s35, 148224
    buffer_load_dwordx4 v6, s[24:27], s65 offen lds
    v_cvt_pk_bf16_f32 v144, v32, v33
    v_cvt_pk_bf16_f32 v145, v34, v35
    v_mfma_f32_32x32x16_bf16 v[48:63], v[68:71], v[212:215], v[48:63]
    ds_read_b64_tr_b16 v[104:105], v24 offset:8192
    ds_read_b64_tr_b16 v[106:107], v24 offset:12288
    ds_read_b64_tr_b16 v[108:109], v25 offset:8192
    buffer_load_dwordx4 v7, s[24:27], s65 offen offset:1024 lds
    v_cvt_pk_bf16_f32 v146, v36, v37
    v_cvt_pk_bf16_f32 v147, v38, v39
    v_mfma_f32_32x32x16_bf16 v[48:63], v[72:75], v[216:219], v[48:63]
    ds_read_b64_tr_b16 v[110:111], v25 offset:12288
    ds_read_b64_tr_b16 v[112:113], v24 offset:16384
    ds_read_b64_tr_b16 v[114:115], v24 offset:20480
    v_cvt_pk_bf16_f32 v148, v40, v41
    v_cvt_pk_bf16_f32 v149, v42, v43
    v_mfma_f32_32x32x16_bf16 v[48:63], v[76:79], v[220:223], v[48:63]
    ds_read_b64_tr_b16 v[116:117], v25 offset:16384
    ds_read_b64_tr_b16 v[118:119], v25 offset:20480
    ds_read_b64_tr_b16 v[120:121], v24 offset:24576
    s_add_u32 m0, s62, 49152
    s_add_u32 s65, s35, 221952
    buffer_load_dwordx4 v6, s[24:27], s65 offen lds
    v_cvt_pk_bf16_f32 v150, v44, v45
    v_cvt_pk_bf16_f32 v151, v46, v47
    v_mfma_f32_32x32x16_bf16 v[48:63], v[80:83], v[224:227], v[48:63]
    ds_read_b64_tr_b16 v[122:123], v24 offset:28672
    ds_read_b64_tr_b16 v[124:125], v25 offset:24576
    s_waitcnt lgkmcnt(12)
    ds_read_b64_tr_b16 v[126:127], v25 offset:28672
    buffer_load_dwordx4 v7, s[24:27], s65 offen offset:1024 lds
    v_permlane32_swap_b32 v144, v146
    v_permlane32_swap_b32 v145, v147
    v_mfma_f32_32x32x16_bf16 v[48:63], v[84:87], v[228:231], v[48:63]
    v_permlane32_swap_b32 v148, v150
    v_permlane32_swap_b32 v149, v151
    v_mfma_f32_32x32x16_bf16 v[48:63], v[88:91], v[232:235], v[48:63]
    buffer_store_dwordx4 v[144:147], v1, s[28:31], s64 offen offset:0 sc1
    v_mfma_f32_32x32x16_bf16 v[48:63], v[92:95], v[236:239], v[48:63]
    s_waitcnt lgkmcnt(0)
    s_waitcnt vmcnt(14)
    s_barrier
    v_mfma_f32_32x32x16_bf16 v[48:63], v[96:99], v[240:243], v[48:63]
    ds_read_b64_tr_b16 v[64:65], v24 offset:32768
    ds_read_b64_tr_b16 v[66:67], v24 offset:36864
    ds_read_b64_tr_b16 v[68:69], v25 offset:32768
    ds_read_b64_tr_b16 v[70:71], v25 offset:36864
    s_add_u32 m0, s62, 98304
    s_add_u32 s65, s35, 1024
    buffer_load_dwordx4 v4, s[24:27], s65 offen lds
    v_mfma_f32_32x32x16_bf16 v[48:63], v[100:103], v[244:247], v[48:63]
    ds_read_b64_tr_b16 v[72:73], v24 offset:40960
    ds_read_b64_tr_b16 v[74:75], v24 offset:45056
    ds_read_b64_tr_b16 v[76:77], v25 offset:40960
    buffer_load_dwordx4 v5, s[24:27], s65 offen offset:1024 lds
    v_mfma_f32_32x32x16_bf16 v[48:63], v[104:107], v[248:251], v[48:63]
    ds_read_b64_tr_b16 v[78:79], v25 offset:45056
    ds_read_b64_tr_b16 v[80:81], v24 offset:49152
    ds_read_b64_tr_b16 v[82:83], v24 offset:53248
    v_mfma_f32_32x32x16_bf16 v[48:63], v[108:111], v[252:255], v[48:63]
    ds_read_b64_tr_b16 v[84:85], v25 offset:49152
    ds_read_b64_tr_b16 v[86:87], v25 offset:53248
    ds_read_b64_tr_b16 v[88:89], v24 offset:57344
    s_add_u32 m0, s62, 114688
    s_add_u32 s65, s35, 74752
    buffer_load_dwordx4 v4, s[24:27], s65 offen lds
    v_mfma_f32_32x32x16_bf16 v[48:63], v[112:115], v[128:131], v[48:63]
    ds_read_b64_tr_b16 v[90:91], v24 offset:61440
    ds_read_b64_tr_b16 v[92:93], v25 offset:57344
    s_waitcnt lgkmcnt(12)
    ds_read_b64_tr_b16 v[94:95], v25 offset:61440
    buffer_load_dwordx4 v5, s[24:27], s65 offen offset:1024 lds
    v_mfma_f32_32x32x16_bf16 v[48:63], v[116:119], v[132:135], v[48:63]
    v_mfma_f32_32x32x16_bf16 v[48:63], v[120:123], v[136:139], v[48:63]
    buffer_store_dwordx4 v[148:151], v1, s[28:31], s64 offen offset:128 sc1
    v_mfma_f32_32x32x16_bf16 v[48:63], v[124:127], v[140:143], v[48:63]
    s_waitcnt lgkmcnt(0)
    s_waitcnt vmcnt(15)
    s_barrier
    v_add_u32 v24, 0xfffe8000, v24
    v_add_u32 v25, 0xfffe8000, v25
    v_mfma_f32_32x32x16_bf16 v[32:47], v[64:67], v[208:211], 0
    ds_read_b64_tr_b16 v[96:97], v24 offset:0
    ds_read_b64_tr_b16 v[98:99], v24 offset:4096
    ds_read_b64_tr_b16 v[100:101], v25 offset:0
    ds_read_b64_tr_b16 v[102:103], v25 offset:4096
    s_nop 1
    v_cvt_pk_bf16_f32 v152, v48, v49
    v_cvt_pk_bf16_f32 v153, v50, v51
    v_mfma_f32_32x32x16_bf16 v[32:47], v[68:71], v[212:215], v[32:47]
    ds_read_b64_tr_b16 v[104:105], v24 offset:8192
    ds_read_b64_tr_b16 v[106:107], v24 offset:12288
    ds_read_b64_tr_b16 v[108:109], v25 offset:8192
    v_cvt_pk_bf16_f32 v154, v52, v53
    v_cvt_pk_bf16_f32 v155, v54, v55
    v_mfma_f32_32x32x16_bf16 v[32:47], v[72:75], v[216:219], v[32:47]
    ds_read_b64_tr_b16 v[110:111], v25 offset:12288
    ds_read_b64_tr_b16 v[112:113], v24 offset:16384
    ds_read_b64_tr_b16 v[114:115], v24 offset:20480
    v_cvt_pk_bf16_f32 v156, v56, v57
    v_cvt_pk_bf16_f32 v157, v58, v59
    v_mfma_f32_32x32x16_bf16 v[32:47], v[76:79], v[220:223], v[32:47]
    ds_read_b64_tr_b16 v[116:117], v25 offset:16384
    ds_read_b64_tr_b16 v[118:119], v25 offset:20480
    ds_read_b64_tr_b16 v[120:121], v24 offset:24576
    v_cvt_pk_bf16_f32 v158, v60, v61
    v_cvt_pk_bf16_f32 v159, v62, v63
    v_mfma_f32_32x32x16_bf16 v[32:47], v[80:83], v[224:227], v[32:47]
    ds_read_b64_tr_b16 v[122:123], v24 offset:28672
    ds_read_b64_tr_b16 v[124:125], v25 offset:24576
    s_waitcnt lgkmcnt(12)
    ds_read_b64_tr_b16 v[126:127], v25 offset:28672
    v_permlane32_swap_b32 v152, v154
    v_permlane32_swap_b32 v153, v155
    v_mfma_f32_32x32x16_bf16 v[32:47], v[84:87], v[228:231], v[32:47]
    v_permlane32_swap_b32 v156, v158
    v_permlane32_swap_b32 v157, v159
    buffer_store_dwordx4 v[152:155], v1, s[28:31], s64 offen offset:1024 sc1
    v_mfma_f32_32x32x16_bf16 v[32:47], v[88:91], v[232:235], v[32:47]
    v_mfma_f32_32x32x16_bf16 v[32:47], v[92:95], v[236:239], v[32:47]
    s_waitcnt lgkmcnt(0)
    s_waitcnt vmcnt(12)
    s_barrier
    v_add_u32 v24, 0x10000, v24
    v_add_u32 v25, 0x10000, v25
    v_mfma_f32_32x32x16_bf16 v[32:47], v[96:99], v[240:243], v[32:47]
    ds_read_b64_tr_b16 v[64:65], v24 offset:0
    ds_read_b64_tr_b16 v[66:67], v24 offset:4096
    ds_read_b64_tr_b16 v[68:69], v25 offset:0
    ds_read_b64_tr_b16 v[70:71], v25 offset:4096
    buffer_store_dwordx4 v[156:159], v1, s[28:31], s64 offen offset:1152 sc1
    s_mov_b64 s[88:89], s[56:57]
    s_mov_b32 s90, 1179648
    s_mov_b32 s91, 0x20000
    v_mfma_f32_32x32x16_bf16 v[32:47], v[100:103], v[244:247], v[32:47]
    ds_read_b64_tr_b16 v[72:73], v24 offset:8192
    ds_read_b64_tr_b16 v[74:75], v24 offset:12288
    ds_read_b64_tr_b16 v[76:77], v25 offset:8192
    s_mul_i32 s81, s70, 1179648
    s_sub_u32 s3, 7, s4
    s_lshl_b32 s3, s3, 6
    v_add_u32 v4, s3, v0
    v_mfma_f32_32x32x16_bf16 v[32:47], v[104:107], v[248:251], v[32:47]
    ds_read_b64_tr_b16 v[78:79], v25 offset:12288
    ds_read_b64_tr_b16 v[80:81], v24 offset:16384
    ds_read_b64_tr_b16 v[82:83], v24 offset:20480
    v_cmp_gt_u32 vcc, 288, v4
    s_mul_i32 s3, s67, 288
    v_add_u32 v4, s3, v4
    v_lshlrev_b32 v5, 4, v4
    v_mfma_f32_32x32x16_bf16 v[32:47], v[108:111], v[252:255], v[32:47]
    ds_read_b64_tr_b16 v[84:85], v25 offset:16384
    ds_read_b64_tr_b16 v[86:87], v25 offset:20480
    ds_read_b64_tr_b16 v[88:89], v24 offset:24576
    v_mov_b32 v7, 0x40000000
    v_cndmask_b32 v5, v7, v5, vcc
    s_mul_i32 s83, s68, 147456
    s_mul_i32 s3, s7, 1152
    v_mfma_f32_32x32x16_bf16 v[32:47], v[112:115], v[128:131], v[32:47]
    ds_read_b64_tr_b16 v[90:91], v24 offset:28672
    ds_read_b64_tr_b16 v[92:93], v25 offset:24576
    s_waitcnt lgkmcnt(12)
    ds_read_b64_tr_b16 v[94:95], v25 offset:28672
    s_add_u32 s83, s83, s3
    v_lshrrev_b32 v6, 4, v0
    v_and_b32 v11, 15, v0
    v_lshl_or_b32 v4, v11, 2, v6
    v_mfma_f32_32x32x16_bf16 v[32:47], v[116:119], v[132:135], v[32:47]
    v_lshlrev_b32 v4, 2, v4
    v_mul_u32_u24 v6, 2304, v6
    s_sub_u32 s3, 7, s4
    s_lshl_b32 s3, s3, 4
    v_add_u32 v11, s3, v11
    v_mfma_f32_32x32x16_bf16 v[32:47], v[120:123], v[136:139], v[32:47]
    v_mfma_f32_32x32x16_bf16 v[32:47], v[124:127], v[140:143], v[32:47]
    s_waitcnt lgkmcnt(0)
    s_waitcnt vmcnt(8)
    s_barrier
    v_add_u32 v24, 0xffff8000, v24
    v_add_u32 v25, 0xffff8000, v25
    v_mfma_f32_32x32x16_bf16 v[48:63], v[64:67], v[208:211], 0
    ds_read_b64_tr_b16 v[96:97], v24 offset:0
    ds_read_b64_tr_b16 v[98:99], v24 offset:4096
    ds_read_b64_tr_b16 v[100:101], v25 offset:0
    ds_read_b64_tr_b16 v[102:103], v25 offset:4096
    s_nop 1
    v_cvt_pk_bf16_f32 v160, v32, v33
    v_cvt_pk_bf16_f32 v161, v34, v35
    v_mfma_f32_32x32x16_bf16 v[48:63], v[68:71], v[212:215], v[48:63]
    ds_read_b64_tr_b16 v[104:105], v24 offset:8192
    ds_read_b64_tr_b16 v[106:107], v24 offset:12288
    ds_read_b64_tr_b16 v[108:109], v25 offset:8192
    v_cvt_pk_bf16_f32 v162, v36, v37
    v_cvt_pk_bf16_f32 v163, v38, v39
    v_cvt_pk_bf16_f32 v164, v40, v41
    v_mfma_f32_32x32x16_bf16 v[48:63], v[72:75], v[216:219], v[48:63]
    ds_read_b64_tr_b16 v[110:111], v25 offset:12288
    ds_read_b64_tr_b16 v[112:113], v24 offset:16384
    ds_read_b64_tr_b16 v[114:115], v24 offset:20480
    v_cvt_pk_bf16_f32 v165, v42, v43
    v_cvt_pk_bf16_f32 v166, v44, v45
    v_cvt_pk_bf16_f32 v167, v46, v47
    v_mfma_f32_32x32x16_bf16 v[48:63], v[76:79], v[220:223], v[48:63]
    ds_read_b64_tr_b16 v[116:117], v25 offset:16384
    ds_read_b64_tr_b16 v[118:119], v25 offset:20480
    ds_read_b64_tr_b16 v[120:121], v24 offset:24576
    v_permlane32_swap_b32 v160, v162
    v_permlane32_swap_b32 v161, v163
    v_permlane32_swap_b32 v164, v166
    v_mfma_f32_32x32x16_bf16 v[48:63], v[80:83], v[224:227], v[48:63]
    ds_read_b64_tr_b16 v[122:123], v24 offset:28672
    ds_read_b64_tr_b16 v[124:125], v25 offset:24576
    s_waitcnt lgkmcnt(12)
    ds_read_b64_tr_b16 v[126:127], v25 offset:28672
    v_permlane32_swap_b32 v165, v167
    buffer_store_dwordx4 v[160:163], v1, s[28:31], s64 offen offset:2048 sc1
    v_mov_b32 v15, 65536
    v_mfma_f32_32x32x16_bf16 v[48:63], v[84:87], v[228:231], v[48:63]
    v_mov_b32 v14, 0
    ds_write_b32 v15, v14
    ds_write_b32 v15, v14 offset:4
    v_mfma_f32_32x32x16_bf16 v[48:63], v[88:91], v[232:235], v[48:63]
    v_mfma_f32_32x32x16_bf16 v[48:63], v[92:95], v[236:239], v[48:63]
    s_waitcnt lgkmcnt(0)
    s_waitcnt vmcnt(4)
    s_barrier
    v_add_u32 v24, 0x10000, v24
    v_add_u32 v25, 0x10000, v25
    v_mfma_f32_32x32x16_bf16 v[48:63], v[96:99], v[240:243], v[48:63]
    ds_read_b64_tr_b16 v[64:65], v24 offset:0
    ds_read_b64_tr_b16 v[66:67], v24 offset:4096
    ds_read_b64_tr_b16 v[68:69], v25 offset:0
    ds_read_b64_tr_b16 v[70:71], v25 offset:4096
    v_mov_b32 v12, 0
    buffer_atomic_add v12, v29, s[28:31], s71 offen sc0 sc1
    buffer_store_dwordx4 v[164:167], v1, s[28:31], s64 offen offset:2176 sc1
    v_xor_b32 v30, 128, v24
    v_mfma_f32_32x32x16_bf16 v[48:63], v[100:103], v[244:247], v[48:63]
    ds_read_b64_tr_b16 v[72:73], v24 offset:8192
    ds_read_b64_tr_b16 v[74:75], v24 offset:12288
    ds_read_b64_tr_b16 v[76:77], v25 offset:8192
    v_xor_b32 v31, 128, v25
    v_cmp_gt_u32 vcc, 72, v11
    v_lshl_add_u32 v6, v11, 4, v6
    v_mfma_f32_32x32x16_bf16 v[48:63], v[104:107], v[248:251], v[48:63]
    ds_read_b64_tr_b16 v[78:79], v25 offset:12288
    ds_read_b64_tr_b16 v[80:81], v24 offset:16384
    ds_read_b64_tr_b16 v[82:83], v24 offset:20480
    s_mul_i32 s3, s67, 9216
    s_add_u32 s83, s83, s3
    v_mfma_f32_32x32x16_bf16 v[48:63], v[108:111], v[252:255], v[48:63]
    ds_read_b64_tr_b16 v[84:85], v25 offset:16384
    ds_read_b64_tr_b16 v[86:87], v25 offset:20480
    ds_read_b64_tr_b16 v[88:89], v24 offset:24576
    v_cndmask_b32 v6, v7, v6, vcc
    v_cmp_gt_u32 vcc, 16, v0
    v_lshlrev_b32 v11, 8, v0
    v_mfma_f32_32x32x16_bf16 v[48:63], v[112:115], v[128:131], v[48:63]
    ds_read_b64_tr_b16 v[90:91], v24 offset:28672
    ds_read_b64_tr_b16 v[92:93], v25 offset:24576
    s_waitcnt lgkmcnt(12)
    ds_read_b64_tr_b16 v[94:95], v25 offset:28672
    s_lshl_b32 s3, 1, s67
    v_mov_b32 v13, s3
    v_mfma_f32_32x32x16_bf16 v[48:63], v[116:119], v[132:135], v[48:63]
    v_cndmask_b32 v11, v7, v11, vcc
    v_readfirstlane_b32 s76, v28
    v_mov_b32 v14, 1
    v_mfma_f32_32x32x16_bf16 v[48:63], v[120:123], v[136:139], v[48:63]
    v_mfma_f32_32x32x16_bf16 v[48:63], v[124:127], v[140:143], v[48:63]
    s_waitcnt lgkmcnt(0)
    s_cmp_ge_u32 s4, 4
    s_cbranch_scc1 L_hiB
    v_mfma_f32_32x32x16_bf16 v[32:47], v[64:67], v[208:211], 0
    ds_read_b64_tr_b16 v[176:177], v30 offset:0
    ds_read_b64_tr_b16 v[178:179], v30 offset:4096
    ds_read_b64_tr_b16 v[180:181], v31 offset:0
    ds_read_b64_tr_b16 v[182:183], v31 offset:4096
    s_nop 3
    v_cvt_pk_bf16_f32 v168, v48, v49
    v_mfma_f32_32x32x16_bf16 v[32:47], v[68:71], v[212:215], v[32:47]
    ds_read_b64_tr_b16 v[184:185], v30 offset:8192
    ds_read_b64_tr_b16 v[186:187], v30 offset:12288
    ds_read_b64_tr_b16 v[188:189], v31 offset:8192
    ds_read_b64_tr_b16 v[190:191], v31 offset:12288
    v_cvt_pk_bf16_f32 v169, v50, v51
    v_cvt_pk_bf16_f32 v170, v52, v53
    v_mfma_f32_32x32x16_bf16 v[32:47], v[72:75], v[216:219], v[32:47]
    ds_read_b64_tr_b16 v[192:193], v30 offset:16384
    ds_read_b64_tr_b16 v[194:195], v30 offset:20480
    ds_read_b64_tr_b16 v[196:197], v31 offset:16384
    ds_read_b64_tr_b16 v[198:199], v31 offset:20480
    v_cvt_pk_bf16_f32 v171, v54, v55
    v_mfma_f32_32x32x16_bf16 v[32:47], v[76:79], v[220:223], v[32:47]
    ds_read_b64_tr_b16 v[200:201], v30 offset:24576
    ds_read_b64_tr_b16 v[202:203], v30 offset:28672
    ds_read_b64_tr_b16 v[204:205], v31 offset:24576
    s_waitcnt lgkmcnt(12)
    ds_read_b64_tr_b16 v[206:207], v31 offset:28672
    v_cvt_pk_bf16_f32 v172, v56, v57
    v_cvt_pk_bf16_f32 v173, v58, v59
    v_mfma_f32_32x32x16_bf16 v[32:47], v[80:83], v[224:227], v[32:47]
    v_cvt_pk_bf16_f32 v174, v60, v61
    v_mfma_f32_32x32x16_bf16 v[32:47], v[84:87], v[228:231], v[32:47]
    v_cvt_pk_bf16_f32 v175, v62, v63
    v_permlane32_swap_b32 v168, v170
    v_mfma_f32_32x32x16_bf16 v[32:47], v[88:91], v[232:235], v[32:47]
    v_permlane32_swap_b32 v169, v171
    v_mfma_f32_32x32x16_bf16 v[32:47], v[92:95], v[236:239], v[32:47]
    v_permlane32_swap_b32 v172, v174
    v_permlane32_swap_b32 v173, v175
    s_waitcnt lgkmcnt(0)
    v_mfma_f32_32x32x16_bf16 v[32:47], v[176:179], v[240:243], v[32:47]
    v_mfma_f32_32x32x16_bf16 v[32:47], v[180:183], v[244:247], v[32:47]
    v_mfma_f32_32x32x16_bf16 v[32:47], v[184:187], v[248:251], v[32:47]
    buffer_store_dwordx4 v[168:171], v1, s[28:31], s64 offen offset:3072 sc1
    v_mfma_f32_32x32x16_bf16 v[32:47], v[188:191], v[252:255], v[32:47]
    v_mfma_f32_32x32x16_bf16 v[32:47], v[192:195], v[128:131], v[32:47]
    v_mfma_f32_32x32x16_bf16 v[32:47], v[196:199], v[132:135], v[32:47]
    buffer_store_dwordx4 v[172:175], v1, s[28:31], s64 offen offset:3200 sc1
    v_mfma_f32_32x32x16_bf16 v[32:47], v[200:203], v[136:139], v[32:47]
    v_mfma_f32_32x32x16_bf16 v[32:47], v[204:207], v[140:143], v[32:47]
    s_nop 11
    v_cvt_pk_bf16_f32 v16, v32, v33
    v_cvt_pk_bf16_f32 v17, v34, v35
    v_cvt_pk_bf16_f32 v18, v36, v37
    v_cvt_pk_bf16_f32 v19, v38, v39
    v_cvt_pk_bf16_f32 v20, v40, v41
    v_cvt_pk_bf16_f32 v21, v42, v43
    v_cvt_pk_bf16_f32 v22, v44, v45
    v_cvt_pk_bf16_f32 v23, v46, v47
    v_permlane32_swap_b32 v16, v18
    v_permlane32_swap_b32 v17, v19
    v_permlane32_swap_b32 v20, v22
    v_permlane32_swap_b32 v21, v23
    s_add_u32 s66, s64, 4096
    buffer_store_dwordx4 v[16:19], v1, s[28:31], s66 offen offset:0 sc1
    s_add_u32 s66, s64, 4096
    buffer_store_dwordx4 v[20:23], v1, s[28:31], s66 offen offset:128 sc1
    s_branch L_joinB
L_hiB:
    s_nop 11
    v_cvt_pk_bf16_f32 v168, v48, v49
    v_cvt_pk_bf16_f32 v169, v50, v51
    v_cvt_pk_bf16_f32 v170, v52, v53
    v_cvt_pk_bf16_f32 v171, v54, v55
    v_cvt_pk_bf16_f32 v172, v56, v57
    v_cvt_pk_bf16_f32 v173, v58, v59
    v_cvt_pk_bf16_f32 v174, v60, v61
    v_cvt_pk_bf16_f32 v175, v62, v63
    v_permlane32_swap_b32 v168, v170
    v_permlane32_swap_b32 v169, v171
    v_permlane32_swap_b32 v172, v174
    v_permlane32_swap_b32 v173, v175
    buffer_store_dwordx4 v[168:171], v1, s[28:31], s64 offen offset:3072 sc1
    buffer_store_dwordx4 v[172:175], v1, s[28:31], s64 offen offset:3200 sc1
L_joinB:
    s_mov_b32 s72, 0x800000
    s_waitcnt vmcnt(0)
    s_mov_b64 exec, 1
    ds_add_rtn_u32 v14, v15, v14
    s_mov_b64 exec, -1
    v_mov_b32 v64, 0
    v_mov_b32 v65, 0
    v_mov_b32 v66, 0
    v_mov_b32 v67, 0
    v_mov_b32 v68, 0
    v_mov_b32 v69, 0
    v_mov_b32 v70, 0
    v_mov_b32 v71, 0
    s_waitcnt lgkmcnt(0)
    v_readfirstlane_b32 s3, v14
    s_nop 1
    s_cmp_eq_u32 s3, 7
    s_cbranch_scc0 L_nosigB
L_chkB:
    v_readfirstlane_b32 s3, v8
    s_nop 1
    s_cmp_ge_u32 s3, 16
    s_cbranch_scc1 L_okB
    s_sleep 16
    buffer_load_dword v8, off, s[84:87], s82 sc1
    s_waitcnt vmcnt(0)
    s_sub_u32 s72, s72, 16
    s_cmp_lg_u32 s72, 0
    s_cbranch_scc1 L_chkB
    s_mov_b32 s72, 1
L_okB:
    buffer_atomic_add v13, v11, s[28:31], s73 offen sc1
    s_mov_b64 exec, 1
    ds_or_b32 v15, v13 offset:4
    s_mov_b64 exec, -1
L_nosigB:
    s_cmp_ge_u32 s4, 3
    s_cbranch_scc1 L_workB
    s_cmp_eq_u32 s4, 0
    s_cbranch_scc0 L_doneB
    s_mov_b64 exec, 1
    v_mov_b32 v64, 0
    buffer_atomic_add v64, v29, s[28:31], s71 offen sc0 sc1
    s_sleep 2
    v_mov_b32 v65, 0
    buffer_atomic_add v65, v29, s[28:31], s71 offen sc0 sc1
    s_sleep 2
L_ploopB:
    v_mov_b32 v66, 0
    buffer_atomic_add v66, v29, s[28:31], s71 offen sc0 sc1
    s_waitcnt vmcnt(2)
    v_readfirstlane_b32 s3, v64
    s_nop 1
    s_sub_u32 s3, s3, s76
    v_mov_b32 v13, s3
    ds_or_b32 v15, v13 offset:4
    s_cmp_eq_u32 s3, 0xffff
    s_cbranch_scc1 L_doneB
    v_mov_b32 v64, 0
    buffer_atomic_add v64, v29, s[28:31], s71 offen sc0 sc1
    s_waitcnt vmcnt(2)
    v_readfirstlane_b32 s3, v65
    s_nop 1
    s_sub_u32 s3, s3, s76
    v_mov_b32 v13, s3
    ds_or_b32 v15, v13 offset:4
    s_cmp_eq_u32 s3, 0xffff
    s_cbranch_scc1 L_doneB
    v_mov_b32 v65, 0
    buffer_atomic_add v65, v29, s[28:31], s71 offen sc0 sc1
    s_waitcnt vmcnt(2)
    v_readfirstlane_b32 s3, v66
    s_nop 1
    s_sub_u32 s3, s3, s76
    v_mov_b32 v13, s3
    ds_or_b32 v15, v13 offset:4
    s_cmp_eq_u32 s3, 0xffff
    s_cbranch_scc1 L_doneB
    s_sub_u32 s72, s72, 16
    s_cmp_gt_i32 s72, 0
    s_cbranch_scc1 L_ploopB
    s_branch L_doneB
L_workB:
    s_mov_b32 s74, 0xffff
    s_mov_b32 s80, 0
    s_mov_b32 s77, 0
    v_readfirstlane_b32 s3, v12
    s_nop 1
    s_sub_u32 s75, s3, s76
L_loopB:
    s_and_b32 s75, s75, s74
    s_cbranch_scc0 L_noldB
    s_cmp_eq_u32 s75, s74
    s_cbranch_scc1 all_2
    s_cmp_eq_u32 s77, s80
    s_cbranch_scc0 L_noldB
    s_mov_b32 s3, s75
    s_sub_u32 s65, s3, 1
    s_and_b32 s3, s3, s65
    s_sub_u32 s65, s3, 1
    s_and_b32 s3, s3, s65
    s_sub_u32 s65, s3, 1
    s_and_b32 s3, s3, s65
    s_xor_b32 s75, s75, s3
all_2:
    s_andn2_b32 s74, s74, s75
    s_cmp_ge_u32 s80, 8
    s_cbranch_scc1 t_19
    s_cmp_ge_u32 s80, 4
    s_cbranch_scc1 t_20
    s_cmp_ge_u32 s80, 2
    s_cbranch_scc1 t_21
    s_cmp_ge_u32 s80, 1
    s_cbranch_scc1 ld_4
    s_branch ld_3
t_21:
    s_cmp_ge_u32 s80, 3
    s_cbranch_scc1 ld_6
    s_branch ld_5
t_20:
    s_cmp_ge_u32 s80, 6
    s_cbranch_scc1 t_22
    s_cmp_ge_u32 s80, 5
    s_cbranch_scc1 ld_8
    s_branch ld_7
t_22:
    s_cmp_ge_u32 s80, 7
    s_cbranch_scc1 ld_10
    s_branch ld_9
t_19:
    s_cmp_ge_u32 s80, 12
    s_cbranch_scc1 t_23
    s_cmp_ge_u32 s80, 10
    s_cbranch_scc1 t_24
    s_cmp_ge_u32 s80, 9
    s_cbranch_scc1 ld_12
    s_branch ld_11
t_24:
    s_cmp_ge_u32 s80, 11
    s_cbranch_scc1 ld_14
    s_branch ld_13
t_23:
    s_cmp_ge_u32 s80, 14
    s_cbranch_scc1 t_25
    s_cmp_ge_u32 s80, 13
    s_cbranch_scc1 ld_16
    s_branch ld_15
t_25:
    s_cmp_ge_u32 s80, 15
    s_cbranch_scc1 ld_18
    s_branch ld_17
ld_3:
    s_ff1_i32_b32 s3, s75
    s_bitset0_b32 s75, s3
    s_mul_i32 s3, s3, 73728
    s_add_u32 s3, s3, s81
    buffer_load_dwordx4 v[192:195], v5, s[28:31], s3 offen sc1
    s_mov_b32 s80, 1
    s_cmp_eq_u32 s75, 0
    s_cbranch_scc1 L_noldB
ld_4:
    s_ff1_i32_b32 s3, s75
    s_bitset0_b32 s75, s3
    s_mul_i32 s3, s3, 73728
    s_add_u32 s3, s3, s81
    buffer_load_dwordx4 v[196:199], v5, s[28:31], s3 offen sc1
    s_mov_b32 s80, 2
    s_cmp_eq_u32 s75, 0
    s_cbranch_scc1 L_noldB
ld_5:
    s_ff1_i32_b32 s3, s75
    s_bitset0_b32 s75, s3
    s_mul_i32 s3, s3, 73728
    s_add_u32 s3, s3, s81
    buffer_load_dwordx4 v[200:203], v5, s[28:31], s3 offen sc1
    s_mov_b32 s80, 3
    s_cmp_eq_u32 s75, 0
    s_cbranch_scc1 L_noldB
ld_6:
    s_ff1_i32_b32 s3, s75
    s_bitset0_b32 s75, s3
    s_mul_i32 s3, s3, 73728
    s_add_u32 s3, s3, s81
    buffer_load_dwordx4 v[204:207], v5, s[28:31], s3 offen sc1
    s_mov_b32 s80, 4
    s_cmp_eq_u32 s75, 0
    s_cbranch_scc1 L_noldB
ld_7:
    s_ff1_i32_b32 s3, s75
    s_bitset0_b32 s75, s3
    s_mul_i32 s3, s3, 73728
    s_add_u32 s3, s3, s81
    buffer_load_dwordx4 v[208:211], v5, s[28:31], s3 offen sc1
    s_mov_b32 s80, 5
    s_cmp_eq_u32 s75, 0
    s_cbranch_scc1 L_noldB
ld_8:
    s_ff1_i32_b32 s3, s75
    s_bitset0_b32 s75, s3
    s_mul_i32 s3, s3, 73728
    s_add_u32 s3, s3, s81
    buffer_load_dwordx4 v[212:215], v5, s[28:31], s3 offen sc1
    s_mov_b32 s80, 6
    s_cmp_eq_u32 s75, 0
    s_cbranch_scc1 L_noldB
ld_9:
    s_ff1_i32_b32 s3, s75
    s_bitset0_b32 s75, s3
    s_mul_i32 s3, s3, 73728
    s_add_u32 s3, s3, s81
    buffer_load_dwordx4 v[216:219], v5, s[28:31], s3 offen sc1
    s_mov_b32 s80, 7
    s_cmp_eq_u32 s75, 0
    s_cbranch_scc1 L_noldB
ld_10:
    s_ff1_i32_b32 s3, s75
    s_bitset0_b32 s75, s3
    s_mul_i32 s3, s3, 73728
    s_add_u32 s3, s3, s81
    buffer_load_dwordx4 v[220:223], v5, s[28:31], s3 offen sc1
    s_mov_b32 s80, 8
    s_cmp_eq_u32 s75, 0
    s_cbranch_scc1 L_noldB
ld_11:
    s_ff1_i32_b32 s3, s75
    s_bitset0_b32 s75, s3
    s_mul_i32 s3, s3, 73728
    s_add_u32 s3, s3, s81
    buffer_load_dwordx4 v[224:227], v5, s[28:31], s3 offen sc1
    s_mov_b32 s80, 9
    s_cmp_eq_u32 s75, 0
    s_cbranch_scc1 L_noldB
ld_12:
    s_ff1_i32_b32 s3, s75
    s_bitset0_b32 s75, s3
    s_mul_i32 s3, s3, 73728
    s_add_u32 s3, s3, s81
    buffer_load_dwordx4 v[228:231], v5, s[28:31], s3 offen sc1
    s_mov_b32 s80, 10
    s_cmp_eq_u32 s75, 0
    s_cbranch_scc1 L_noldB
ld_13:
    s_ff1_i32_b32 s3, s75
    s_bitset0_b32 s75, s3
    s_mul_i32 s3, s3, 73728
    s_add_u32 s3, s3, s81
    buffer_load_dwordx4 v[232:235], v5, s[28:31], s3 offen sc1
    s_mov_b32 s80, 11
    s_cmp_eq_u32 s75, 0
    s_cbranch_scc1 L_noldB
ld_14:
    s_ff1_i32_b32 s3, s75
    s_bitset0_b32 s75, s3
    s_mul_i32 s3, s3, 73728
    s_add_u32 s3, s3, s81
    buffer_load_dwordx4 v[236:239], v5, s[28:31], s3 offen sc1
    s_mov_b32 s80, 12
    s_cmp_eq_u32 s75, 0
    s_cbranch_scc1 L_noldB
ld_15:
    s_ff1_i32_b32 s3, s75
    s_bitset0_b32 s75, s3
    s_mul_i32 s3, s3, 73728
    s_add_u32 s3, s3, s81
    buffer_load_dwordx4 v[240:243], v5, s[28:31], s3 offen sc1
    s_mov_b32 s80, 13
    s_cmp_eq_u32 s75, 0
    s_cbranch_scc1 L_noldB
ld_16:
    s_ff1_i32_b32 s3, s75
    s_bitset0_b32 s75, s3
    s_mul_i32 s3, s3, 73728
    s_add_u32 s3, s3, s81
    buffer_load_dwordx4 v[244:247], v5, s[28:31], s3 offen sc1
    s_mov_b32 s80, 14
    s_cmp_eq_u32 s75, 0
    s_cbranch_scc1 L_noldB
ld_17:
    s_ff1_i32_b32 s3, s75
    s_bitset0_b32 s75, s3
    s_mul_i32 s3, s3, 73728
    s_add_u32 s3, s3, s81
    buffer_load_dwordx4 v[248:251], v5, s[28:31], s3 offen sc1
    s_mov_b32 s80, 15
    s_cmp_eq_u32 s75, 0
    s_cbranch_scc1 L_noldB
ld_18:
    s_ff1_i32_b32 s3, s75
    s_bitset0_b32 s75, s3
    s_mul_i32 s3, s3, 73728
    s_add_u32 s3, s3, s81
    buffer_load_dwordx4 v[252:255], v5, s[28:31], s3 offen sc1
    s_mov_b32 s80, 16
    s_branch L_ldoutB
L_noldB:
    ds_read_b32 v14, v15 offset:4
    s_sub_u32 s72, s72, 1
    s_cmp_gt_i32 s72, 0
    s_cbranch_scc0 L_finB
    s_getreg_b32 s3, hwreg(HW_REG_IB_STS)
    s_and_b32 s3, s3, 0xc0000f
    s_cselect_b32 s3, s80, s77
    s_waitcnt lgkmcnt(0)
    v_readfirstlane_b32 s75, v14
    s_cmp_eq_u32 s3, s80
    s_cbranch_scc1 L_loopB
    s_and_b32 s3, s75, s74
    s_cmp_eq_u32 s3, s74
    s_cbranch_scc1 L_loopB
    s_waitcnt vmcnt(0)
L_ldoutB:
    s_cmp_ge_u32 s77, 8
    s_cbranch_scc1 t_42
    s_cmp_ge_u32 s77, 4
    s_cbranch_scc1 t_43
    s_cmp_ge_u32 s77, 2
    s_cbranch_scc1 t_44
    s_cmp_ge_u32 s77, 1
    s_cbranch_scc1 ac_27
    s_branch ac_26
t_44:
    s_cmp_ge_u32 s77, 3
    s_cbranch_scc1 ac_29
    s_branch ac_28
t_43:
    s_cmp_ge_u32 s77, 6
    s_cbranch_scc1 t_45
    s_cmp_ge_u32 s77, 5
    s_cbranch_scc1 ac_31
    s_branch ac_30
t_45:
    s_cmp_ge_u32 s77, 7
    s_cbranch_scc1 ac_33
    s_branch ac_32
t_42:
    s_cmp_ge_u32 s77, 12
    s_cbranch_scc1 t_46
    s_cmp_ge_u32 s77, 10
    s_cbranch_scc1 t_47
    s_cmp_ge_u32 s77, 9
    s_cbranch_scc1 ac_35
    s_branch ac_34
t_47:
    s_cmp_ge_u32 s77, 11
    s_cbranch_scc1 ac_37
    s_branch ac_36
t_46:
    s_cmp_ge_u32 s77, 14
    s_cbranch_scc1 t_48
    s_cmp_ge_u32 s77, 13
    s_cbranch_scc1 ac_39
    s_branch ac_38
t_48:
    s_cmp_ge_u32 s77, 15
    s_cbranch_scc1 ac_41
    s_branch ac_40
ac_26:
    s_waitcnt vmcnt(15)
    v_lshlrev_b32 v72, 16, v192
    v_and_b32 v73, 0xffff0000, v192
    v_lshlrev_b32 v74, 16, v193
    v_and_b32 v75, 0xffff0000, v193
    v_lshlrev_b32 v76, 16, v194
    v_and_b32 v77, 0xffff0000, v194
    v_lshlrev_b32 v78, 16, v195
    v_and_b32 v79, 0xffff0000, v195
    v_pk_add_f32 v[64:65], v[64:65], v[72:73]
    v_pk_add_f32 v[66:67], v[66:67], v[74:75]
    v_pk_add_f32 v[68:69], v[68:69], v[76:77]
    v_pk_add_f32 v[70:71], v[70:71], v[78:79]
    s_cmp_eq_u32 s80, 1
    s_cbranch_scc1 L_acoutB
ac_27:
    s_waitcnt vmcnt(14)
    v_lshlrev_b32 v72, 16, v196
    v_and_b32 v73, 0xffff0000, v196
    v_lshlrev_b32 v74, 16, v197
    v_and_b32 v75, 0xffff0000, v197
    v_lshlrev_b32 v76, 16, v198
    v_and_b32 v77, 0xffff0000, v198
    v_lshlrev_b32 v78, 16, v199
    v_and_b32 v79, 0xffff0000, v199
    v_pk_add_f32 v[64:65], v[64:65], v[72:73]
    v_pk_add_f32 v[66:67], v[66:67], v[74:75]
    v_pk_add_f32 v[68:69], v[68:69], v[76:77]
    v_pk_add_f32 v[70:71], v[70:71], v[78:79]
    s_cmp_eq_u32 s80, 2
    s_cbranch_scc1 L_acoutB
ac_28:
    s_waitcnt vmcnt(13)
    v_lshlrev_b32 v72, 16, v200
    v_and_b32 v73, 0xffff0000, v200
    v_lshlrev_b32 v74, 16, v201
    v_and_b32 v75, 0xffff0000, v201
    v_lshlrev_b32 v76, 16, v202
    v_and_b32 v77, 0xffff0000, v202
    v_lshlrev_b32 v78, 16, v203
    v_and_b32 v79, 0xffff0000, v203
    v_pk_add_f32 v[64:65], v[64:65], v[72:73]
    v_pk_add_f32 v[66:67], v[66:67], v[74:75]
    v_pk_add_f32 v[68:69], v[68:69], v[76:77]
    v_pk_add_f32 v[70:71], v[70:71], v[78:79]
    s_cmp_eq_u32 s80, 3
    s_cbranch_scc1 L_acoutB
ac_29:
    s_waitcnt vmcnt(12)
    v_lshlrev_b32 v72, 16, v204
    v_and_b32 v73, 0xffff0000, v204
    v_lshlrev_b32 v74, 16, v205
    v_and_b32 v75, 0xffff0000, v205
    v_lshlrev_b32 v76, 16, v206
    v_and_b32 v77, 0xffff0000, v206
    v_lshlrev_b32 v78, 16, v207
    v_and_b32 v79, 0xffff0000, v207
    v_pk_add_f32 v[64:65], v[64:65], v[72:73]
    v_pk_add_f32 v[66:67], v[66:67], v[74:75]
    v_pk_add_f32 v[68:69], v[68:69], v[76:77]
    v_pk_add_f32 v[70:71], v[70:71], v[78:79]
    s_cmp_eq_u32 s80, 4
    s_cbranch_scc1 L_acoutB
ac_30:
    s_waitcnt vmcnt(11)
    v_lshlrev_b32 v72, 16, v208
    v_and_b32 v73, 0xffff0000, v208
    v_lshlrev_b32 v74, 16, v209
    v_and_b32 v75, 0xffff0000, v209
    v_lshlrev_b32 v76, 16, v210
    v_and_b32 v77, 0xffff0000, v210
    v_lshlrev_b32 v78, 16, v211
    v_and_b32 v79, 0xffff0000, v211
    v_pk_add_f32 v[64:65], v[64:65], v[72:73]
    v_pk_add_f32 v[66:67], v[66:67], v[74:75]
    v_pk_add_f32 v[68:69], v[68:69], v[76:77]
    v_pk_add_f32 v[70:71], v[70:71], v[78:79]
    s_cmp_eq_u32 s80, 5
    s_cbranch_scc1 L_acoutB
ac_31:
    s_waitcnt vmcnt(10)
    v_lshlrev_b32 v72, 16, v212
    v_and_b32 v73, 0xffff0000, v212
    v_lshlrev_b32 v74, 16, v213
    v_and_b32 v75, 0xffff0000, v213
    v_lshlrev_b32 v76, 16, v214
    v_and_b32 v77, 0xffff0000, v214
    v_lshlrev_b32 v78, 16, v215
    v_and_b32 v79, 0xffff0000, v215
    v_pk_add_f32 v[64:65], v[64:65], v[72:73]
    v_pk_add_f32 v[66:67], v[66:67], v[74:75]
    v_pk_add_f32 v[68:69], v[68:69], v[76:77]
    v_pk_add_f32 v[70:71], v[70:71], v[78:79]
    s_cmp_eq_u32 s80, 6
    s_cbranch_scc1 L_acoutB
ac_32:
    s_waitcnt vmcnt(9)
    v_lshlrev_b32 v72, 16, v216
    v_and_b32 v73, 0xffff0000, v216
    v_lshlrev_b32 v74, 16, v217
    v_and_b32 v75, 0xffff0000, v217
    v_lshlrev_b32 v76, 16, v218
    v_and_b32 v77, 0xffff0000, v218
    v_lshlrev_b32 v78, 16, v219
    v_and_b32 v79, 0xffff0000, v219
    v_pk_add_f32 v[64:65], v[64:65], v[72:73]
    v_pk_add_f32 v[66:67], v[66:67], v[74:75]
    v_pk_add_f32 v[68:69], v[68:69], v[76:77]
    v_pk_add_f32 v[70:71], v[70:71], v[78:79]
    s_cmp_eq_u32 s80, 7
    s_cbranch_scc1 L_acoutB
ac_33:
    s_waitcnt vmcnt(8)
    v_lshlrev_b32 v72, 16, v220
    v_and_b32 v73, 0xffff0000, v220
    v_lshlrev_b32 v74, 16, v221
    v_and_b32 v75, 0xffff0000, v221
    v_lshlrev_b32 v76, 16, v222
    v_and_b32 v77, 0xffff0000, v222
    v_lshlrev_b32 v78, 16, v223
    v_and_b32 v79, 0xffff0000, v223
    v_pk_add_f32 v[64:65], v[64:65], v[72:73]
    v_pk_add_f32 v[66:67], v[66:67], v[74:75]
    v_pk_add_f32 v[68:69], v[68:69], v[76:77]
    v_pk_add_f32 v[70:71], v[70:71], v[78:79]
    s_cmp_eq_u32 s80, 8
    s_cbranch_scc1 L_acoutB
ac_34:
    s_waitcnt vmcnt(7)
    v_lshlrev_b32 v72, 16, v224
    v_and_b32 v73, 0xffff0000, v224
    v_lshlrev_b32 v74, 16, v225
    v_and_b32 v75, 0xffff0000, v225
    v_lshlrev_b32 v76, 16, v226
    v_and_b32 v77, 0xffff0000, v226
    v_lshlrev_b32 v78, 16, v227
    v_and_b32 v79, 0xffff0000, v227
    v_pk_add_f32 v[64:65], v[64:65], v[72:73]
    v_pk_add_f32 v[66:67], v[66:67], v[74:75]
    v_pk_add_f32 v[68:69], v[68:69], v[76:77]
    v_pk_add_f32 v[70:71], v[70:71], v[78:79]
    s_cmp_eq_u32 s80, 9
    s_cbranch_scc1 L_acoutB
ac_35:
    s_waitcnt vmcnt(6)
    v_lshlrev_b32 v72, 16, v228
    v_and_b32 v73, 0xffff0000, v228
    v_lshlrev_b32 v74, 16, v229
    v_and_b32 v75, 0xffff0000, v229
    v_lshlrev_b32 v76, 16, v230
    v_and_b32 v77, 0xffff0000, v230
    v_lshlrev_b32 v78, 16, v231
    v_and_b32 v79, 0xffff0000, v231
    v_pk_add_f32 v[64:65], v[64:65], v[72:73]
    v_pk_add_f32 v[66:67], v[66:67], v[74:75]
    v_pk_add_f32 v[68:69], v[68:69], v[76:77]
    v_pk_add_f32 v[70:71], v[70:71], v[78:79]
    s_cmp_eq_u32 s80, 10
    s_cbranch_scc1 L_acoutB
ac_36:
    s_waitcnt vmcnt(5)
    v_lshlrev_b32 v72, 16, v232
    v_and_b32 v73, 0xffff0000, v232
    v_lshlrev_b32 v74, 16, v233
    v_and_b32 v75, 0xffff0000, v233
    v_lshlrev_b32 v76, 16, v234
    v_and_b32 v77, 0xffff0000, v234
    v_lshlrev_b32 v78, 16, v235
    v_and_b32 v79, 0xffff0000, v235
    v_pk_add_f32 v[64:65], v[64:65], v[72:73]
    v_pk_add_f32 v[66:67], v[66:67], v[74:75]
    v_pk_add_f32 v[68:69], v[68:69], v[76:77]
    v_pk_add_f32 v[70:71], v[70:71], v[78:79]
    s_cmp_eq_u32 s80, 11
    s_cbranch_scc1 L_acoutB
ac_37:
    s_waitcnt vmcnt(4)
    v_lshlrev_b32 v72, 16, v236
    v_and_b32 v73, 0xffff0000, v236
    v_lshlrev_b32 v74, 16, v237
    v_and_b32 v75, 0xffff0000, v237
    v_lshlrev_b32 v76, 16, v238
    v_and_b32 v77, 0xffff0000, v238
    v_lshlrev_b32 v78, 16, v239
    v_and_b32 v79, 0xffff0000, v239
    v_pk_add_f32 v[64:65], v[64:65], v[72:73]
    v_pk_add_f32 v[66:67], v[66:67], v[74:75]
    v_pk_add_f32 v[68:69], v[68:69], v[76:77]
    v_pk_add_f32 v[70:71], v[70:71], v[78:79]
    s_cmp_eq_u32 s80, 12
    s_cbranch_scc1 L_acoutB
ac_38:
    s_waitcnt vmcnt(3)
    v_lshlrev_b32 v72, 16, v240
    v_and_b32 v73, 0xffff0000, v240
    v_lshlrev_b32 v74, 16, v241
    v_and_b32 v75, 0xffff0000, v241
    v_lshlrev_b32 v76, 16, v242
    v_and_b32 v77, 0xffff0000, v242
    v_lshlrev_b32 v78, 16, v243
    v_and_b32 v79, 0xffff0000, v243
    v_pk_add_f32 v[64:65], v[64:65], v[72:73]
    v_pk_add_f32 v[66:67], v[66:67], v[74:75]
    v_pk_add_f32 v[68:69], v[68:69], v[76:77]
    v_pk_add_f32 v[70:71], v[70:71], v[78:79]
    s_cmp_eq_u32 s80, 13
    s_cbranch_scc1 L_acoutB
ac_39:
    s_waitcnt vmcnt(2)
    v_lshlrev_b32 v72, 16, v244
    v_and_b32 v73, 0xffff0000, v244
    v_lshlrev_b32 v74, 16, v245
    v_and_b32 v75, 0xffff0000, v245
    v_lshlrev_b32 v76, 16, v246
    v_and_b32 v77, 0xffff0000, v246
    v_lshlrev_b32 v78, 16, v247
    v_and_b32 v79, 0xffff0000, v247
    v_pk_add_f32 v[64:65], v[64:65], v[72:73]
    v_pk_add_f32 v[66:67], v[66:67], v[74:75]
    v_pk_add_f32 v[68:69], v[68:69], v[76:77]
    v_pk_add_f32 v[70:71], v[70:71], v[78:79]
    s_cmp_eq_u32 s80, 14
    s_cbranch_scc1 L_acoutB
ac_40:
    s_waitcnt vmcnt(1)
    v_lshlrev_b32 v72, 16, v248
    v_and_b32 v73, 0xffff0000, v248
    v_lshlrev_b32 v74, 16, v249
    v_and_b32 v75, 0xffff0000, v249
    v_lshlrev_b32 v76, 16, v250
    v_and_b32 v77, 0xffff0000, v250
    v_lshlrev_b32 v78, 16, v251
    v_and_b32 v79, 0xffff0000, v251
    v_pk_add_f32 v[64:65], v[64:65], v[72:73]
    v_pk_add_f32 v[66:67], v[66:67], v[74:75]
    v_pk_add_f32 v[68:69], v[68:69], v[76:77]
    v_pk_add_f32 v[70:71], v[70:71], v[78:79]
    s_cmp_eq_u32 s80, 15
    s_cbranch_scc1 L_acoutB
ac_41:
    s_waitcnt vmcnt(0)
    v_lshlrev_b32 v72, 16, v252
    v_and_b32 v73, 0xffff0000, v252
    v_lshlrev_b32 v74, 16, v253
    v_and_b32 v75, 0xffff0000, v253
    v_lshlrev_b32 v76, 16, v254
    v_and_b32 v77, 0xffff0000, v254
    v_lshlrev_b32 v78, 16, v255
    v_and_b32 v79, 0xffff0000, v255
    v_pk_add_f32 v[64:65], v[64:65], v[72:73]
    v_pk_add_f32 v[66:67], v[66:67], v[74:75]
    v_pk_add_f32 v[68:69], v[68:69], v[76:77]
    v_pk_add_f32 v[70:71], v[70:71], v[78:79]
L_finB:
    v_cvt_pk_bf16_f32 v192, v64, v65
    v_cvt_pk_bf16_f32 v193, v66, v67
    v_cvt_pk_bf16_f32 v194, v68, v69
    v_cvt_pk_bf16_f32 v195, v70, v71
    ds_bpermute_b32 v196, v4, v192
    ds_bpermute_b32 v197, v4, v193
    ds_bpermute_b32 v198, v4, v194
    ds_bpermute_b32 v199, v4, v195
    s_waitcnt lgkmcnt(0)
    buffer_store_dwordx4 v[196:199], v6, s[88:91], s83 offen
    s_branch L_doneB
L_acoutB:
    s_mov_b32 s77, s80
    s_branch L_noldB
L_doneB:
    s_endpgm
.p2align 6
L_branchA:
    s_nop 4
    s_barrier
    s_mov_b32 s65, s81
    buffer_load_dword v13, v9, s[8:11], s65 offen
    s_barrier
    s_add_u32 m0, s62, 0
    s_add_u32 s65, s34, 0
    buffer_load_dwordx4 v4, s[12:15], s65 offen nt lds
    buffer_load_dwordx4 v5, s[12:15], s65 offen offset:1024 nt lds
    s_add_u32 m0, s62, 16384
    s_add_u32 s65, s34, 16384
    buffer_load_dwordx4 v4, s[12:15], s65 offen nt lds
    buffer_load_dwordx4 v5, s[12:15], s65 offen offset:1024 nt lds
    s_add_u32 m0, s62, 32768
    s_add_u32 s65, s34, 32768
    buffer_load_dwordx4 v4, s[12:15], s65 offen nt lds
    buffer_load_dwordx4 v5, s[12:15], s65 offen offset:1024 nt lds
    s_add_u32 m0, s62, 49152
    s_add_u32 s65, s34, 49152
    buffer_load_dwordx4 v4, s[12:15], s65 offen nt lds
    buffer_load_dwordx4 v5, s[12:15], s65 offen offset:1024 nt lds
    s_add_u32 m0, s62, 65536
    s_add_u32 s65, s34, 65536
    buffer_load_dwordx4 v4, s[12:15], s65 offen nt lds
    buffer_load_dwordx4 v5, s[12:15], s65 offen offset:1024 nt lds
    s_add_u32 m0, s62, 81920
    s_add_u32 s65, s34, 81920
    buffer_load_dwordx4 v4, s[12:15], s65 offen nt lds
    buffer_load_dwordx4 v5, s[12:15], s65 offen offset:1024 nt lds
    s_barrier
    s_cmp_lt_u32 s68, 9
    s_cselect_b32 s66, s32, s77
    s_add_u32 m0, s69, 147456
    s_add_u32 s65, s66, 0
    buffer_load_dwordx4 v8, s[8:11], s65 offen lds
    s_cmp_lt_u32 s68, 9
    s_cselect_b32 s66, s33, s76
    s_add_u32 m0, s62, 98304
    s_add_u32 s65, s66, 0
    buffer_load_dwordx4 v6, s[20:23], s65 offen lds
    s_add_u32 m0, s62, 99328
    s_add_u32 s65, s66, 16384
    buffer_load_dwordx4 v7, s[20:23], s65 offen lds
    s_barrier
    s_cmp_lt_u32 s68, 9
    s_cselect_b32 s66, s33, s76
    s_add_u32 m0, s62, 114688
    s_add_u32 s65, s66, 262144
    buffer_load_dwordx4 v6, s[20:23], s65 offen lds
    s_add_u32 m0, s62, 115712
    s_add_u32 s65, s66, 278528
    buffer_load_dwordx4 v7, s[20:23], s65 offen lds
    s_barrier
    s_cmp_lt_u32 s68, 8
    s_cselect_b32 s66, s32, s77
    s_add_u32 m0, s69, 155648
    s_add_u32 s65, s66, 128
    buffer_load_dwordx4 v8, s[8:11], s65 offen lds
    s_cmp_lt_u32 s68, 8
    s_cselect_b32 s66, s33, s76
    s_add_u32 m0, s62, 131072
    s_add_u32 s65, s66, 524288
    buffer_load_dwordx4 v6, s[20:23], s65 offen lds
    s_add_u32 m0, s62, 132096
    s_add_u32 s65, s66, 540672
    buffer_load_dwordx4 v7, s[20:23], s65 offen lds
    s_bfe_u32 s6, s4, 0x10001
    s_lshr_b32 s72, s4, 2
    s_mov_b32 s63, 0x3e0293ee
    s_mov_b32 s18, s14
    s_mov_b32 s26, 4718592
    s_mov_b64 s[28:29], s[60:61]
    s_mov_b32 s30, 0x10000000
    s_mul_i32 s35, s67, 294912
    s_add_u32 s35, s35, s83
    s_lshl_b32 s65, s7, 7
    s_add_u32 s3, s75, s65
    s_mul_i32 s64, s3, 73728
    s_lshl_b32 s65, s72, 9
    s_add_u32 s64, s64, s65
    s_lshl_b32 s65, s5, 8
    s_add_u32 s64, s64, s65
    s_mul_i32 s65, s6, 36864
    s_add_u32 s64, s64, s65
    v_and_b32 v96, 31, v0
    v_lshrrev_b32 v97, 5, v0
    v_bfe_u32 v98, v0, 2, 2
    v_and_b32 v99, 3, v0
    v_bfe_u32 v102, v0, 4, 1
    v_lshlrev_b32 v100, 3, v99
    v_lshl_or_b32 v100, v102, 5, v100
    v_lshl_or_b32 v100, v98, 6, v100
    v_lshl_or_b32 v100, v98, 9, v100
    v_lshl_or_b32 v100, v97, 12, v100
    s_lshl_b32 s3, s72, 8
    s_lshl_b32 s65, s5, 7
    s_add_u32 s3, s3, s65
    v_xor_b32 v100, s3, v100
    v_add_u32 v16, 98304, v100
    v_xor_b32 v17, 64, v16
    v_bfe_u32 v100, v96, 1, 3
    v_xor_b32 v100, v100, v97
    v_lshlrev_b32 v100, 4, v100
    v_lshl_or_b32 v100, v96, 7, v100
    s_lshl_b32 s3, s6, 12
    s_add_u32 s3, s3, 147456
    v_add_u32 v18, s3, v100
    v_xor_b32 v19, 32, v18
    v_xor_b32 v20, 64, v18
    v_xor_b32 v21, 96, v18
    v_and_b32 v100, 7, v0
    v_lshlrev_b32 v100, 1, v100
    v_lshrrev_b32 v101, 4, v0
    v_xor_b32 v100, v100, v101
    v_lshlrev_b32 v100, 4, v100
    v_and_b32 v96, 15, v0
    v_lshl_or_b32 v100, v96, 8, v100
    s_mul_i32 s74, s7, s72
    s_lshl_b32 s74, s74, 14
    v_add_u32 v28, s74, v100
    v_xor_b32 v29, 64, v28
    v_xor_b32 v30, 128, v28
    v_xor_b32 v31, 192, v28
    v_lshlrev_b32 v10, 4, v0
    s_lshl_b32 s3, s4, 12
    s_add_u32 s3, s3, 131072
    v_add_u32 v14, s3, v10
    v_lshlrev_b32 v100, 4, v96
    v_lshl_or_b32 v100, v101, 9, v100
    s_lshr_b32 s3, s4, 1
    s_lshl_b32 s3, s3, 13
    s_lshl_b32 s65, s5, 8
    s_add_u32 s3, s3, s65
    s_add_u32 s3, s3, 131072
    v_add_u32 v15, s3, v100
    s_waitcnt vmcnt(5)
    s_barrier
    ds_read_b128 v[64:67], v18 offset:0
    ds_read_b64_tr_b16 v[68:69], v16 offset:0
    ds_read_b64_tr_b16 v[70:71], v16 offset:2048
    ds_read_b64_tr_b16 v[72:73], v17 offset:0
    ds_read_b64_tr_b16 v[74:75], v17 offset:2048
    ds_read_b128 v[76:79], v19 offset:0
    ds_read_b64_tr_b16 v[80:81], v16 offset:8192
    ds_read_b64_tr_b16 v[82:83], v16 offset:10240
    ds_read_b64_tr_b16 v[84:85], v17 offset:8192
    ds_read_b64_tr_b16 v[86:87], v17 offset:10240
    s_waitcnt lgkmcnt(0)
    s_waitcnt vmcnt(3)
    s_barrier
    v_mfma_f32_32x32x16_bf16 v[224:239], v[68:71], v[64:67], 0
    ds_read_b128 v[96:99], v20 offset:0
    ds_read_b64_tr_b16 v[100:101], v16 offset:16384
    ds_read_b64_tr_b16 v[102:103], v16 offset:18432
    ds_read_b64_tr_b16 v[104:105], v17 offset:16384
    ds_read_b64_tr_b16 v[106:107], v17 offset:18432
    s_cmp_lt_u32 s68, 8
    s_cselect_b32 s66, s33, s76
    s_add_u32 m0, s62, 98304
    s_add_u32 s65, s66, 786432
    buffer_load_dwordx4 v6, s[20:23], s65 offen lds
    v_mfma_f32_32x32x16_bf16 v[240:255], v[72:75], v[64:67], 0
    ds_read_b128 v[108:111], v21 offset:0
    ds_read_b64_tr_b16 v[112:113], v16 offset:24576
    ds_read_b64_tr_b16 v[114:115], v16 offset:26624
    ds_read_b64_tr_b16 v[116:117], v17 offset:24576
    ds_read_b64_tr_b16 v[118:119], v17 offset:26624
    v_mfma_f32_32x32x16_bf16 v[224:239], v[80:83], v[76:79], v[224:239]
    s_add_u32 m0, s62, 99328
    s_add_u32 s65, s66, 802816
    buffer_load_dwordx4 v7, s[20:23], s65 offen lds
    v_mfma_f32_32x32x16_bf16 v[240:255], v[84:87], v[76:79], v[240:255]
    s_waitcnt lgkmcnt(0)
    s_waitcnt vmcnt(2)
    s_barrier
    v_mfma_f32_32x32x16_bf16 v[224:239], v[100:103], v[96:99], v[224:239]
    ds_read_b128 v[64:67], v18 offset:8192
    ds_read_b64_tr_b16 v[68:69], v16 offset:32768
    ds_read_b64_tr_b16 v[70:71], v16 offset:34816
    ds_read_b64_tr_b16 v[72:73], v17 offset:32768
    ds_read_b64_tr_b16 v[74:75], v17 offset:34816
    s_cmp_lt_u32 s68, 7
    s_cselect_b32 s66, s32, s77
    s_add_u32 m0, s69, 147456
    s_add_u32 s65, s66, 256
    buffer_load_dwordx4 v8, s[8:11], s65 offen lds
    v_mfma_f32_32x32x16_bf16 v[240:255], v[104:107], v[96:99], v[240:255]
    ds_read_b128 v[76:79], v19 offset:8192
    ds_read_b64_tr_b16 v[80:81], v16 offset:40960
    ds_read_b64_tr_b16 v[82:83], v16 offset:43008
    ds_read_b64_tr_b16 v[84:85], v17 offset:40960
    ds_read_b64_tr_b16 v[86:87], v17 offset:43008
    s_cmp_lt_u32 s68, 7
    s_cselect_b32 s66, s33, s76
    s_add_u32 m0, s62, 114688
    s_add_u32 s65, s66, 1048576
    buffer_load_dwordx4 v6, s[20:23], s65 offen lds
    v_mfma_f32_32x32x16_bf16 v[224:239], v[112:115], v[108:111], v[224:239]
    s_add_u32 m0, s62, 115712
    s_add_u32 s65, s66, 1064960
    buffer_load_dwordx4 v7, s[20:23], s65 offen lds
    v_mfma_f32_32x32x16_bf16 v[240:255], v[116:119], v[108:111], v[240:255]
    s_waitcnt lgkmcnt(0)
    s_waitcnt vmcnt(3)
    s_barrier
    v_mfma_f32_32x32x16_bf16 v[224:239], v[68:71], v[64:67], v[224:239]
    ds_read_b128 v[96:99], v20 offset:8192
    ds_read_b64_tr_b16 v[100:101], v16 offset:0
    ds_read_b64_tr_b16 v[102:103], v16 offset:2048
    ds_read_b64_tr_b16 v[104:105], v17 offset:0
    ds_read_b64_tr_b16 v[106:107], v17 offset:2048
    s_cmp_lt_u32 s68, 7
    s_cselect_b32 s66, s33, s76
    s_add_u32 m0, s62, 131072
    s_add_u32 s65, s66, 1310720
    buffer_load_dwordx4 v6, s[20:23], s65 offen lds
    v_mfma_f32_32x32x16_bf16 v[240:255], v[72:75], v[64:67], v[240:255]
    ds_read_b128 v[108:111], v21 offset:8192
    ds_read_b64_tr_b16 v[112:113], v16 offset:8192
    ds_read_b64_tr_b16 v[114:115], v16 offset:10240
    ds_read_b64_tr_b16 v[116:117], v17 offset:8192
    ds_read_b64_tr_b16 v[118:119], v17 offset:10240
    v_mfma_f32_32x32x16_bf16 v[224:239], v[80:83], v[76:79], v[224:239]
    s_add_u32 m0, s62, 132096
    s_add_u32 s65, s66, 1327104
    buffer_load_dwordx4 v7, s[20:23], s65 offen lds
    v_mfma_f32_32x32x16_bf16 v[240:255], v[84:87], v[76:79], v[240:255]
    s_waitcnt lgkmcnt(0)
    s_waitcnt vmcnt(2)
    s_barrier
    v_mfma_f32_32x32x16_bf16 v[224:239], v[100:103], v[96:99], v[224:239]
    ds_read_b128 v[64:67], v18 offset:0
    ds_read_b64_tr_b16 v[68:69], v16 offset:16384
    ds_read_b64_tr_b16 v[70:71], v16 offset:18432
    ds_read_b64_tr_b16 v[72:73], v17 offset:16384
    ds_read_b64_tr_b16 v[74:75], v17 offset:18432
    s_cmp_lt_u32 s68, 6
    s_cselect_b32 s66, s32, s77
    s_add_u32 m0, s69, 155648
    s_add_u32 s65, s66, 384
    buffer_load_dwordx4 v8, s[8:11], s65 offen lds
    v_mfma_f32_32x32x16_bf16 v[240:255], v[104:107], v[96:99], v[240:255]
    ds_read_b128 v[76:79], v19 offset:0
    ds_read_b64_tr_b16 v[80:81], v16 offset:24576
    ds_read_b64_tr_b16 v[82:83], v16 offset:26624
    ds_read_b64_tr_b16 v[84:85], v17 offset:24576
    ds_read_b64_tr_b16 v[86:87], v17 offset:26624
    s_cmp_lt_u32 s68, 6
    s_cselect_b32 s66, s33, s76
    s_add_u32 m0, s62, 98304
    s_add_u32 s65, s66, 1572864
    buffer_load_dwordx4 v6, s[20:23], s65 offen lds
    v_mfma_f32_32x32x16_bf16 v[224:239], v[112:115], v[108:111], v[224:239]
    s_add_u32 m0, s62, 99328
    s_add_u32 s65, s66, 1589248
    buffer_load_dwordx4 v7, s[20:23], s65 offen lds
    v_mfma_f32_32x32x16_bf16 v[240:255], v[116:119], v[108:111], v[240:255]
    s_waitcnt lgkmcnt(0)
    s_waitcnt vmcnt(3)
    s_barrier
    v_mfma_f32_32x32x16_bf16 v[224:239], v[68:71], v[64:67], v[224:239]
    ds_read_b128 v[96:99], v20 offset:0
    ds_read_b64_tr_b16 v[100:101], v16 offset:32768
    ds_read_b64_tr_b16 v[102:103], v16 offset:34816
    ds_read_b64_tr_b16 v[104:105], v17 offset:32768
    ds_read_b64_tr_b16 v[106:107], v17 offset:34816
    s_cmp_lt_u32 s68, 6
    s_cselect_b32 s66, s33, s76
    s_add_u32 m0, s62, 114688
    s_add_u32 s65, s66, 1835008
    buffer_load_dwordx4 v6, s[20:23], s65 offen lds
    v_mfma_f32_32x32x16_bf16 v[240:255], v[72:75], v[64:67], v[240:255]
    ds_read_b128 v[108:111], v21 offset:0
    ds_read_b64_tr_b16 v[112:113], v16 offset:40960
    ds_read_b64_tr_b16 v[114:115], v16 offset:43008
    ds_read_b64_tr_b16 v[116:117], v17 offset:40960
    ds_read_b64_tr_b16 v[118:119], v17 offset:43008
    v_mfma_f32_32x32x16_bf16 v[224:239], v[80:83], v[76:79], v[224:239]
    s_add_u32 m0, s62, 115712
    s_add_u32 s65, s66, 1851392
    buffer_load_dwordx4 v7, s[20:23], s65 offen lds
    v_mfma_f32_32x32x16_bf16 v[240:255], v[84:87], v[76:79], v[240:255]
    s_waitcnt lgkmcnt(0)
    s_waitcnt vmcnt(2)
    s_barrier
    v_mfma_f32_32x32x16_bf16 v[224:239], v[100:103], v[96:99], v[224:239]
    ds_read_b128 v[64:67], v18 offset:8192
    ds_read_b64_tr_b16 v[68:69], v16 offset:0
    ds_read_b64_tr_b16 v[70:71], v16 offset:2048
    ds_read_b64_tr_b16 v[72:73], v17 offset:0
    ds_read_b64_tr_b16 v[74:75], v17 offset:2048
    s_cmp_lt_u32 s68, 5
    s_cselect_b32 s66, s32, s77
    s_add_u32 m0, s69, 147456
    s_add_u32 s65, s66, 512
    buffer_load_dwordx4 v8, s[8:11], s65 offen lds
    v_mfma_f32_32x32x16_bf16 v[240:255], v[104:107], v[96:99], v[240:255]
    ds_read_b128 v[76:79], v19 offset:8192
    ds_read_b64_tr_b16 v[80:81], v16 offset:8192
    ds_read_b64_tr_b16 v[82:83], v16 offset:10240
    ds_read_b64_tr_b16 v[84:85], v17 offset:8192
    ds_read_b64_tr_b16 v[86:87], v17 offset:10240
    s_cmp_lt_u32 s68, 5
    s_cselect_b32 s66, s33, s76
    s_add_u32 m0, s62, 131072
    s_add_u32 s65, s66, 2097152
    buffer_load_dwordx4 v6, s[20:23], s65 offen lds
    v_mfma_f32_32x32x16_bf16 v[224:239], v[112:115], v[108:111], v[224:239]
    s_add_u32 m0, s62, 132096
    s_add_u32 s65, s66, 2113536
    buffer_load_dwordx4 v7, s[20:23], s65 offen lds
    v_mfma_f32_32x32x16_bf16 v[240:255], v[116:119], v[108:111], v[240:255]
    s_waitcnt lgkmcnt(0)
    s_waitcnt vmcnt(3)
    s_barrier
    v_mfma_f32_32x32x16_bf16 v[224:239], v[68:71], v[64:67], v[224:239]
    ds_read_b128 v[96:99], v20 offset:8192
    ds_read_b64_tr_b16 v[100:101], v16 offset:16384
    ds_read_b64_tr_b16 v[102:103], v16 offset:18432
    ds_read_b64_tr_b16 v[104:105], v17 offset:16384
    ds_read_b64_tr_b16 v[106:107], v17 offset:18432
    s_cmp_lt_u32 s68, 5
    s_cselect_b32 s66, s33, s76
    s_add_u32 m0, s62, 98304
    s_add_u32 s65, s66, 2359296
    buffer_load_dwordx4 v6, s[20:23], s65 offen lds
    v_mfma_f32_32x32x16_bf16 v[240:255], v[72:75], v[64:67], v[240:255]
    ds_read_b128 v[108:111], v21 offset:8192
    ds_read_b64_tr_b16 v[112:113], v16 offset:24576
    ds_read_b64_tr_b16 v[114:115], v16 offset:26624
    ds_read_b64_tr_b16 v[116:117], v17 offset:24576
    ds_read_b64_tr_b16 v[118:119], v17 offset:26624
    v_mfma_f32_32x32x16_bf16 v[224:239], v[80:83], v[76:79], v[224:239]
    s_add_u32 m0, s62, 99328
    s_add_u32 s65, s66, 2375680
    buffer_load_dwordx4 v7, s[20:23], s65 offen lds
    v_mfma_f32_32x32x16_bf16 v[240:255], v[84:87], v[76:79], v[240:255]
    s_waitcnt lgkmcnt(0)
    s_waitcnt vmcnt(2)
    s_barrier
    v_mfma_f32_32x32x16_bf16 v[224:239], v[100:103], v[96:99], v[224:239]
    ds_read_b128 v[64:67], v18 offset:0
    ds_read_b64_tr_b16 v[68:69], v16 offset:32768
    ds_read_b64_tr_b16 v[70:71], v16 offset:34816
    ds_read_b64_tr_b16 v[72:73], v17 offset:32768
    ds_read_b64_tr_b16 v[74:75], v17 offset:34816
    s_cmp_lt_u32 s68, 4
    s_cselect_b32 s66, s32, s77
    s_add_u32 m0, s69, 155648
    s_add_u32 s65, s66, 640
    buffer_load_dwordx4 v8, s[8:11], s65 offen lds
    v_mfma_f32_32x32x16_bf16 v[240:255], v[104:107], v[96:99], v[240:255]
    ds_read_b128 v[76:79], v19 offset:0
    ds_read_b64_tr_b16 v[80:81], v16 offset:40960
    ds_read_b64_tr_b16 v[82:83], v16 offset:43008
    ds_read_b64_tr_b16 v[84:85], v17 offset:40960
    ds_read_b64_tr_b16 v[86:87], v17 offset:43008
    s_cmp_lt_u32 s68, 4
    s_cselect_b32 s66, s33, s76
    s_add_u32 m0, s62, 114688
    s_add_u32 s65, s66, 2621440
    buffer_load_dwordx4 v6, s[20:23], s65 offen lds
    v_mfma_f32_32x32x16_bf16 v[224:239], v[112:115], v[108:111], v[224:239]
    s_add_u32 m0, s62, 115712
    s_add_u32 s65, s66, 2637824
    buffer_load_dwordx4 v7, s[20:23], s65 offen lds
    v_mfma_f32_32x32x16_bf16 v[240:255], v[116:119], v[108:111], v[240:255]
    s_waitcnt lgkmcnt(0)
    s_waitcnt vmcnt(3)
    s_barrier
    v_mfma_f32_32x32x16_bf16 v[224:239], v[68:71], v[64:67], v[224:239]
    ds_read_b128 v[96:99], v20 offset:0
    ds_read_b64_tr_b16 v[100:101], v16 offset:0
    ds_read_b64_tr_b16 v[102:103], v16 offset:2048
    ds_read_b64_tr_b16 v[104:105], v17 offset:0
    ds_read_b64_tr_b16 v[106:107], v17 offset:2048
    s_cmp_lt_u32 s68, 4
    s_cselect_b32 s66, s33, s76
    s_add_u32 m0, s62, 131072
    s_add_u32 s65, s66, 2883584
    buffer_load_dwordx4 v6, s[20:23], s65 offen lds
    v_mfma_f32_32x32x16_bf16 v[240:255], v[72:75], v[64:67], v[240:255]
    ds_read_b128 v[108:111], v21 offset:0
    ds_read_b64_tr_b16 v[112:113], v16 offset:8192
    ds_read_b64_tr_b16 v[114:115], v16 offset:10240
    ds_read_b64_tr_b16 v[116:117], v17 offset:8192
    ds_read_b64_tr_b16 v[118:119], v17 offset:10240
    v_mfma_f32_32x32x16_bf16 v[224:239], v[80:83], v[76:79], v[224:239]
    s_add_u32 m0, s62, 132096
    s_add_u32 s65, s66, 2899968
    buffer_load_dwordx4 v7, s[20:23], s65 offen lds
    v_mfma_f32_32x32x16_bf16 v[240:255], v[84:87], v[76:79], v[240:255]
    s_waitcnt lgkmcnt(0)
    s_waitcnt vmcnt(2)
    s_barrier
    v_mfma_f32_32x32x16_bf16 v[224:239], v[100:103], v[96:99], v[224:239]
    ds_read_b128 v[64:67], v18 offset:8192
    ds_read_b64_tr_b16 v[68:69], v16 offset:16384
    ds_read_b64_tr_b16 v[70:71], v16 offset:18432
    ds_read_b64_tr_b16 v[72:73], v17 offset:16384
    ds_read_b64_tr_b16 v[74:75], v17 offset:18432
    s_cmp_lt_u32 s68, 3
    s_cselect_b32 s66, s32, s77
    s_add_u32 m0, s69, 147456
    s_add_u32 s65, s66, 768
    buffer_load_dwordx4 v8, s[8:11], s65 offen lds
    v_mfma_f32_32x32x16_bf16 v[240:255], v[104:107], v[96:99], v[240:255]
    ds_read_b128 v[76:79], v19 offset:8192
    ds_read_b64_tr_b16 v[80:81], v16 offset:24576
    ds_read_b64_tr_b16 v[82:83], v16 offset:26624
    ds_read_b64_tr_b16 v[84:85], v17 offset:24576
    ds_read_b64_tr_b16 v[86:87], v17 offset:26624
    s_cmp_lt_u32 s68, 3
    s_cselect_b32 s66, s33, s76
    s_add_u32 m0, s62, 98304
    s_add_u32 s65, s66, 3145728
    buffer_load_dwordx4 v6, s[20:23], s65 offen lds
    v_mfma_f32_32x32x16_bf16 v[224:239], v[112:115], v[108:111], v[224:239]
    s_add_u32 m0, s62, 99328
    s_add_u32 s65, s66, 3162112
    buffer_load_dwordx4 v7, s[20:23], s65 offen lds
    v_mfma_f32_32x32x16_bf16 v[240:255], v[116:119], v[108:111], v[240:255]
    s_waitcnt lgkmcnt(0)
    s_waitcnt vmcnt(3)
    s_barrier
    v_mfma_f32_32x32x16_bf16 v[224:239], v[68:71], v[64:67], v[224:239]
    ds_read_b128 v[96:99], v20 offset:8192
    ds_read_b64_tr_b16 v[100:101], v16 offset:32768
    ds_read_b64_tr_b16 v[102:103], v16 offset:34816
    ds_read_b64_tr_b16 v[104:105], v17 offset:32768
    ds_read_b64_tr_b16 v[106:107], v17 offset:34816
    s_cmp_lt_u32 s68, 3
    s_cselect_b32 s66, s33, s76
    s_add_u32 m0, s62, 114688
    s_add_u32 s65, s66, 3407872
    buffer_load_dwordx4 v6, s[20:23], s65 offen lds
    v_mfma_f32_32x32x16_bf16 v[240:255], v[72:75], v[64:67], v[240:255]
    ds_read_b128 v[108:111], v21 offset:8192
    ds_read_b64_tr_b16 v[112:113], v16 offset:40960
    ds_read_b64_tr_b16 v[114:115], v16 offset:43008
    ds_read_b64_tr_b16 v[116:117], v17 offset:40960
    ds_read_b64_tr_b16 v[118:119], v17 offset:43008
    v_mfma_f32_32x32x16_bf16 v[224:239], v[80:83], v[76:79], v[224:239]
    s_add_u32 m0, s62, 115712
    s_add_u32 s65, s66, 3424256
    buffer_load_dwordx4 v7, s[20:23], s65 offen lds
    v_mfma_f32_32x32x16_bf16 v[240:255], v[84:87], v[76:79], v[240:255]
    s_waitcnt lgkmcnt(0)
    s_waitcnt vmcnt(2)
    s_barrier
    v_mfma_f32_32x32x16_bf16 v[224:239], v[100:103], v[96:99], v[224:239]
    ds_read_b128 v[64:67], v18 offset:0
    ds_read_b64_tr_b16 v[68:69], v16 offset:0
    ds_read_b64_tr_b16 v[70:71], v16 offset:2048
    ds_read_b64_tr_b16 v[72:73], v17 offset:0
    ds_read_b64_tr_b16 v[74:75], v17 offset:2048
    s_cmp_lt_u32 s68, 2
    s_cselect_b32 s66, s32, s77
    s_add_u32 m0, s69, 155648
    s_add_u32 s65, s66, 896
    buffer_load_dwordx4 v8, s[8:11], s65 offen lds
    v_mfma_f32_32x32x16_bf16 v[240:255], v[104:107], v[96:99], v[240:255]
    ds_read_b128 v[76:79], v19 offset:0
    ds_read_b64_tr_b16 v[80:81], v16 offset:8192
    ds_read_b64_tr_b16 v[82:83], v16 offset:10240
    ds_read_b64_tr_b16 v[84:85], v17 offset:8192
    ds_read_b64_tr_b16 v[86:87], v17 offset:10240
    s_cmp_lt_u32 s68, 2
    s_cselect_b32 s66, s33, s76
    s_add_u32 m0, s62, 131072
    s_add_u32 s65, s66, 3670016
    buffer_load_dwordx4 v6, s[20:23], s65 offen lds
    v_mfma_f32_32x32x16_bf16 v[224:239], v[112:115], v[108:111], v[224:239]
    s_add_u32 m0, s62, 132096
    s_add_u32 s65, s66, 3686400
    buffer_load_dwordx4 v7, s[20:23], s65 offen lds
    v_mfma_f32_32x32x16_bf16 v[240:255], v[116:119], v[108:111], v[240:255]
    s_waitcnt lgkmcnt(0)
    s_waitcnt vmcnt(3)
    s_barrier
    v_mfma_f32_32x32x16_bf16 v[224:239], v[68:71], v[64:67], v[224:239]
    ds_read_b128 v[96:99], v20 offset:0
    ds_read_b64_tr_b16 v[100:101], v16 offset:16384
    ds_read_b64_tr_b16 v[102:103], v16 offset:18432
    ds_read_b64_tr_b16 v[104:105], v17 offset:16384
    ds_read_b64_tr_b16 v[106:107], v17 offset:18432
    s_cmp_lt_u32 s68, 2
    s_cselect_b32 s66, s33, s76
    s_add_u32 m0, s62, 98304
    s_add_u32 s65, s66, 3932160
    buffer_load_dwordx4 v6, s[20:23], s65 offen lds
    v_mfma_f32_32x32x16_bf16 v[240:255], v[72:75], v[64:67], v[240:255]
    ds_read_b128 v[108:111], v21 offset:0
    ds_read_b64_tr_b16 v[112:113], v16 offset:24576
    ds_read_b64_tr_b16 v[114:115], v16 offset:26624
    ds_read_b64_tr_b16 v[116:117], v17 offset:24576
    ds_read_b64_tr_b16 v[118:119], v17 offset:26624
    v_mfma_f32_32x32x16_bf16 v[224:239], v[80:83], v[76:79], v[224:239]
    s_add_u32 m0, s62, 99328
    s_add_u32 s65, s66, 3948544
    buffer_load_dwordx4 v7, s[20:23], s65 offen lds
    v_mfma_f32_32x32x16_bf16 v[240:255], v[84:87], v[76:79], v[240:255]
    s_waitcnt lgkmcnt(0)
    s_waitcnt vmcnt(2)
    s_barrier
    v_mfma_f32_32x32x16_bf16 v[224:239], v[100:103], v[96:99], v[224:239]
    ds_read_b128 v[64:67], v18 offset:8192
    ds_read_b64_tr_b16 v[68:69], v16 offset:32768
    ds_read_b64_tr_b16 v[70:71], v16 offset:34816
    ds_read_b64_tr_b16 v[72:73], v17 offset:32768
    ds_read_b64_tr_b16 v[74:75], v17 offset:34816
    s_cmp_lt_u32 s68, 1
    s_cselect_b32 s66, s32, s77
    s_add_u32 m0, s69, 147456
    s_add_u32 s65, s66, 1024
    buffer_load_dwordx4 v8, s[8:11], s65 offen lds
    v_mfma_f32_32x32x16_bf16 v[240:255], v[104:107], v[96:99], v[240:255]
    ds_read_b128 v[76:79], v19 offset:8192
    ds_read_b64_tr_b16 v[80:81], v16 offset:40960
    ds_read_b64_tr_b16 v[82:83], v16 offset:43008
    ds_read_b64_tr_b16 v[84:85], v17 offset:40960
    ds_read_b64_tr_b16 v[86:87], v17 offset:43008
    s_cmp_lt_u32 s68, 1
    s_cselect_b32 s66, s33, s76
    s_add_u32 m0, s62, 114688
    s_add_u32 s65, s66, 4194304
    buffer_load_dwordx4 v6, s[20:23], s65 offen lds
    v_mfma_f32_32x32x16_bf16 v[224:239], v[112:115], v[108:111], v[224:239]
    s_add_u32 m0, s62, 115712
    s_add_u32 s65, s66, 4210688
    buffer_load_dwordx4 v7, s[20:23], s65 offen lds
    v_mfma_f32_32x32x16_bf16 v[240:255], v[116:119], v[108:111], v[240:255]
    s_waitcnt lgkmcnt(0)
    s_waitcnt vmcnt(3)
    s_barrier
    v_mfma_f32_32x32x16_bf16 v[224:239], v[68:71], v[64:67], v[224:239]
    ds_read_b128 v[96:99], v20 offset:8192
    ds_read_b64_tr_b16 v[100:101], v16 offset:0
    ds_read_b64_tr_b16 v[102:103], v16 offset:2048
    ds_read_b64_tr_b16 v[104:105], v17 offset:0
    ds_read_b64_tr_b16 v[106:107], v17 offset:2048
    s_cmp_lt_u32 s68, 1
    s_cselect_b32 s66, s33, s76
    s_add_u32 m0, s62, 131072
    s_add_u32 s65, s66, 4456448
    buffer_load_dwordx4 v6, s[20:23], s65 offen lds
    v_mfma_f32_32x32x16_bf16 v[240:255], v[72:75], v[64:67], v[240:255]
    ds_read_b128 v[108:111], v21 offset:8192
    ds_read_b64_tr_b16 v[112:113], v16 offset:8192
    ds_read_b64_tr_b16 v[114:115], v16 offset:10240
    ds_read_b64_tr_b16 v[116:117], v17 offset:8192
    ds_read_b64_tr_b16 v[118:119], v17 offset:10240
    v_mfma_f32_32x32x16_bf16 v[224:239], v[80:83], v[76:79], v[224:239]
    s_add_u32 m0, s62, 132096
    s_add_u32 s65, s66, 4472832
    buffer_load_dwordx4 v7, s[20:23], s65 offen lds
    v_mfma_f32_32x32x16_bf16 v[240:255], v[84:87], v[76:79], v[240:255]
    s_waitcnt lgkmcnt(0)
    s_waitcnt vmcnt(2)
    s_barrier
    v_mfma_f32_32x32x16_bf16 v[224:239], v[100:103], v[96:99], v[224:239]
    ds_read_b128 v[64:67], v18 offset:0
    ds_read_b64_tr_b16 v[68:69], v16 offset:16384
    ds_read_b64_tr_b16 v[70:71], v16 offset:18432
    ds_read_b64_tr_b16 v[72:73], v17 offset:16384
    ds_read_b64_tr_b16 v[74:75], v17 offset:18432
    v_mfma_f32_32x32x16_bf16 v[240:255], v[104:107], v[96:99], v[240:255]
    ds_read_b128 v[76:79], v19 offset:0
    ds_read_b64_tr_b16 v[80:81], v16 offset:24576
    ds_read_b64_tr_b16 v[82:83], v16 offset:26624
    ds_read_b64_tr_b16 v[84:85], v17 offset:24576
    ds_read_b64_tr_b16 v[86:87], v17 offset:26624
    v_mfma_f32_32x32x16_bf16 v[224:239], v[112:115], v[108:111], v[224:239]
    v_mfma_f32_32x32x16_bf16 v[240:255], v[116:119], v[108:111], v[240:255]
    s_waitcnt lgkmcnt(0)
    s_waitcnt vmcnt(0)
    s_barrier
    v_mfma_f32_32x32x16_bf16 v[224:239], v[68:71], v[64:67], v[224:239]
    ds_read_b128 v[96:99], v20 offset:0
    ds_read_b64_tr_b16 v[100:101], v16 offset:32768
    ds_read_b64_tr_b16 v[102:103], v16 offset:34816
    ds_read_b64_tr_b16 v[104:105], v17 offset:32768
    ds_read_b64_tr_b16 v[106:107], v17 offset:34816
    s_mov_b64 s[88:89], s[54:55]
    s_mov_b32 s90, 4718592
    v_bfe_u32 v11, v0, 2, 2
    v_mul_u32_u24 v11, 9, v11
    v_and_b32 v9, 3, v0
    v_add_lshl_u32 v11, v11, v9, 7
    s_lshl_b32 s80, s68, 3
    s_add_u32 s80, s80, s4
    s_mul_i32 s80, s80, 4608
    s_mul_i32 s65, s67, 294912
    s_add_u32 s65, s65, s80
    buffer_load_dword v13, v11, s[88:91], s65 offen offset:0
    v_mfma_f32_32x32x16_bf16 v[240:255], v[72:75], v[64:67], v[240:255]
    ds_read_b128 v[108:111], v21 offset:0
    ds_read_b64_tr_b16 v[112:113], v16 offset:40960
    ds_read_b64_tr_b16 v[114:115], v16 offset:43008
    ds_read_b64_tr_b16 v[116:117], v17 offset:40960
    ds_read_b64_tr_b16 v[118:119], v17 offset:43008
    v_mfma_f32_32x32x16_bf16 v[224:239], v[80:83], v[76:79], v[224:239]
    v_mfma_f32_32x32x16_bf16 v[240:255], v[84:87], v[76:79], v[240:255]
    s_waitcnt lgkmcnt(0)
    s_barrier
    v_mfma_f32_32x32x16_bf16 v[224:239], v[100:103], v[96:99], v[224:239]
    ds_read_b128 v[64:67], v28 offset:0
    ds_read_b128 v[68:71], v29 offset:0
    ds_read_b128 v[72:75], v30 offset:0
    ds_read_b128 v[76:79], v31 offset:0
    v_mfma_f32_32x32x16_bf16 v[240:255], v[104:107], v[96:99], v[240:255]
    ds_read_b128 v[80:83], v28 offset:4096
    ds_read_b128 v[84:87], v29 offset:4096
    ds_read_b128 v[88:91], v30 offset:4096
    ds_read_b128 v[92:95], v31 offset:4096
    v_mfma_f32_32x32x16_bf16 v[224:239], v[112:115], v[108:111], v[224:239]
    v_mfma_f32_32x32x16_bf16 v[240:255], v[116:119], v[108:111], v[240:255]
    ds_read_b128 v[96:99], v28 offset:8192
    ds_read_b128 v[100:103], v29 offset:8192
    ds_read_b128 v[104:107], v30 offset:8192
    ds_read_b128 v[108:111], v31 offset:8192
    ds_read_b128 v[112:115], v28 offset:12288
    ds_read_b128 v[116:119], v29 offset:12288
    ds_read_b128 v[120:123], v30 offset:12288
    s_waitcnt lgkmcnt(12)
    ds_read_b128 v[124:127], v31 offset:12288
    s_nop 1
    v_cvt_pk_bf16_f32 v32, v224, v225
    v_cvt_pk_bf16_f32 v33, v226, v227
    v_cvt_pk_bf16_f32 v34, v228, v229
    v_cvt_pk_bf16_f32 v35, v230, v231
    v_cvt_pk_bf16_f32 v36, v232, v233
    v_cvt_pk_bf16_f32 v37, v234, v235
    v_cvt_pk_bf16_f32 v38, v236, v237
    v_cvt_pk_bf16_f32 v39, v238, v239
    v_cvt_pk_bf16_f32 v40, v240, v241
    v_cvt_pk_bf16_f32 v41, v242, v243
    v_cvt_pk_bf16_f32 v42, v244, v245
    v_cvt_pk_bf16_f32 v43, v246, v247
    v_cvt_pk_bf16_f32 v44, v248, v249
    v_cvt_pk_bf16_f32 v45, v250, v251
    v_cvt_pk_bf16_f32 v46, v252, v253
    v_cvt_pk_bf16_f32 v47, v254, v255
    v_permlane32_swap_b32 v32, v34
    v_permlane32_swap_b32 v33, v35
    v_permlane32_swap_b32 v36, v38
    v_permlane32_swap_b32 v37, v39
    v_permlane32_swap_b32 v40, v42
    v_permlane32_swap_b32 v41, v43
    v_permlane32_swap_b32 v44, v46
    v_permlane32_swap_b32 v45, v47
    ds_write_b128 v14, v[32:35] offset:0
    ds_write_b128 v14, v[36:39] offset:1024
    s_waitcnt lgkmcnt(12)
    ds_write_b128 v14, v[40:43] offset:2048
    ds_write_b128 v14, v[44:47] offset:3072
    s_waitcnt lgkmcnt(0)
    s_barrier
    ds_read_b128 v[32:35], v15 offset:0
    ds_read_b128 v[36:39], v15 offset:2048
    ds_read_b128 v[40:43], v15 offset:4096
    ds_read_b128 v[44:47], v15 offset:6144
    ds_read_b128 v[48:51], v28 offset:16384
    ds_read_b128 v[52:55], v29 offset:16384
    ds_read_b128 v[56:59], v30 offset:16384
    ds_read_b128 v[60:63], v31 offset:16384
    s_waitcnt lgkmcnt(4)
    v_mfma_f32_16x16x32_bf16 v[128:131], v[64:67], v[32:35], 0
    ds_read_b128 v[64:67], v28 offset:20480
    s_add_u32 m0, s62, 0
    s_add_u32 s65, s34, 98304
    buffer_load_dwordx4 v4, s[12:15], s65 offen nt lds
    v_mfma_f32_16x16x32_bf16 v[128:131], v[68:71], v[36:39], v[128:131]
    ds_read_b128 v[68:71], v29 offset:20480
    v_mfma_f32_16x16x32_bf16 v[128:131], v[72:75], v[40:43], v[128:131]
    ds_read_b128 v[72:75], v30 offset:20480
    v_mfma_f32_16x16x32_bf16 v[128:131], v[76:79], v[44:47], v[128:131]
    ds_read_b128 v[76:79], v31 offset:20480
    v_mfma_f32_16x16x32_bf16 v[132:135], v[80:83], v[32:35], 0
    ds_read_b128 v[80:83], v28 offset:24576
    v_mfma_f32_16x16x32_bf16 v[132:135], v[84:87], v[36:39], v[132:135]
    ds_read_b128 v[84:87], v29 offset:24576
    v_mfma_f32_16x16x32_bf16 v[132:135], v[88:91], v[40:43], v[132:135]
    ds_read_b128 v[88:91], v30 offset:24576
    v_mfma_f32_16x16x32_bf16 v[132:135], v[92:95], v[44:47], v[132:135]
    ds_read_b128 v[92:95], v31 offset:24576
    v_mfma_f32_16x16x32_bf16 v[136:139], v[96:99], v[32:35], 0
    ds_read_b128 v[96:99], v28 offset:28672
    buffer_load_dwordx4 v5, s[12:15], s65 offen offset:1024 nt lds
    v_mfma_f32_16x16x32_bf16 v[136:139], v[100:103], v[36:39], v[136:139]
    ds_read_b128 v[100:103], v29 offset:28672
    v_mfma_f32_16x16x32_bf16 v[136:139], v[104:107], v[40:43], v[136:139]
    ds_read_b128 v[104:107], v30 offset:28672
    v_mfma_f32_16x16x32_bf16 v[136:139], v[108:111], v[44:47], v[136:139]
    s_waitcnt lgkmcnt(12)
    ds_read_b128 v[108:111], v31 offset:28672
    v_mfma_f32_16x16x32_bf16 v[140:143], v[112:115], v[32:35], 0
    v_mfma_f32_16x16x32_bf16 v[140:143], v[116:119], v[36:39], v[140:143]
    v_mfma_f32_16x16x32_bf16 v[140:143], v[120:123], v[40:43], v[140:143]
    v_mfma_f32_16x16x32_bf16 v[140:143], v[124:127], v[44:47], v[140:143]
    s_waitcnt lgkmcnt(0)
    s_barrier
    ds_read_b128 v[112:115], v28 offset:32768
    ds_read_b128 v[116:119], v29 offset:32768
    ds_read_b128 v[120:123], v30 offset:32768
    ds_read_b128 v[124:127], v31 offset:32768
    v_mfma_f32_16x16x32_bf16 v[144:147], v[48:51], v[32:35], 0
    ds_read_b128 v[48:51], v28 offset:36864
    s_add_u32 m0, s62, 16384
    s_add_u32 s65, s34, 114688
    buffer_load_dwordx4 v4, s[12:15], s65 offen nt lds
    v_max_f32 v1, v128, v129
    v_mfma_f32_16x16x32_bf16 v[144:147], v[52:55], v[36:39], v[144:147]
    ds_read_b128 v[52:55], v29 offset:36864
    v_max3_f32 v1, v1, v130, v131
    v_mfma_f32_16x16x32_bf16 v[144:147], v[56:59], v[40:43], v[144:147]
    ds_read_b128 v[56:59], v30 offset:36864
    v_max3_f32 v1, v1, v132, v133
    v_mfma_f32_16x16x32_bf16 v[144:147], v[60:63], v[44:47], v[144:147]
    ds_read_b128 v[60:63], v31 offset:36864
    v_max3_f32 v1, v1, v134, v135
    v_max3_f32 v1, v1, v136, v137
    v_mfma_f32_16x16x32_bf16 v[148:151], v[64:67], v[32:35], 0
    ds_read_b128 v[64:67], v28 offset:40960
    v_max3_f32 v1, v1, v138, v139
    v_mfma_f32_16x16x32_bf16 v[148:151], v[68:71], v[36:39], v[148:151]
    ds_read_b128 v[68:71], v29 offset:40960
    v_max3_f32 v1, v1, v140, v141
    v_mfma_f32_16x16x32_bf16 v[148:151], v[72:75], v[40:43], v[148:151]
    ds_read_b128 v[72:75], v30 offset:40960
    v_max3_f32 v1, v1, v142, v143
    v_mfma_f32_16x16x32_bf16 v[148:151], v[76:79], v[44:47], v[148:151]
    ds_read_b128 v[76:79], v31 offset:40960
    v_lshrrev_b32 v12, 4, v0
    v_lshlrev_b32 v2, 2, v12
    v_mfma_f32_16x16x32_bf16 v[152:155], v[80:83], v[32:35], 0
    ds_read_b128 v[80:83], v28 offset:45056
    buffer_load_dwordx4 v5, s[12:15], s65 offen offset:1024 nt lds
    v_xor_b32 v2, v2, v0
    v_mfma_f32_16x16x32_bf16 v[152:155], v[84:87], v[36:39], v[152:155]
    ds_read_b128 v[84:87], v29 offset:45056
    v_and_b32 v2, 15, v2
    v_mfma_f32_16x16x32_bf16 v[152:155], v[88:91], v[40:43], v[152:155]
    ds_read_b128 v[88:91], v30 offset:45056
    v_lshlrev_b32 v2, 4, v2
    v_mfma_f32_16x16x32_bf16 v[152:155], v[92:95], v[44:47], v[152:155]
    s_waitcnt lgkmcnt(12)
    ds_read_b128 v[92:95], v31 offset:45056
    s_lshl_b32 s3, s5, 5
    v_xor_b32 v2, s3, v2
    v_mfma_f32_16x16x32_bf16 v[156:159], v[96:99], v[32:35], 0
    v_bfe_u32 v14, v2, 7, 1
    v_mfma_f32_16x16x32_bf16 v[156:159], v[100:103], v[36:39], v[156:159]
    v_mul_u32_u24 v12, 1152, v12
    v_mfma_f32_16x16x32_bf16 v[156:159], v[104:107], v[40:43], v[156:159]
    v_add_u32 v6, v12, v2
    v_mfma_f32_16x16x32_bf16 v[156:159], v[108:111], v[44:47], v[156:159]
    v_xor_b32 v2, 16, v6
    v_add_u32 v7, 3584, v2
    s_waitcnt lgkmcnt(0)
    s_barrier
    v_add_u32 v28, 0xc000, v28
    v_add_u32 v29, 0xc000, v29
    v_add_u32 v30, 0xc000, v30
    v_add_u32 v31, 0xc000, v31
    ds_read_b128 v[96:99], v28 offset:0
    ds_read_b128 v[100:103], v29 offset:0
    ds_read_b128 v[104:107], v30 offset:0
    ds_read_b128 v[108:111], v31 offset:0
    v_mfma_f32_16x16x32_bf16 v[160:163], v[112:115], v[32:35], 0
    ds_read_b128 v[112:115], v28 offset:4096
    s_add_u32 m0, s62, 32768
    s_add_u32 s65, s34, 0
    buffer_load_dwordx4 v4, s[16:19], s65 offen nt lds
    v_max3_f32 v1, v1, v144, v145
    v_mfma_f32_16x16x32_bf16 v[160:163], v[116:119], v[36:39], v[160:163]
    ds_read_b128 v[116:119], v29 offset:4096
    v_max3_f32 v1, v1, v146, v147
    v_mfma_f32_16x16x32_bf16 v[160:163], v[120:123], v[40:43], v[160:163]
    ds_read_b128 v[120:123], v30 offset:4096
    v_max3_f32 v1, v1, v148, v149
    v_max3_f32 v1, v1, v150, v151
    v_mfma_f32_16x16x32_bf16 v[160:163], v[124:127], v[44:47], v[160:163]
    ds_read_b128 v[124:127], v31 offset:4096
    v_max3_f32 v1, v1, v152, v153
    v_mfma_f32_16x16x32_bf16 v[164:167], v[48:51], v[32:35], 0
    ds_read_b128 v[48:51], v28 offset:8192
    v_max3_f32 v1, v1, v154, v155
    v_mfma_f32_16x16x32_bf16 v[164:167], v[52:55], v[36:39], v[164:167]
    ds_read_b128 v[52:55], v29 offset:8192
    v_max3_f32 v1, v1, v156, v157
    v_max3_f32 v1, v1, v158, v159
    v_mfma_f32_16x16x32_bf16 v[164:167], v[56:59], v[40:43], v[164:167]
    ds_read_b128 v[56:59], v30 offset:8192
    v_and_b32 v2, 3, v0
    v_mfma_f32_16x16x32_bf16 v[164:167], v[60:63], v[44:47], v[164:167]
    ds_read_b128 v[60:63], v31 offset:8192
    v_lshlrev_b32 v2, 3, v2
    v_bfe_u32 v12, v0, 2, 3
    v_mfma_f32_16x16x32_bf16 v[168:171], v[64:67], v[32:35], 0
    ds_read_b128 v[64:67], v28 offset:12288
    buffer_load_dwordx4 v5, s[16:19], s65 offen offset:1024 nt lds
    v_lshl_or_b32 v2, v12, 5, v2
    v_mfma_f32_16x16x32_bf16 v[168:171], v[68:71], v[36:39], v[168:171]
    ds_read_b128 v[68:71], v29 offset:12288
    v_lshrrev_b32 v12, 2, v0
    v_mfma_f32_16x16x32_bf16 v[168:171], v[72:75], v[40:43], v[168:171]
    ds_read_b128 v[72:75], v30 offset:12288
    v_lshl_or_b32 v2, v12, 8, v2
    v_add_u32 v16, s74, v2
    v_mfma_f32_16x16x32_bf16 v[168:171], v[76:79], v[44:47], v[168:171]
    s_waitcnt lgkmcnt(12)
    ds_read_b128 v[76:79], v31 offset:12288
    v_xor_b32 v17, 32, v16
    v_mfma_f32_16x16x32_bf16 v[172:175], v[80:83], v[32:35], 0
    v_xor_b32 v18, 64, v16
    v_mfma_f32_16x16x32_bf16 v[172:175], v[84:87], v[36:39], v[172:175]
    v_xor_b32 v19, 96, v16
    v_xor_b32 v20, 128, v16
    v_mfma_f32_16x16x32_bf16 v[172:175], v[88:91], v[40:43], v[172:175]
    v_xor_b32 v21, 160, v16
    v_mfma_f32_16x16x32_bf16 v[172:175], v[92:95], v[44:47], v[172:175]
    v_xor_b32 v22, 192, v16
    v_xor_b32 v23, 224, v16
    s_waitcnt lgkmcnt(0)
    s_barrier
    ds_read_b128 v[80:83], v28 offset:16384
    ds_read_b128 v[84:87], v29 offset:16384
    ds_read_b128 v[88:91], v30 offset:16384
    ds_read_b128 v[92:95], v31 offset:16384
    v_mfma_f32_16x16x32_bf16 v[176:179], v[96:99], v[32:35], 0
    ds_read_b128 v[96:99], v28 offset:20480
    s_add_u32 m0, s62, 49152
    s_add_u32 s65, s34, 16384
    buffer_load_dwordx4 v4, s[16:19], s65 offen nt lds
    v_max3_f32 v1, v1, v160, v161
    v_max3_f32 v1, v1, v162, v163
    v_mfma_f32_16x16x32_bf16 v[176:179], v[100:103], v[36:39], v[176:179]
    ds_read_b128 v[100:103], v29 offset:20480
    v_max3_f32 v1, v1, v164, v165
    v_max3_f32 v1, v1, v166, v167
    v_mfma_f32_16x16x32_bf16 v[176:179], v[104:107], v[40:43], v[176:179]
    ds_read_b128 v[104:107], v30 offset:20480
    v_max3_f32 v1, v1, v168, v169
    v_max3_f32 v1, v1, v170, v171
    v_mfma_f32_16x16x32_bf16 v[176:179], v[108:111], v[44:47], v[176:179]
    ds_read_b128 v[108:111], v31 offset:20480
    v_max3_f32 v1, v1, v172, v173
    v_max3_f32 v1, v1, v174, v175
    v_and_b32 v2, 3, v0
    v_mfma_f32_16x16x32_bf16 v[180:183], v[112:115], v[32:35], 0
    ds_read_b128 v[112:115], v28 offset:24576
    v_lshlrev_b32 v2, 3, v2
    v_bfe_u32 v12, v0, 4, 1
    v_mfma_f32_16x16x32_bf16 v[180:183], v[116:119], v[36:39], v[180:183]
    ds_read_b128 v[116:119], v29 offset:24576
    v_lshl_or_b32 v2, v12, 5, v2
    v_bfe_u32 v12, v0, 2, 2
    v_mfma_f32_16x16x32_bf16 v[180:183], v[120:123], v[40:43], v[180:183]
    ds_read_b128 v[120:123], v30 offset:24576
    v_lshl_or_b32 v2, v12, 6, v2
    v_lshl_or_b32 v2, v12, 8, v2
    v_lshrrev_b32 v12, 5, v0
    v_mfma_f32_16x16x32_bf16 v[180:183], v[124:127], v[44:47], v[180:183]
    ds_read_b128 v[124:127], v31 offset:24576
    v_lshl_or_b32 v2, v12, 10, v2
    v_lshlrev_b32 v12, 4, v12
    v_mfma_f32_16x16x32_bf16 v[184:187], v[48:51], v[32:35], 0
    ds_read_b128 v[48:51], v28 offset:28672
    buffer_load_dwordx4 v5, s[16:19], s65 offen offset:1024 nt lds
    v_xor_b32 v2, v2, v12
    s_lshl_b32 s3, s72, 7
    v_mfma_f32_16x16x32_bf16 v[184:187], v[52:55], v[36:39], v[184:187]
    ds_read_b128 v[52:55], v29 offset:28672
    s_lshl_b32 s75, s5, 6
    s_add_u32 s3, s3, s75
    v_xor_b32 v24, s3, v2
    v_mfma_f32_16x16x32_bf16 v[184:187], v[56:59], v[40:43], v[184:187]
    ds_read_b128 v[56:59], v30 offset:28672
    v_xor_b32 v25, 2080, v24
    v_and_b32 v2, 15, v0
    v_mfma_f32_16x16x32_bf16 v[184:187], v[60:63], v[44:47], v[184:187]
    s_waitcnt lgkmcnt(12)
    ds_read_b128 v[60:63], v31 offset:28672
    v_lshlrev_b32 v2, 4, v2
    v_lshl_or_b32 v2, v12, 4, v2
    v_mfma_f32_16x16x32_bf16 v[188:191], v[64:67], v[32:35], 0
    v_bfe_u32 v12, v0, 4, 1
    v_lshl_or_b32 v2, v12, 10, v2
    s_lshl_b32 s3, s6, 11
    v_mfma_f32_16x16x32_bf16 v[188:191], v[68:71], v[36:39], v[188:191]
    s_add_u32 s3, s3, 32768
    v_add_u32 v26, s3, v2
    v_mfma_f32_16x16x32_bf16 v[188:191], v[72:75], v[40:43], v[188:191]
    s_lshl_b32 s3, s72, 14
    s_and_b32 s75, s69, 3072
    v_mfma_f32_16x16x32_bf16 v[188:191], v[76:79], v[44:47], v[188:191]
    s_add_u32 s3, s3, s75
    s_add_u32 s3, s3, 32768
    v_add_u32 v27, s3, v10
    s_waitcnt lgkmcnt(0)
    s_barrier
    ds_read_b128 v[64:67], v28 offset:32768
    ds_read_b128 v[68:71], v29 offset:32768
    ds_read_b128 v[72:75], v30 offset:32768
    ds_read_b128 v[76:79], v31 offset:32768
    v_mfma_f32_16x16x32_bf16 v[192:195], v[80:83], v[32:35], 0
    ds_read_b128 v[80:83], v28 offset:36864
    v_mfma_f32_16x16x32_bf16 v[192:195], v[84:87], v[36:39], v[192:195]
    ds_read_b128 v[84:87], v29 offset:36864
    v_max3_f32 v1, v1, v176, v177
    v_mfma_f32_16x16x32_bf16 v[192:195], v[88:91], v[40:43], v[192:195]
    ds_read_b128 v[88:91], v30 offset:36864
    v_mfma_f32_16x16x32_bf16 v[192:195], v[92:95], v[44:47], v[192:195]
    ds_read_b128 v[92:95], v31 offset:36864
    v_max3_f32 v1, v1, v178, v179
    v_mfma_f32_16x16x32_bf16 v[196:199], v[96:99], v[32:35], 0
    ds_read_b128 v[96:99], v28 offset:40960
    v_mfma_f32_16x16x32_bf16 v[196:199], v[100:103], v[36:39], v[196:199]
    ds_read_b128 v[100:103], v29 offset:40960
    v_max3_f32 v1, v1, v180, v181
    v_mfma_f32_16x16x32_bf16 v[196:199], v[104:107], v[40:43], v[196:199]
    ds_read_b128 v[104:107], v30 offset:40960
    v_mfma_f32_16x16x32_bf16 v[196:199], v[108:111], v[44:47], v[196:199]
    ds_read_b128 v[108:111], v31 offset:40960
    v_max3_f32 v1, v1, v182, v183
    v_mfma_f32_16x16x32_bf16 v[200:203], v[112:115], v[32:35], 0
    ds_read_b128 v[112:115], v28 offset:45056
    v_mfma_f32_16x16x32_bf16 v[200:203], v[116:119], v[36:39], v[200:203]
    ds_read_b128 v[116:119], v29 offset:45056
    v_max3_f32 v1, v1, v184, v185
    v_mfma_f32_16x16x32_bf16 v[200:203], v[120:123], v[40:43], v[200:203]
    ds_read_b128 v[120:123], v30 offset:45056
    v_mfma_f32_16x16x32_bf16 v[200:203], v[124:127], v[44:47], v[200:203]
    s_waitcnt lgkmcnt(12)
    ds_read_b128 v[124:127], v31 offset:45056
    v_max3_f32 v1, v1, v186, v187
    v_mfma_f32_16x16x32_bf16 v[204:207], v[48:51], v[32:35], 0
    v_mfma_f32_16x16x32_bf16 v[204:207], v[52:55], v[36:39], v[204:207]
    v_max3_f32 v1, v1, v188, v189
    v_mfma_f32_16x16x32_bf16 v[204:207], v[56:59], v[40:43], v[204:207]
    v_mfma_f32_16x16x32_bf16 v[204:207], v[60:63], v[44:47], v[204:207]
    v_max3_f32 v1, v1, v190, v191
    s_waitcnt lgkmcnt(0)
    s_waitcnt vmcnt(6)
    s_barrier
    v_add_u32 v28, 0xffff4000, v28
    v_add_u32 v29, 0xffff4000, v29
    v_add_u32 v30, 0xffff4000, v30
    v_add_u32 v31, 0xffff4000, v31
    ds_read_b128 v[48:51], v28 offset:0
    ds_read_b128 v[52:55], v29 offset:0
    ds_read_b128 v[56:59], v30 offset:0
    ds_read_b128 v[60:63], v31 offset:0
    v_mfma_f32_16x16x32_bf16 v[208:211], v[64:67], v[32:35], 0
    ds_read_b128 v[64:67], v28 offset:4096
    v_bfe_u32 v11, v0, 2, 2
    v_mul_u32_u24 v11, 9, v11
    v_and_b32 v9, 3, v0
    v_add_lshl_u32 v11, v11, v9, 7
    s_lshl_b32 s80, s68, 3
    s_add_u32 s80, s80, s4
    s_mul_i32 s80, s80, 4608
    s_mul_i32 s65, s67, 294912
    s_add_u32 s65, s65, s80
    buffer_load_dword v13, v11, s[24:27], s65 offen offset:0
    v_mfma_f32_16x16x32_bf16 v[208:211], v[68:71], v[36:39], v[208:211]
    ds_read_b128 v[68:71], v29 offset:4096
    v_max3_f32 v1, v1, v192, v193
    v_mfma_f32_16x16x32_bf16 v[208:211], v[72:75], v[40:43], v[208:211]
    ds_read_b128 v[72:75], v30 offset:4096
    v_mfma_f32_16x16x32_bf16 v[208:211], v[76:79], v[44:47], v[208:211]
    ds_read_b128 v[76:79], v31 offset:4096
    v_max3_f32 v1, v1, v194, v195
    v_mfma_f32_16x16x32_bf16 v[212:215], v[80:83], v[32:35], 0
    ds_read_b128 v[80:83], v28 offset:8192
    v_mfma_f32_16x16x32_bf16 v[212:215], v[84:87], v[36:39], v[212:215]
    ds_read_b128 v[84:87], v29 offset:8192
    v_max3_f32 v1, v1, v196, v197
    v_mfma_f32_16x16x32_bf16 v[212:215], v[88:91], v[40:43], v[212:215]
    ds_read_b128 v[88:91], v30 offset:8192
    v_mfma_f32_16x16x32_bf16 v[212:215], v[92:95], v[44:47], v[212:215]
    ds_read_b128 v[92:95], v31 offset:8192
    v_max3_f32 v1, v1, v198, v199
    v_mfma_f32_16x16x32_bf16 v[216:219], v[96:99], v[32:35], 0
    ds_read_b128 v[96:99], v28 offset:12288
    v_mfma_f32_16x16x32_bf16 v[216:219], v[100:103], v[36:39], v[216:219]
    ds_read_b128 v[100:103], v29 offset:12288
    v_max3_f32 v1, v1, v200, v201
    v_mfma_f32_16x16x32_bf16 v[216:219], v[104:107], v[40:43], v[216:219]
    ds_read_b128 v[104:107], v30 offset:12288
    v_mfma_f32_16x16x32_bf16 v[216:219], v[108:111], v[44:47], v[216:219]
    s_waitcnt lgkmcnt(12)
    ds_read_b128 v[108:111], v31 offset:12288
    v_max3_f32 v1, v1, v202, v203
    v_mfma_f32_16x16x32_bf16 v[220:223], v[112:115], v[32:35], 0
    v_mfma_f32_16x16x32_bf16 v[220:223], v[116:119], v[36:39], v[220:223]
    v_max3_f32 v1, v1, v204, v205
    v_mfma_f32_16x16x32_bf16 v[220:223], v[120:123], v[40:43], v[220:223]
    v_mfma_f32_16x16x32_bf16 v[220:223], v[124:127], v[44:47], v[220:223]
    v_max3_f32 v1, v1, v206, v207
    s_waitcnt lgkmcnt(0)
    s_waitcnt vmcnt(5)
    s_barrier
    ds_read_b128 v[112:115], v28 offset:16384
    ds_read_b128 v[116:119], v29 offset:16384
    ds_read_b128 v[120:123], v30 offset:16384
    ds_read_b128 v[124:127], v31 offset:16384
    v_mfma_f32_16x16x32_bf16 v[224:227], v[48:51], v[32:35], 0
    ds_read_b128 v[48:51], v28 offset:20480
    s_add_u32 m0, s62, 0
    s_add_u32 s65, s34, 32768
    buffer_load_dwordx4 v4, s[16:19], s65 offen nt lds
    v_mfma_f32_16x16x32_bf16 v[224:227], v[52:55], v[36:39], v[224:227]
    ds_read_b128 v[52:55], v29 offset:20480
    v_max3_f32 v1, v1, v208, v209
    v_mfma_f32_16x16x32_bf16 v[224:227], v[56:59], v[40:43], v[224:227]
    ds_read_b128 v[56:59], v30 offset:20480
    v_mfma_f32_16x16x32_bf16 v[224:227], v[60:63], v[44:47], v[224:227]
    ds_read_b128 v[60:63], v31 offset:20480
    v_max3_f32 v1, v1, v210, v211
    v_mfma_f32_16x16x32_bf16 v[228:231], v[64:67], v[32:35], 0
    ds_read_b128 v[64:67], v28 offset:24576
    v_mfma_f32_16x16x32_bf16 v[228:231], v[68:71], v[36:39], v[228:231]
    ds_read_b128 v[68:71], v29 offset:24576
    v_max3_f32 v1, v1, v212, v213
    v_mfma_f32_16x16x32_bf16 v[228:231], v[72:75], v[40:43], v[228:231]
    ds_read_b128 v[72:75], v30 offset:24576
    v_mfma_f32_16x16x32_bf16 v[228:231], v[76:79], v[44:47], v[228:231]
    ds_read_b128 v[76:79], v31 offset:24576
    v_max3_f32 v1, v1, v214, v215
    v_mfma_f32_16x16x32_bf16 v[232:235], v[80:83], v[32:35], 0
    ds_read_b128 v[80:83], v28 offset:28672
    buffer_load_dwordx4 v5, s[16:19], s65 offen offset:1024 nt lds
    v_mfma_f32_16x16x32_bf16 v[232:235], v[84:87], v[36:39], v[232:235]
    ds_read_b128 v[84:87], v29 offset:28672
    v_max3_f32 v1, v1, v216, v217
    v_mfma_f32_16x16x32_bf16 v[232:235], v[88:91], v[40:43], v[232:235]
    ds_read_b128 v[88:91], v30 offset:28672
    v_mfma_f32_16x16x32_bf16 v[232:235], v[92:95], v[44:47], v[232:235]
    s_waitcnt lgkmcnt(12)
    ds_read_b128 v[92:95], v31 offset:28672
    v_max3_f32 v1, v1, v218, v219
    v_mfma_f32_16x16x32_bf16 v[236:239], v[96:99], v[32:35], 0
    v_mfma_f32_16x16x32_bf16 v[236:239], v[100:103], v[36:39], v[236:239]
    v_max3_f32 v1, v1, v220, v221
    v_mfma_f32_16x16x32_bf16 v[236:239], v[104:107], v[40:43], v[236:239]
    v_mfma_f32_16x16x32_bf16 v[236:239], v[108:111], v[44:47], v[236:239]
    v_max3_f32 v1, v1, v222, v223
    s_waitcnt lgkmcnt(0)
    v_mfma_f32_16x16x32_bf16 v[240:243], v[112:115], v[32:35], 0
    v_max3_f32 v1, v1, v224, v225
    v_mfma_f32_16x16x32_bf16 v[240:243], v[116:119], v[36:39], v[240:243]
    v_max3_f32 v1, v1, v226, v227
    v_mfma_f32_16x16x32_bf16 v[240:243], v[120:123], v[40:43], v[240:243]
    v_max3_f32 v1, v1, v228, v229
    v_mfma_f32_16x16x32_bf16 v[240:243], v[124:127], v[44:47], v[240:243]
    v_max3_f32 v1, v1, v230, v231
    v_mfma_f32_16x16x32_bf16 v[244:247], v[48:51], v[32:35], 0
    v_max3_f32 v1, v1, v232, v233
    v_mfma_f32_16x16x32_bf16 v[244:247], v[52:55], v[36:39], v[244:247]
    v_max3_f32 v1, v1, v234, v235
    v_mfma_f32_16x16x32_bf16 v[244:247], v[56:59], v[40:43], v[244:247]
    v_max3_f32 v1, v1, v236, v237
    v_mfma_f32_16x16x32_bf16 v[244:247], v[60:63], v[44:47], v[244:247]
    v_max3_f32 v1, v1, v238, v239
    v_mfma_f32_16x16x32_bf16 v[248:251], v[64:67], v[32:35], 0
    v_mfma_f32_16x16x32_bf16 v[248:251], v[68:71], v[36:39], v[248:251]
    v_mfma_f32_16x16x32_bf16 v[248:251], v[72:75], v[40:43], v[248:251]
    v_mfma_f32_16x16x32_bf16 v[248:251], v[76:79], v[44:47], v[248:251]
    v_mfma_f32_16x16x32_bf16 v[252:255], v[80:83], v[32:35], 0
    v_mfma_f32_16x16x32_bf16 v[252:255], v[84:87], v[36:39], v[252:255]
    v_mfma_f32_16x16x32_bf16 v[252:255], v[88:91], v[40:43], v[252:255]
    v_mfma_f32_16x16x32_bf16 v[252:255], v[92:95], v[44:47], v[252:255]
    v_max3_f32 v1, v1, v240, v241
    v_max3_f32 v1, v1, v242, v243
    v_max3_f32 v1, v1, v244, v245
    v_max3_f32 v1, v1, v246, v247
    v_max3_f32 v1, v1, v248, v249
    v_max3_f32 v1, v1, v250, v251
    s_nop 1
    v_max3_f32 v1, v1, v252, v253
    v_max3_f32 v1, v1, v254, v255
    v_mov_b32 v2, v1
    s_nop 1
    v_permlane16_swap_b32 v1, v2
    v_max_f32 v1, v1, v2
    v_mov_b32 v2, v1
    s_nop 1
    v_permlane32_swap_b32 v1, v2
    v_max_f32 v1, v1, v2
    v_mul_f32 v2, s63, v1
    v_fma_f32 v128, v128, s63, -v2
    v_fma_f32 v129, v129, s63, -v2
    v_fma_f32 v130, v130, s63, -v2
    v_fma_f32 v131, v131, s63, -v2
    v_exp_f32 v128, v128
    v_exp_f32 v129, v129
    v_exp_f32 v130, v130
    v_exp_f32 v131, v131
    v_fma_f32 v132, v132, s63, -v2
    v_fma_f32 v133, v133, s63, -v2
    v_fma_f32 v134, v134, s63, -v2
    v_fma_f32 v135, v135, s63, -v2
    v_exp_f32 v132, v132
    v_exp_f32 v133, v133
    v_exp_f32 v134, v134
    v_exp_f32 v135, v135
    v_cvt_pk_bf16_f32 v128, v128, v129
    v_cvt_pk_bf16_f32 v129, v130, v131
    v_fma_f32 v136, v136, s63, -v2
    v_fma_f32 v137, v137, s63, -v2
    v_fma_f32 v138, v138, s63, -v2
    v_fma_f32 v139, v139, s63, -v2
    v_exp_f32 v136, v136
    v_exp_f32 v137, v137
    v_exp_f32 v138, v138
    v_exp_f32 v139, v139
    v_cvt_pk_bf16_f32 v130, v132, v133
    v_cvt_pk_bf16_f32 v131, v134, v135
    v_fma_f32 v140, v140, s63, -v2
    v_fma_f32 v141, v141, s63, -v2
    v_fma_f32 v142, v142, s63, -v2
    v_fma_f32 v143, v143, s63, -v2
    v_exp_f32 v140, v140
    v_exp_f32 v141, v141
    v_exp_f32 v142, v142
    v_exp_f32 v143, v143
    v_cvt_pk_bf16_f32 v132, v136, v137
    v_cvt_pk_bf16_f32 v133, v138, v139
    v_cvt_pk_bf16_f32 v134, v140, v141
    v_cvt_pk_bf16_f32 v135, v142, v143
    v_mov_b32 v140, 0x3f803f80
    v_mov_b32 v141, 0x3f803f80
    v_mov_b32 v142, 0x3f803f80
    v_mov_b32 v143, 0x3f803f80
    s_waitcnt vmcnt(5)
    s_barrier
    ds_read_b64_tr_b16 v[64:65], v16 offset:32768
    ds_read_b64_tr_b16 v[66:67], v16 offset:36864
    ds_read_b64_tr_b16 v[68:69], v17 offset:32768
    ds_read_b64_tr_b16 v[70:71], v17 offset:36864
    ds_read_b64_tr_b16 v[72:73], v18 offset:32768
    ds_read_b64_tr_b16 v[74:75], v18 offset:36864
    ds_read_b64_tr_b16 v[76:77], v19 offset:32768
    ds_read_b64_tr_b16 v[78:79], v19 offset:36864
    ds_read_b64_tr_b16 v[80:81], v20 offset:32768
    ds_read_b64_tr_b16 v[82:83], v20 offset:36864
    ds_read_b64_tr_b16 v[84:85], v21 offset:32768
    ds_read_b64_tr_b16 v[86:87], v21 offset:36864
    ds_read_b64_tr_b16 v[88:89], v22 offset:32768
    ds_read_b64_tr_b16 v[90:91], v22 offset:36864
    v_fma_f32 v144, v144, s63, -v2
    v_fma_f32 v145, v145, s63, -v2
    v_fma_f32 v146, v146, s63, -v2
    v_fma_f32 v147, v147, s63, -v2
    v_mfma_f32_16x16x32_bf16 v[136:139], v[140:143], v[128:131], 0
    s_mov_b64 s[84:85], s[58:59]
    s_mov_b32 s86, 256
    s_mov_b32 s87, 0x20000
    s_lshl_b32 s70, s7, 3
    s_add_u32 s70, s70, s68
    s_lshl_b32 s73, s70, 12
    s_add_u32 s73, s73, 0x1400000
    s_lshl_b32 s71, s67, 8
    s_add_u32 s71, s71, s73
    s_lshl_b32 s82, s70, 4
    v_min_u32 v29, 1, v0
    v_lshlrev_b32 v29, 30, v29
    v_mov_b32 v28, 0
    buffer_atomic_add v28, v29, s[28:31], s71 offen sc0 sc1
    v_exp_f32 v144, v144
    v_exp_f32 v145, v145
    v_mfma_f32_16x16x32_bf16 v[136:139], v[140:143], v[132:135], v[136:139]
    v_exp_f32 v146, v146
    v_exp_f32 v147, v147
    s_waitcnt lgkmcnt(10)
    v_mfma_f32_16x16x32_bf16 v[32:35], v[64:67], v[128:131], 0
    ds_read_b64_tr_b16 v[92:93], v23 offset:32768
    ds_read_b64_tr_b16 v[94:95], v23 offset:36864
    ds_read_b64_tr_b16 v[96:97], v16 offset:40960
    ds_read_b64_tr_b16 v[98:99], v16 offset:45056
    v_fma_f32 v148, v148, s63, -v2
    v_fma_f32 v149, v149, s63, -v2
    v_mfma_f32_16x16x32_bf16 v[36:39], v[68:71], v[128:131], 0
    v_fma_f32 v150, v150, s63, -v2
    v_fma_f32 v151, v151, s63, -v2
    s_waitcnt lgkmcnt(10)
    v_mfma_f32_16x16x32_bf16 v[40:43], v[72:75], v[128:131], 0
    ds_read_b64_tr_b16 v[100:101], v17 offset:40960
    ds_read_b64_tr_b16 v[102:103], v17 offset:45056
    ds_read_b64_tr_b16 v[104:105], v18 offset:40960
    ds_read_b64_tr_b16 v[106:107], v18 offset:45056
    s_add_u32 m0, s62, 16384
    s_add_u32 s65, s34, 49152
    buffer_load_dwordx4 v4, s[16:19], s65 offen nt lds
    v_exp_f32 v148, v148
    v_exp_f32 v149, v149
    v_mfma_f32_16x16x32_bf16 v[44:47], v[76:79], v[128:131], 0
    v_exp_f32 v150, v150
    v_exp_f32 v151, v151
    s_waitcnt lgkmcnt(10)
    v_mfma_f32_16x16x32_bf16 v[48:51], v[80:83], v[128:131], 0
    ds_read_b64_tr_b16 v[108:109], v19 offset:40960
    ds_read_b64_tr_b16 v[110:111], v19 offset:45056
    ds_read_b64_tr_b16 v[112:113], v20 offset:40960
    ds_read_b64_tr_b16 v[114:115], v20 offset:45056
    v_cvt_pk_bf16_f32 v144, v144, v145
    v_cvt_pk_bf16_f32 v145, v146, v147
    v_mfma_f32_16x16x32_bf16 v[52:55], v[84:87], v[128:131], 0
    v_fma_f32 v152, v152, s63, -v2
    v_fma_f32 v153, v153, s63, -v2
    s_waitcnt lgkmcnt(10)
    v_mfma_f32_16x16x32_bf16 v[56:59], v[88:91], v[128:131], 0
    ds_read_b64_tr_b16 v[116:117], v21 offset:40960
    ds_read_b64_tr_b16 v[118:119], v21 offset:45056
    ds_read_b64_tr_b16 v[120:121], v22 offset:40960
    ds_read_b64_tr_b16 v[122:123], v22 offset:45056
    buffer_load_dwordx4 v5, s[16:19], s65 offen offset:1024 nt lds
    v_fma_f32 v154, v154, s63, -v2
    v_fma_f32 v155, v155, s63, -v2
    v_mfma_f32_16x16x32_bf16 v[60:63], v[92:95], v[128:131], 0
    v_exp_f32 v152, v152
    v_exp_f32 v153, v153
    s_waitcnt lgkmcnt(10)
    v_mfma_f32_16x16x32_bf16 v[32:35], v[96:99], v[132:135], v[32:35]
    ds_read_b64_tr_b16 v[124:125], v23 offset:40960
    ds_read_b64_tr_b16 v[126:127], v23 offset:45056
    v_exp_f32 v154, v154
    v_exp_f32 v155, v155
    v_mfma_f32_16x16x32_bf16 v[36:39], v[100:103], v[132:135], v[36:39]
    v_cvt_pk_bf16_f32 v146, v148, v149
    v_cvt_pk_bf16_f32 v147, v150, v151
    s_waitcnt lgkmcnt(8)
    v_mfma_f32_16x16x32_bf16 v[40:43], v[104:107], v[132:135], v[40:43]
    v_fma_f32 v156, v156, s63, -v2
    v_fma_f32 v157, v157, s63, -v2
    v_mfma_f32_16x16x32_bf16 v[44:47], v[108:111], v[132:135], v[44:47]
    v_fma_f32 v158, v158, s63, -v2
    v_fma_f32 v159, v159, s63, -v2
    s_waitcnt lgkmcnt(4)
    v_mfma_f32_16x16x32_bf16 v[48:51], v[112:115], v[132:135], v[48:51]
    v_exp_f32 v156, v156
    v_exp_f32 v157, v157
    v_mfma_f32_16x16x32_bf16 v[52:55], v[116:119], v[132:135], v[52:55]
    v_exp_f32 v158, v158
    v_exp_f32 v159, v159
    s_waitcnt lgkmcnt(0)
    v_mfma_f32_16x16x32_bf16 v[56:59], v[120:123], v[132:135], v[56:59]
    v_cvt_pk_bf16_f32 v148, v152, v153
    v_cvt_pk_bf16_f32 v149, v154, v155
    v_mfma_f32_16x16x32_bf16 v[60:63], v[124:127], v[132:135], v[60:63]
    v_cvt_pk_bf16_f32 v150, v156, v157
    v_cvt_pk_bf16_f32 v151, v158, v159
    s_add_u32 m0, s62, 98304
    s_add_u32 s65, s35, 0
    buffer_load_dwordx4 v6, s[24:27], s65 offen lds
    buffer_load_dwordx4 v7, s[24:27], s65 offen offset:1024 lds
    s_add_u32 m0, s62, 114688
    s_add_u32 s65, s35, 73728
    buffer_load_dwordx4 v6, s[24:27], s65 offen lds
    buffer_load_dwordx4 v7, s[24:27], s65 offen offset:1024 lds
    v_add_u32 v16, 0xc000, v16
    v_add_u32 v17, 0xc000, v17
    v_add_u32 v18, 0xc000, v18
    v_add_u32 v19, 0xc000, v19
    v_add_u32 v20, 0xc000, v20
    v_add_u32 v21, 0xc000, v21
    v_add_u32 v22, 0xc000, v22
    v_add_u32 v23, 0xc000, v23
    s_waitcnt vmcnt(9)
    s_barrier
    ds_read_b64_tr_b16 v[64:65], v16 offset:0
    ds_read_b64_tr_b16 v[66:67], v16 offset:4096
    ds_read_b64_tr_b16 v[68:69], v17 offset:0
    ds_read_b64_tr_b16 v[70:71], v17 offset:4096
    ds_read_b64_tr_b16 v[72:73], v18 offset:0
    ds_read_b64_tr_b16 v[74:75], v18 offset:4096
    ds_read_b64_tr_b16 v[76:77], v19 offset:0
    ds_read_b64_tr_b16 v[78:79], v19 offset:4096
    ds_read_b64_tr_b16 v[80:81], v20 offset:0
    ds_read_b64_tr_b16 v[82:83], v20 offset:4096
    ds_read_b64_tr_b16 v[84:85], v21 offset:0
    ds_read_b64_tr_b16 v[86:87], v21 offset:4096
    ds_read_b64_tr_b16 v[88:89], v22 offset:0
    ds_read_b64_tr_b16 v[90:91], v22 offset:4096
    v_fma_f32 v160, v160, s63, -v2
    v_fma_f32 v161, v161, s63, -v2
    v_fma_f32 v162, v162, s63, -v2
    v_fma_f32 v163, v163, s63, -v2
    v_mfma_f32_16x16x32_bf16 v[136:139], v[140:143], v[144:147], v[136:139]
    s_add_u32 m0, s62, 32768
    s_add_u32 s65, s34, 65536
    buffer_load_dwordx4 v4, s[16:19], s65 offen nt lds
    v_exp_f32 v160, v160
    v_exp_f32 v161, v161
    v_mfma_f32_16x16x32_bf16 v[136:139], v[140:143], v[148:151], v[136:139]
    v_exp_f32 v162, v162
    v_exp_f32 v163, v163
    s_waitcnt lgkmcnt(10)
    v_mfma_f32_16x16x32_bf16 v[32:35], v[64:67], v[144:147], v[32:35]
    ds_read_b64_tr_b16 v[92:93], v23 offset:0
    ds_read_b64_tr_b16 v[94:95], v23 offset:4096
    ds_read_b64_tr_b16 v[96:97], v16 offset:8192
    ds_read_b64_tr_b16 v[98:99], v16 offset:12288
    v_fma_f32 v164, v164, s63, -v2
    v_fma_f32 v165, v165, s63, -v2
    v_mfma_f32_16x16x32_bf16 v[36:39], v[68:71], v[144:147], v[36:39]
    v_fma_f32 v166, v166, s63, -v2
    v_fma_f32 v167, v167, s63, -v2
    s_waitcnt lgkmcnt(10)
    v_mfma_f32_16x16x32_bf16 v[40:43], v[72:75], v[144:147], v[40:43]
    ds_read_b64_tr_b16 v[100:101], v17 offset:8192
    ds_read_b64_tr_b16 v[102:103], v17 offset:12288
    ds_read_b64_tr_b16 v[104:105], v18 offset:8192
    ds_read_b64_tr_b16 v[106:107], v18 offset:12288
    v_exp_f32 v164, v164
    v_exp_f32 v165, v165
    v_mfma_f32_16x16x32_bf16 v[44:47], v[76:79], v[144:147], v[44:47]
    v_exp_f32 v166, v166
    v_exp_f32 v167, v167
    s_waitcnt lgkmcnt(10)
    v_mfma_f32_16x16x32_bf16 v[48:51], v[80:83], v[144:147], v[48:51]
    ds_read_b64_tr_b16 v[108:109], v19 offset:8192
    ds_read_b64_tr_b16 v[110:111], v19 offset:12288
    ds_read_b64_tr_b16 v[112:113], v20 offset:8192
    ds_read_b64_tr_b16 v[114:115], v20 offset:12288
    buffer_load_dwordx4 v5, s[16:19], s65 offen offset:1024 nt lds
    v_cvt_pk_bf16_f32 v160, v160, v161
    v_cvt_pk_bf16_f32 v161, v162, v163
    v_mfma_f32_16x16x32_bf16 v[52:55], v[84:87], v[144:147], v[52:55]
    v_fma_f32 v168, v168, s63, -v2
    v_fma_f32 v169, v169, s63, -v2
    s_waitcnt lgkmcnt(10)
    v_mfma_f32_16x16x32_bf16 v[56:59], v[88:91], v[144:147], v[56:59]
    ds_read_b64_tr_b16 v[116:117], v21 offset:8192
    ds_read_b64_tr_b16 v[118:119], v21 offset:12288
    ds_read_b64_tr_b16 v[120:121], v22 offset:8192
    ds_read_b64_tr_b16 v[122:123], v22 offset:12288
    v_fma_f32 v170, v170, s63, -v2
    v_fma_f32 v171, v171, s63, -v2
    v_mfma_f32_16x16x32_bf16 v[60:63], v[92:95], v[144:147], v[60:63]
    v_exp_f32 v168, v168
    v_exp_f32 v169, v169
    s_waitcnt lgkmcnt(10)
    v_mfma_f32_16x16x32_bf16 v[32:35], v[96:99], v[148:151], v[32:35]
    ds_read_b64_tr_b16 v[124:125], v23 offset:8192
    ds_read_b64_tr_b16 v[126:127], v23 offset:12288
    v_exp_f32 v170, v170
    v_exp_f32 v171, v171
    v_mfma_f32_16x16x32_bf16 v[36:39], v[100:103], v[148:151], v[36:39]
    v_cvt_pk_bf16_f32 v162, v164, v165
    v_cvt_pk_bf16_f32 v163, v166, v167
    s_waitcnt lgkmcnt(8)
    v_mfma_f32_16x16x32_bf16 v[40:43], v[104:107], v[148:151], v[40:43]
    v_fma_f32 v172, v172, s63, -v2
    v_fma_f32 v173, v173, s63, -v2
    v_mfma_f32_16x16x32_bf16 v[44:47], v[108:111], v[148:151], v[44:47]
    v_fma_f32 v174, v174, s63, -v2
    v_fma_f32 v175, v175, s63, -v2
    s_waitcnt lgkmcnt(4)
    v_mfma_f32_16x16x32_bf16 v[48:51], v[112:115], v[148:151], v[48:51]
    v_exp_f32 v172, v172
    v_exp_f32 v173, v173
    v_mfma_f32_16x16x32_bf16 v[52:55], v[116:119], v[148:151], v[52:55]
    v_exp_f32 v174, v174
    v_exp_f32 v175, v175
    s_waitcnt lgkmcnt(0)
    v_mfma_f32_16x16x32_bf16 v[56:59], v[120:123], v[148:151], v[56:59]
    v_cvt_pk_bf16_f32 v164, v168, v169
    v_cvt_pk_bf16_f32 v165, v170, v171
    v_mfma_f32_16x16x32_bf16 v[60:63], v[124:127], v[148:151], v[60:63]
    v_cvt_pk_bf16_f32 v166, v172, v173
    v_cvt_pk_bf16_f32 v167, v174, v175
    v_add_u32 v16, 0xffff4000, v16
    v_add_u32 v17, 0xffff4000, v17
    v_add_u32 v18, 0xffff4000, v18
    v_add_u32 v19, 0xffff4000, v19
    v_add_u32 v20, 0xffff4000, v20
    v_add_u32 v21, 0xffff4000, v21
    v_add_u32 v22, 0xffff4000, v22
    v_add_u32 v23, 0xffff4000, v23
    s_waitcnt vmcnt(8)
    s_barrier
    ds_read_b64_tr_b16 v[64:65], v16 offset:0
    ds_read_b64_tr_b16 v[66:67], v16 offset:4096
    ds_read_b64_tr_b16 v[68:69], v17 offset:0
    ds_read_b64_tr_b16 v[70:71], v17 offset:4096
    ds_read_b64_tr_b16 v[72:73], v18 offset:0
    ds_read_b64_tr_b16 v[74:75], v18 offset:4096
    ds_read_b64_tr_b16 v[76:77], v19 offset:0
    ds_read_b64_tr_b16 v[78:79], v19 offset:4096
    ds_read_b64_tr_b16 v[80:81], v20 offset:0
    ds_read_b64_tr_b16 v[82:83], v20 offset:4096
    ds_read_b64_tr_b16 v[84:85], v21 offset:0
    ds_read_b64_tr_b16 v[86:87], v21 offset:4096
    ds_read_b64_tr_b16 v[88:89], v22 offset:0
    ds_read_b64_tr_b16 v[90:91], v22 offset:4096
    v_fma_f32 v176, v176, s63, -v2
    v_fma_f32 v177, v177, s63, -v2
    v_fma_f32 v178, v178, s63, -v2
    v_fma_f32 v179, v179, s63, -v2
    v_mfma_f32_16x16x32_bf16 v[136:139], v[140:143], v[160:163], v[136:139]
    s_add_u32 m0, s62, 49152
    s_add_u32 s65, s34, 81920
    buffer_load_dwordx4 v4, s[16:19], s65 offen nt lds
    v_exp_f32 v176, v176
    v_exp_f32 v177, v177
    v_mfma_f32_16x16x32_bf16 v[136:139], v[140:143], v[164:167], v[136:139]
    v_exp_f32 v178, v178
    v_exp_f32 v179, v179
    s_waitcnt lgkmcnt(10)
    v_mfma_f32_16x16x32_bf16 v[32:35], v[64:67], v[160:163], v[32:35]
    ds_read_b64_tr_b16 v[92:93], v23 offset:0
    ds_read_b64_tr_b16 v[94:95], v23 offset:4096
    ds_read_b64_tr_b16 v[96:97], v16 offset:8192
    ds_read_b64_tr_b16 v[98:99], v16 offset:12288
    v_fma_f32 v180, v180, s63, -v2
    v_fma_f32 v181, v181, s63, -v2
    v_mfma_f32_16x16x32_bf16 v[36:39], v[68:71], v[160:163], v[36:39]
    v_fma_f32 v182, v182, s63, -v2
    v_fma_f32 v183, v183, s63, -v2
    s_waitcnt lgkmcnt(10)
    v_mfma_f32_16x16x32_bf16 v[40:43], v[72:75], v[160:163], v[40:43]
    ds_read_b64_tr_b16 v[100:101], v17 offset:8192
    ds_read_b64_tr_b16 v[102:103], v17 offset:12288
    ds_read_b64_tr_b16 v[104:105], v18 offset:8192
    ds_read_b64_tr_b16 v[106:107], v18 offset:12288
    v_exp_f32 v180, v180
    v_exp_f32 v181, v181
    v_mfma_f32_16x16x32_bf16 v[44:47], v[76:79], v[160:163], v[44:47]
    v_exp_f32 v182, v182
    v_exp_f32 v183, v183
    s_waitcnt lgkmcnt(10)
    v_mfma_f32_16x16x32_bf16 v[48:51], v[80:83], v[160:163], v[48:51]
    ds_read_b64_tr_b16 v[108:109], v19 offset:8192
    ds_read_b64_tr_b16 v[110:111], v19 offset:12288
    ds_read_b64_tr_b16 v[112:113], v20 offset:8192
    ds_read_b64_tr_b16 v[114:115], v20 offset:12288
    buffer_load_dwordx4 v5, s[16:19], s65 offen offset:1024 nt lds
    v_cvt_pk_bf16_f32 v176, v176, v177
    v_cvt_pk_bf16_f32 v177, v178, v179
    v_mfma_f32_16x16x32_bf16 v[52:55], v[84:87], v[160:163], v[52:55]
    v_fma_f32 v184, v184, s63, -v2
    v_fma_f32 v185, v185, s63, -v2
    s_waitcnt lgkmcnt(10)
    v_mfma_f32_16x16x32_bf16 v[56:59], v[88:91], v[160:163], v[56:59]
    ds_read_b64_tr_b16 v[116:117], v21 offset:8192
    ds_read_b64_tr_b16 v[118:119], v21 offset:12288
    ds_read_b64_tr_b16 v[120:121], v22 offset:8192
    ds_read_b64_tr_b16 v[122:123], v22 offset:12288
    v_fma_f32 v186, v186, s63, -v2
    v_fma_f32 v187, v187, s63, -v2
    v_mfma_f32_16x16x32_bf16 v[60:63], v[92:95], v[160:163], v[60:63]
    v_exp_f32 v184, v184
    v_exp_f32 v185, v185
    s_waitcnt lgkmcnt(10)
    v_mfma_f32_16x16x32_bf16 v[32:35], v[96:99], v[164:167], v[32:35]
    ds_read_b64_tr_b16 v[124:125], v23 offset:8192
    ds_read_b64_tr_b16 v[126:127], v23 offset:12288
    v_exp_f32 v186, v186
    v_exp_f32 v187, v187
    v_mfma_f32_16x16x32_bf16 v[36:39], v[100:103], v[164:167], v[36:39]
    v_cvt_pk_bf16_f32 v178, v180, v181
    v_cvt_pk_bf16_f32 v179, v182, v183
    s_waitcnt lgkmcnt(8)
    v_mfma_f32_16x16x32_bf16 v[40:43], v[104:107], v[164:167], v[40:43]
    v_fma_f32 v188, v188, s63, -v2
    v_fma_f32 v189, v189, s63, -v2
    v_mfma_f32_16x16x32_bf16 v[44:47], v[108:111], v[164:167], v[44:47]
    v_fma_f32 v190, v190, s63, -v2
    v_fma_f32 v191, v191, s63, -v2
    s_waitcnt lgkmcnt(4)
    v_mfma_f32_16x16x32_bf16 v[48:51], v[112:115], v[164:167], v[48:51]
    v_exp_f32 v188, v188
    v_exp_f32 v189, v189
    v_mfma_f32_16x16x32_bf16 v[52:55], v[116:119], v[164:167], v[52:55]
    v_exp_f32 v190, v190
    v_exp_f32 v191, v191
    s_waitcnt lgkmcnt(0)
    v_mfma_f32_16x16x32_bf16 v[56:59], v[120:123], v[164:167], v[56:59]
    v_cvt_pk_bf16_f32 v180, v184, v185
    v_cvt_pk_bf16_f32 v181, v186, v187
    v_mfma_f32_16x16x32_bf16 v[60:63], v[124:127], v[164:167], v[60:63]
    v_cvt_pk_bf16_f32 v182, v188, v189
    v_cvt_pk_bf16_f32 v183, v190, v191
    s_add_u32 m0, s62, 131072
    s_add_u32 s65, s35, 147456
    buffer_load_dwordx4 v6, s[24:27], s65 offen lds
    buffer_load_dwordx4 v7, s[24:27], s65 offen offset:1024 lds
    s_add_u32 m0, s62, 147456
    s_add_u32 s65, s35, 221184
    buffer_load_dwordx4 v6, s[24:27], s65 offen lds
    buffer_load_dwordx4 v7, s[24:27], s65 offen offset:1024 lds
    s_waitcnt vmcnt(12)
    s_barrier
    ds_read_b64_tr_b16 v[64:65], v16 offset:16384
    ds_read_b64_tr_b16 v[66:67], v16 offset:20480
    ds_read_b64_tr_b16 v[68:69], v17 offset:16384
    ds_read_b64_tr_b16 v[70:71], v17 offset:20480
    ds_read_b64_tr_b16 v[72:73], v18 offset:16384
    ds_read_b64_tr_b16 v[74:75], v18 offset:20480
    ds_read_b64_tr_b16 v[76:77], v19 offset:16384
    ds_read_b64_tr_b16 v[78:79], v19 offset:20480
    ds_read_b64_tr_b16 v[80:81], v20 offset:16384
    ds_read_b64_tr_b16 v[82:83], v20 offset:20480
    ds_read_b64_tr_b16 v[84:85], v21 offset:16384
    ds_read_b64_tr_b16 v[86:87], v21 offset:20480
    ds_read_b64_tr_b16 v[88:89], v22 offset:16384
    ds_read_b64_tr_b16 v[90:91], v22 offset:20480
    v_fma_f32 v192, v192, s63, -v2
    v_fma_f32 v193, v193, s63, -v2
    v_fma_f32 v194, v194, s63, -v2
    v_fma_f32 v195, v195, s63, -v2
    v_mfma_f32_16x16x32_bf16 v[136:139], v[140:143], v[176:179], v[136:139]
    s_add_u32 m0, s62, 0
    s_add_u32 s65, s34, 98304
    buffer_load_dwordx4 v4, s[16:19], s65 offen nt lds
    v_exp_f32 v192, v192
    v_exp_f32 v193, v193
    v_mfma_f32_16x16x32_bf16 v[136:139], v[140:143], v[180:183], v[136:139]
    v_exp_f32 v194, v194
    v_exp_f32 v195, v195
    s_waitcnt lgkmcnt(10)
    v_mfma_f32_16x16x32_bf16 v[32:35], v[64:67], v[176:179], v[32:35]
    ds_read_b64_tr_b16 v[92:93], v23 offset:16384
    ds_read_b64_tr_b16 v[94:95], v23 offset:20480
    ds_read_b64_tr_b16 v[96:97], v16 offset:24576
    ds_read_b64_tr_b16 v[98:99], v16 offset:28672
    v_fma_f32 v196, v196, s63, -v2
    v_fma_f32 v197, v197, s63, -v2
    v_mfma_f32_16x16x32_bf16 v[36:39], v[68:71], v[176:179], v[36:39]
    v_fma_f32 v198, v198, s63, -v2
    v_fma_f32 v199, v199, s63, -v2
    s_waitcnt lgkmcnt(10)
    v_mfma_f32_16x16x32_bf16 v[40:43], v[72:75], v[176:179], v[40:43]
    ds_read_b64_tr_b16 v[100:101], v17 offset:24576
    ds_read_b64_tr_b16 v[102:103], v17 offset:28672
    ds_read_b64_tr_b16 v[104:105], v18 offset:24576
    ds_read_b64_tr_b16 v[106:107], v18 offset:28672
    v_exp_f32 v196, v196
    v_exp_f32 v197, v197
    v_mfma_f32_16x16x32_bf16 v[44:47], v[76:79], v[176:179], v[44:47]
    v_exp_f32 v198, v198
    v_exp_f32 v199, v199
    s_waitcnt lgkmcnt(10)
    v_mfma_f32_16x16x32_bf16 v[48:51], v[80:83], v[176:179], v[48:51]
    ds_read_b64_tr_b16 v[108:109], v19 offset:24576
    ds_read_b64_tr_b16 v[110:111], v19 offset:28672
    ds_read_b64_tr_b16 v[112:113], v20 offset:24576
    ds_read_b64_tr_b16 v[114:115], v20 offset:28672
    buffer_load_dwordx4 v5, s[16:19], s65 offen offset:1024 nt lds
    v_cvt_pk_bf16_f32 v192, v192, v193
    v_cvt_pk_bf16_f32 v193, v194, v195
    v_mfma_f32_16x16x32_bf16 v[52:55], v[84:87], v[176:179], v[52:55]
    v_fma_f32 v200, v200, s63, -v2
    v_fma_f32 v201, v201, s63, -v2
    s_waitcnt lgkmcnt(10)
    v_mfma_f32_16x16x32_bf16 v[56:59], v[88:91], v[176:179], v[56:59]
    ds_read_b64_tr_b16 v[116:117], v21 offset:24576
    ds_read_b64_tr_b16 v[118:119], v21 offset:28672
    ds_read_b64_tr_b16 v[120:121], v22 offset:24576
    ds_read_b64_tr_b16 v[122:123], v22 offset:28672
    v_fma_f32 v202, v202, s63, -v2
    v_fma_f32 v203, v203, s63, -v2
    v_mfma_f32_16x16x32_bf16 v[60:63], v[92:95], v[176:179], v[60:63]
    v_exp_f32 v200, v200
    v_exp_f32 v201, v201
    s_waitcnt lgkmcnt(10)
    v_mfma_f32_16x16x32_bf16 v[32:35], v[96:99], v[180:183], v[32:35]
    ds_read_b64_tr_b16 v[124:125], v23 offset:24576
    ds_read_b64_tr_b16 v[126:127], v23 offset:28672
    v_exp_f32 v202, v202
    v_exp_f32 v203, v203
    v_mfma_f32_16x16x32_bf16 v[36:39], v[100:103], v[180:183], v[36:39]
    v_cvt_pk_bf16_f32 v194, v196, v197
    v_cvt_pk_bf16_f32 v195, v198, v199
    s_waitcnt lgkmcnt(8)
    v_mfma_f32_16x16x32_bf16 v[40:43], v[104:107], v[180:183], v[40:43]
    v_fma_f32 v204, v204, s63, -v2
    v_fma_f32 v205, v205, s63, -v2
    v_mfma_f32_16x16x32_bf16 v[44:47], v[108:111], v[180:183], v[44:47]
    v_fma_f32 v206, v206, s63, -v2
    v_fma_f32 v207, v207, s63, -v2
    s_waitcnt lgkmcnt(4)
    v_mfma_f32_16x16x32_bf16 v[48:51], v[112:115], v[180:183], v[48:51]
    v_exp_f32 v204, v204
    v_exp_f32 v205, v205
    v_mfma_f32_16x16x32_bf16 v[52:55], v[116:119], v[180:183], v[52:55]
    v_exp_f32 v206, v206
    v_exp_f32 v207, v207
    s_waitcnt lgkmcnt(0)
    v_mfma_f32_16x16x32_bf16 v[56:59], v[120:123], v[180:183], v[56:59]
    v_cvt_pk_bf16_f32 v196, v200, v201
    v_cvt_pk_bf16_f32 v197, v202, v203
    v_mfma_f32_16x16x32_bf16 v[60:63], v[124:127], v[180:183], v[60:63]
    v_cvt_pk_bf16_f32 v198, v204, v205
    v_cvt_pk_bf16_f32 v199, v206, v207
    s_waitcnt vmcnt(8)
    s_barrier
    ds_read_b64_tr_b16 v[64:65], v16 offset:32768
    ds_read_b64_tr_b16 v[66:67], v16 offset:36864
    ds_read_b64_tr_b16 v[68:69], v17 offset:32768
    ds_read_b64_tr_b16 v[70:71], v17 offset:36864
    ds_read_b64_tr_b16 v[72:73], v18 offset:32768
    ds_read_b64_tr_b16 v[74:75], v18 offset:36864
    ds_read_b64_tr_b16 v[76:77], v19 offset:32768
    ds_read_b64_tr_b16 v[78:79], v19 offset:36864
    ds_read_b64_tr_b16 v[80:81], v20 offset:32768
    ds_read_b64_tr_b16 v[82:83], v20 offset:36864
    ds_read_b64_tr_b16 v[84:85], v21 offset:32768
    ds_read_b64_tr_b16 v[86:87], v21 offset:36864
    ds_read_b64_tr_b16 v[88:89], v22 offset:32768
    ds_read_b64_tr_b16 v[90:91], v22 offset:36864
    v_fma_f32 v208, v208, s63, -v2
    v_fma_f32 v209, v209, s63, -v2
    v_fma_f32 v210, v210, s63, -v2
    v_fma_f32 v211, v211, s63, -v2
    v_mfma_f32_16x16x32_bf16 v[136:139], v[140:143], v[192:195], v[136:139]
    v_bfe_u32 v11, v0, 3, 2
    v_mul_u32_u24 v11, 9, v11
    v_and_b32 v9, 7, v0
    v_min_u32 v9, 4, v9
    v_add_lshl_u32 v11, v11, v9, 7
    s_lshl_b32 s80, s68, 3
    s_add_u32 s80, s80, s4
    s_mul_i32 s80, s80, 4608
    s_mul_i32 s65, s67, 294912
    s_add_u32 s65, s65, s80
    buffer_load_dword v13, v11, s[24:27], s65 offen offset:512
    v_exp_f32 v208, v208
    v_exp_f32 v209, v209
    v_mfma_f32_16x16x32_bf16 v[136:139], v[140:143], v[196:199], v[136:139]
    v_exp_f32 v210, v210
    v_exp_f32 v211, v211
    s_waitcnt lgkmcnt(10)
    v_mfma_f32_16x16x32_bf16 v[32:35], v[64:67], v[192:195], v[32:35]
    ds_read_b64_tr_b16 v[92:93], v23 offset:32768
    ds_read_b64_tr_b16 v[94:95], v23 offset:36864
    ds_read_b64_tr_b16 v[96:97], v16 offset:40960
    ds_read_b64_tr_b16 v[98:99], v16 offset:45056
    v_fma_f32 v212, v212, s63, -v2
    v_fma_f32 v213, v213, s63, -v2
    v_mfma_f32_16x16x32_bf16 v[36:39], v[68:71], v[192:195], v[36:39]
    s_add_u32 m0, s62, 16384
    s_add_u32 s65, s34, 114688
    buffer_load_dwordx4 v4, s[16:19], s65 offen nt lds
    v_fma_f32 v214, v214, s63, -v2
    v_fma_f32 v215, v215, s63, -v2
    s_waitcnt lgkmcnt(10)
    v_mfma_f32_16x16x32_bf16 v[40:43], v[72:75], v[192:195], v[40:43]
    ds_read_b64_tr_b16 v[100:101], v17 offset:40960
    ds_read_b64_tr_b16 v[102:103], v17 offset:45056
    ds_read_b64_tr_b16 v[104:105], v18 offset:40960
    ds_read_b64_tr_b16 v[106:107], v18 offset:45056
    v_exp_f32 v212, v212
    v_exp_f32 v213, v213
    v_mfma_f32_16x16x32_bf16 v[44:47], v[76:79], v[192:195], v[44:47]
    v_exp_f32 v214, v214
    v_exp_f32 v215, v215
    s_waitcnt lgkmcnt(10)
    v_mfma_f32_16x16x32_bf16 v[48:51], v[80:83], v[192:195], v[48:51]
    ds_read_b64_tr_b16 v[108:109], v19 offset:40960
    ds_read_b64_tr_b16 v[110:111], v19 offset:45056
    ds_read_b64_tr_b16 v[112:113], v20 offset:40960
    ds_read_b64_tr_b16 v[114:115], v20 offset:45056
    buffer_load_dwordx4 v5, s[16:19], s65 offen offset:1024 nt lds
    v_cvt_pk_bf16_f32 v208, v208, v209
    v_cvt_pk_bf16_f32 v209, v210, v211
    v_mfma_f32_16x16x32_bf16 v[52:55], v[84:87], v[192:195], v[52:55]
    v_fma_f32 v216, v216, s63, -v2
    v_fma_f32 v217, v217, s63, -v2
    s_waitcnt lgkmcnt(10)
    v_mfma_f32_16x16x32_bf16 v[56:59], v[88:91], v[192:195], v[56:59]
    ds_read_b64_tr_b16 v[116:117], v21 offset:40960
    ds_read_b64_tr_b16 v[118:119], v21 offset:45056
    ds_read_b64_tr_b16 v[120:121], v22 offset:40960
    ds_read_b64_tr_b16 v[122:123], v22 offset:45056
    v_fma_f32 v218, v218, s63, -v2
    v_fma_f32 v219, v219, s63, -v2
    v_mfma_f32_16x16x32_bf16 v[60:63], v[92:95], v[192:195], v[60:63]
    s_cmp_eq_u32 s4, 0
    s_cbranch_scc0 na_49
    v_lshlrev_b32 v11, 8, v0
    v_mov_b32 v30, 1
    buffer_atomic_add v30, v11, s[84:87], s82 offen sc1
na_49:
    v_exp_f32 v216, v216
    v_exp_f32 v217, v217
    s_waitcnt lgkmcnt(10)
    v_mfma_f32_16x16x32_bf16 v[32:35], v[96:99], v[196:199], v[32:35]
    ds_read_b64_tr_b16 v[124:125], v23 offset:40960
    ds_read_b64_tr_b16 v[126:127], v23 offset:45056
    v_exp_f32 v218, v218
    v_exp_f32 v219, v219
    v_mfma_f32_16x16x32_bf16 v[36:39], v[100:103], v[196:199], v[36:39]
    v_cvt_pk_bf16_f32 v210, v212, v213
    v_cvt_pk_bf16_f32 v211, v214, v215
    s_waitcnt lgkmcnt(8)
    v_mfma_f32_16x16x32_bf16 v[40:43], v[104:107], v[196:199], v[40:43]
    v_fma_f32 v220, v220, s63, -v2
    v_fma_f32 v221, v221, s63, -v2
    v_mfma_f32_16x16x32_bf16 v[44:47], v[108:111], v[196:199], v[44:47]
    v_fma_f32 v222, v222, s63, -v2
    v_fma_f32 v223, v223, s63, -v2
    s_waitcnt lgkmcnt(4)
    v_mfma_f32_16x16x32_bf16 v[48:51], v[112:115], v[196:199], v[48:51]
    v_exp_f32 v220, v220
    v_exp_f32 v221, v221
    v_mfma_f32_16x16x32_bf16 v[52:55], v[116:119], v[196:199], v[52:55]
    v_exp_f32 v222, v222
    v_exp_f32 v223, v223
    s_waitcnt lgkmcnt(0)
    v_mfma_f32_16x16x32_bf16 v[56:59], v[120:123], v[196:199], v[56:59]
    v_cvt_pk_bf16_f32 v212, v216, v217
    v_cvt_pk_bf16_f32 v213, v218, v219
    v_mfma_f32_16x16x32_bf16 v[60:63], v[124:127], v[196:199], v[60:63]
    v_cvt_pk_bf16_f32 v214, v220, v221
    v_cvt_pk_bf16_f32 v215, v222, v223
    v_add_u32 v16, 0xc000, v16
    v_add_u32 v17, 0xc000, v17
    v_add_u32 v18, 0xc000, v18
    v_add_u32 v19, 0xc000, v19
    v_add_u32 v20, 0xc000, v20
    v_add_u32 v21, 0xc000, v21
    v_add_u32 v22, 0xc000, v22
    v_add_u32 v23, 0xc000, v23
    s_waitcnt vmcnt(9)
    s_barrier
    v_add_u32 v24, 0x18000, v24
    v_add_u32 v25, 0x18000, v25
    ds_read_b64_tr_b16 v[64:65], v16 offset:0
    ds_read_b64_tr_b16 v[66:67], v16 offset:4096
    ds_read_b64_tr_b16 v[68:69], v17 offset:0
    ds_read_b64_tr_b16 v[70:71], v17 offset:4096
    ds_read_b64_tr_b16 v[72:73], v18 offset:0
    ds_read_b64_tr_b16 v[74:75], v18 offset:4096
    ds_read_b64_tr_b16 v[76:77], v19 offset:0
    ds_read_b64_tr_b16 v[78:79], v19 offset:4096
    ds_read_b64_tr_b16 v[80:81], v20 offset:0
    ds_read_b64_tr_b16 v[82:83], v20 offset:4096
    ds_read_b64_tr_b16 v[84:85], v21 offset:0
    ds_read_b64_tr_b16 v[86:87], v21 offset:4096
    ds_read_b64_tr_b16 v[88:89], v22 offset:0
    ds_read_b64_tr_b16 v[90:91], v22 offset:4096
    v_fma_f32 v224, v224, s63, -v2
    v_fma_f32 v225, v225, s63, -v2
    v_fma_f32 v226, v226, s63, -v2
    v_fma_f32 v227, v227, s63, -v2
    v_mfma_f32_16x16x32_bf16 v[136:139], v[140:143], v[208:211], v[136:139]
    s_add_u32 m0, s62, 65536
    s_add_u32 s65, s35, 256
    buffer_load_dwordx4 v6, s[24:27], s65 offen lds
    v_exp_f32 v224, v224
    v_exp_f32 v225, v225
    v_mfma_f32_16x16x32_bf16 v[136:139], v[140:143], v[212:215], v[136:139]
    v_exp_f32 v226, v226
    v_exp_f32 v227, v227
    s_waitcnt lgkmcnt(10)
    v_mfma_f32_16x16x32_bf16 v[32:35], v[64:67], v[208:211], v[32:35]
    ds_read_b64_tr_b16 v[92:93], v23 offset:0
    ds_read_b64_tr_b16 v[94:95], v23 offset:4096
    ds_read_b64_tr_b16 v[96:97], v16 offset:8192
    ds_read_b64_tr_b16 v[98:99], v16 offset:12288
    v_fma_f32 v228, v228, s63, -v2
    v_fma_f32 v229, v229, s63, -v2
    v_mfma_f32_16x16x32_bf16 v[36:39], v[68:71], v[208:211], v[36:39]
    buffer_load_dwordx4 v7, s[24:27], s65 offen offset:1024 lds
    v_fma_f32 v230, v230, s63, -v2
    v_fma_f32 v231, v231, s63, -v2
    s_waitcnt lgkmcnt(10)
    v_mfma_f32_16x16x32_bf16 v[40:43], v[72:75], v[208:211], v[40:43]
    ds_read_b64_tr_b16 v[100:101], v17 offset:8192
    ds_read_b64_tr_b16 v[102:103], v17 offset:12288
    ds_read_b64_tr_b16 v[104:105], v18 offset:8192
    ds_read_b64_tr_b16 v[106:107], v18 offset:12288
    v_exp_f32 v228, v228
    v_exp_f32 v229, v229
    v_mfma_f32_16x16x32_bf16 v[44:47], v[76:79], v[208:211], v[44:47]
    v_exp_f32 v230, v230
    v_exp_f32 v231, v231
    s_waitcnt lgkmcnt(10)
    v_mfma_f32_16x16x32_bf16 v[48:51], v[80:83], v[208:211], v[48:51]
    ds_read_b64_tr_b16 v[108:109], v19 offset:8192
    ds_read_b64_tr_b16 v[110:111], v19 offset:12288
    ds_read_b64_tr_b16 v[112:113], v20 offset:8192
    ds_read_b64_tr_b16 v[114:115], v20 offset:12288
    s_add_u32 m0, s62, 81920
    s_add_u32 s65, s35, 73984
    buffer_load_dwordx4 v6, s[24:27], s65 offen lds
    v_cvt_pk_bf16_f32 v224, v224, v225
    v_cvt_pk_bf16_f32 v225, v226, v227
    v_mfma_f32_16x16x32_bf16 v[52:55], v[84:87], v[208:211], v[52:55]
    v_fma_f32 v232, v232, s63, -v2
    v_fma_f32 v233, v233, s63, -v2
    s_waitcnt lgkmcnt(10)
    v_mfma_f32_16x16x32_bf16 v[56:59], v[88:91], v[208:211], v[56:59]
    ds_read_b64_tr_b16 v[116:117], v21 offset:8192
    ds_read_b64_tr_b16 v[118:119], v21 offset:12288
    ds_read_b64_tr_b16 v[120:121], v22 offset:8192
    ds_read_b64_tr_b16 v[122:123], v22 offset:12288
    v_fma_f32 v234, v234, s63, -v2
    v_fma_f32 v235, v235, s63, -v2
    v_mfma_f32_16x16x32_bf16 v[60:63], v[92:95], v[208:211], v[60:63]
    buffer_load_dwordx4 v7, s[24:27], s65 offen offset:1024 lds
    v_exp_f32 v232, v232
    v_exp_f32 v233, v233
    s_waitcnt lgkmcnt(10)
    v_mfma_f32_16x16x32_bf16 v[32:35], v[96:99], v[212:215], v[32:35]
    ds_read_b64_tr_b16 v[124:125], v23 offset:8192
    ds_read_b64_tr_b16 v[126:127], v23 offset:12288
    ds_read_b64_tr_b16 v[144:145], v24 offset:0
    ds_read_b64_tr_b16 v[146:147], v24 offset:4096
    ds_read_b64_tr_b16 v[148:149], v25 offset:0
    s_waitcnt lgkmcnt(12)
    ds_read_b64_tr_b16 v[150:151], v25 offset:4096
    ds_read_b64_tr_b16 v[152:153], v24 offset:8192
    ds_read_b64_tr_b16 v[154:155], v24 offset:12288
    s_waitcnt lgkmcnt(12)
    ds_read_b64_tr_b16 v[156:157], v25 offset:8192
    ds_read_b64_tr_b16 v[158:159], v25 offset:12288
    ds_read_b64_tr_b16 v[160:161], v24 offset:16384
    s_waitcnt lgkmcnt(12)
    ds_read_b64_tr_b16 v[162:163], v24 offset:20480
    ds_read_b64_tr_b16 v[164:165], v25 offset:16384
    v_exp_f32 v234, v234
    v_exp_f32 v235, v235
    v_mfma_f32_16x16x32_bf16 v[36:39], v[100:103], v[212:215], v[36:39]
    ds_read_b64_tr_b16 v[166:167], v25 offset:20480
    v_cvt_pk_bf16_f32 v226, v228, v229
    v_cvt_pk_bf16_f32 v227, v230, v231
    v_mfma_f32_16x16x32_bf16 v[40:43], v[104:107], v[212:215], v[40:43]
    s_waitcnt lgkmcnt(12)
    ds_read_b64_tr_b16 v[168:169], v24 offset:24576
    v_fma_f32 v236, v236, s63, -v2
    v_fma_f32 v237, v237, s63, -v2
    v_mfma_f32_16x16x32_bf16 v[44:47], v[108:111], v[212:215], v[44:47]
    ds_read_b64_tr_b16 v[170:171], v24 offset:28672
    v_fma_f32 v238, v238, s63, -v2
    v_fma_f32 v239, v239, s63, -v2
    v_mfma_f32_16x16x32_bf16 v[48:51], v[112:115], v[212:215], v[48:51]
    ds_read_b64_tr_b16 v[172:173], v25 offset:24576
    v_exp_f32 v236, v236
    v_exp_f32 v237, v237
    v_mfma_f32_16x16x32_bf16 v[52:55], v[116:119], v[212:215], v[52:55]
    s_waitcnt lgkmcnt(12)
    ds_read_b64_tr_b16 v[174:175], v25 offset:28672
    v_exp_f32 v238, v238
    v_exp_f32 v239, v239
    v_mfma_f32_16x16x32_bf16 v[56:59], v[120:123], v[212:215], v[56:59]
    v_cvt_pk_bf16_f32 v228, v232, v233
    v_cvt_pk_bf16_f32 v229, v234, v235
    v_mfma_f32_16x16x32_bf16 v[60:63], v[124:127], v[212:215], v[60:63]
    v_cvt_pk_bf16_f32 v230, v236, v237
    v_cvt_pk_bf16_f32 v231, v238, v239
    v_add_u32 v16, 0xffff4000, v16
    v_add_u32 v17, 0xffff4000, v17
    v_add_u32 v18, 0xffff4000, v18
    v_add_u32 v19, 0xffff4000, v19
    v_add_u32 v20, 0xffff4000, v20
    v_add_u32 v21, 0xffff4000, v21
    v_add_u32 v22, 0xffff4000, v22
    v_add_u32 v23, 0xffff4000, v23
    s_waitcnt lgkmcnt(0)
    s_waitcnt vmcnt(7)
    s_barrier
    ds_read_b64_tr_b16 v[64:65], v16 offset:0
    ds_read_b64_tr_b16 v[66:67], v16 offset:4096
    ds_read_b64_tr_b16 v[68:69], v17 offset:0
    ds_read_b64_tr_b16 v[70:71], v17 offset:4096
    ds_read_b64_tr_b16 v[72:73], v18 offset:0
    ds_read_b64_tr_b16 v[74:75], v18 offset:4096
    ds_read_b64_tr_b16 v[76:77], v19 offset:0
    ds_read_b64_tr_b16 v[78:79], v19 offset:4096
    ds_read_b64_tr_b16 v[80:81], v20 offset:0
    ds_read_b64_tr_b16 v[82:83], v20 offset:4096
    ds_read_b64_tr_b16 v[84:85], v21 offset:0
    ds_read_b64_tr_b16 v[86:87], v21 offset:4096
    ds_read_b64_tr_b16 v[88:89], v22 offset:0
    ds_read_b64_tr_b16 v[90:91], v22 offset:4096
    v_fma_f32 v240, v240, s63, -v2
    v_fma_f32 v241, v241, s63, -v2
    v_fma_f32 v242, v242, s63, -v2
    v_fma_f32 v243, v243, s63, -v2
    v_mfma_f32_16x16x32_bf16 v[136:139], v[140:143], v[224:227], v[136:139]
    s_mov_b64 s[88:89], s[54:55]
    s_mov_b32 s90, 4718592
    v_bfe_u32 v11, v0, 3, 2
    v_mul_u32_u24 v11, 9, v11
    v_and_b32 v9, 7, v0
    v_min_u32 v9, 4, v9
    v_add_lshl_u32 v11, v11, v9, 7
    s_lshl_b32 s80, s68, 3
    s_add_u32 s80, s80, s4
    s_mul_i32 s80, s80, 4608
    s_mul_i32 s65, s67, 294912
    s_add_u32 s65, s65, s80
    buffer_load_dword v13, v11, s[88:91], s65 offen offset:512
    v_exp_f32 v240, v240
    v_exp_f32 v241, v241
    v_mfma_f32_16x16x32_bf16 v[136:139], v[140:143], v[228:231], v[136:139]
    v_exp_f32 v242, v242
    v_exp_f32 v243, v243
    s_waitcnt lgkmcnt(10)
    v_mfma_f32_16x16x32_bf16 v[32:35], v[64:67], v[224:227], v[32:35]
    ds_read_b64_tr_b16 v[92:93], v23 offset:0
    ds_read_b64_tr_b16 v[94:95], v23 offset:4096
    ds_read_b64_tr_b16 v[96:97], v16 offset:8192
    ds_read_b64_tr_b16 v[98:99], v16 offset:12288
    v_fma_f32 v244, v244, s63, -v2
    v_fma_f32 v245, v245, s63, -v2
    v_mfma_f32_16x16x32_bf16 v[36:39], v[68:71], v[224:227], v[36:39]
    v_fma_f32 v246, v246, s63, -v2
    v_fma_f32 v247, v247, s63, -v2
    s_waitcnt lgkmcnt(10)
    v_mfma_f32_16x16x32_bf16 v[40:43], v[72:75], v[224:227], v[40:43]
    ds_read_b64_tr_b16 v[100:101], v17 offset:8192
    ds_read_b64_tr_b16 v[102:103], v17 offset:12288
    ds_read_b64_tr_b16 v[104:105], v18 offset:8192
    ds_read_b64_tr_b16 v[106:107], v18 offset:12288
    v_exp_f32 v244, v244
    v_exp_f32 v245, v245
    v_mfma_f32_16x16x32_bf16 v[44:47], v[76:79], v[224:227], v[44:47]
    v_exp_f32 v246, v246
    v_exp_f32 v247, v247
    s_waitcnt lgkmcnt(10)
    v_mfma_f32_16x16x32_bf16 v[48:51], v[80:83], v[224:227], v[48:51]
    ds_read_b64_tr_b16 v[108:109], v19 offset:8192
    ds_read_b64_tr_b16 v[110:111], v19 offset:12288
    ds_read_b64_tr_b16 v[112:113], v20 offset:8192
    ds_read_b64_tr_b16 v[114:115], v20 offset:12288
    v_cvt_pk_bf16_f32 v240, v240, v241
    v_cvt_pk_bf16_f32 v241, v242, v243
    v_mfma_f32_16x16x32_bf16 v[52:55], v[84:87], v[224:227], v[52:55]
    v_fma_f32 v248, v248, s63, -v2
    v_fma_f32 v249, v249, s63, -v2
    s_waitcnt lgkmcnt(10)
    v_mfma_f32_16x16x32_bf16 v[56:59], v[88:91], v[224:227], v[56:59]
    ds_read_b64_tr_b16 v[116:117], v21 offset:8192
    ds_read_b64_tr_b16 v[118:119], v21 offset:12288
    ds_read_b64_tr_b16 v[120:121], v22 offset:8192
    ds_read_b64_tr_b16 v[122:123], v22 offset:12288
    v_fma_f32 v250, v250, s63, -v2
    v_fma_f32 v251, v251, s63, -v2
    v_mfma_f32_16x16x32_bf16 v[60:63], v[92:95], v[224:227], v[60:63]
    v_exp_f32 v248, v248
    v_exp_f32 v249, v249
    s_waitcnt lgkmcnt(10)
    v_mfma_f32_16x16x32_bf16 v[32:35], v[96:99], v[228:231], v[32:35]
    ds_read_b64_tr_b16 v[124:125], v23 offset:8192
    ds_read_b64_tr_b16 v[126:127], v23 offset:12288
    ds_read_b64_tr_b16 v[176:177], v24 offset:32768
    ds_read_b64_tr_b16 v[178:179], v24 offset:36864
    ds_read_b64_tr_b16 v[180:181], v25 offset:32768
    s_waitcnt lgkmcnt(12)
    ds_read_b64_tr_b16 v[182:183], v25 offset:36864
    ds_read_b64_tr_b16 v[184:185], v24 offset:40960
    ds_read_b64_tr_b16 v[186:187], v24 offset:45056
    s_waitcnt lgkmcnt(12)
    ds_read_b64_tr_b16 v[188:189], v25 offset:40960
    ds_read_b64_tr_b16 v[190:191], v25 offset:45056
    ds_read_b64_tr_b16 v[192:193], v24 offset:49152
    s_waitcnt lgkmcnt(12)
    ds_read_b64_tr_b16 v[194:195], v24 offset:53248
    ds_read_b64_tr_b16 v[196:197], v25 offset:49152
    v_exp_f32 v250, v250
    v_exp_f32 v251, v251
    v_mfma_f32_16x16x32_bf16 v[36:39], v[100:103], v[228:231], v[36:39]
    ds_read_b64_tr_b16 v[198:199], v25 offset:53248
    v_cvt_pk_bf16_f32 v242, v244, v245
    v_cvt_pk_bf16_f32 v243, v246, v247
    v_mfma_f32_16x16x32_bf16 v[40:43], v[104:107], v[228:231], v[40:43]
    s_waitcnt lgkmcnt(12)
    ds_read_b64_tr_b16 v[200:201], v24 offset:57344
    v_fma_f32 v252, v252, s63, -v2
    v_fma_f32 v253, v253, s63, -v2
    v_mfma_f32_16x16x32_bf16 v[44:47], v[108:111], v[228:231], v[44:47]
    ds_read_b64_tr_b16 v[202:203], v24 offset:61440
    v_fma_f32 v254, v254, s63, -v2
    v_fma_f32 v255, v255, s63, -v2
    v_mfma_f32_16x16x32_bf16 v[48:51], v[112:115], v[228:231], v[48:51]
    ds_read_b64_tr_b16 v[204:205], v25 offset:57344
    v_exp_f32 v252, v252
    v_exp_f32 v253, v253
    v_mfma_f32_16x16x32_bf16 v[52:55], v[116:119], v[228:231], v[52:55]
    s_waitcnt lgkmcnt(12)
    ds_read_b64_tr_b16 v[206:207], v25 offset:61440
    v_exp_f32 v254, v254
    v_exp_f32 v255, v255
    v_mfma_f32_16x16x32_bf16 v[56:59], v[120:123], v[228:231], v[56:59]
    v_cvt_pk_bf16_f32 v244, v248, v249
    v_cvt_pk_bf16_f32 v245, v250, v251
    v_mfma_f32_16x16x32_bf16 v[60:63], v[124:127], v[228:231], v[60:63]
    v_cvt_pk_bf16_f32 v246, v252, v253
    v_cvt_pk_bf16_f32 v247, v254, v255
    s_waitcnt lgkmcnt(0)
    s_waitcnt vmcnt(5)
    s_barrier
    ds_read_b64_tr_b16 v[64:65], v16 offset:16384
    ds_read_b64_tr_b16 v[66:67], v16 offset:20480
    ds_read_b64_tr_b16 v[68:69], v17 offset:16384
    ds_read_b64_tr_b16 v[70:71], v17 offset:20480
    ds_read_b64_tr_b16 v[72:73], v18 offset:16384
    ds_read_b64_tr_b16 v[74:75], v18 offset:20480
    ds_read_b64_tr_b16 v[76:77], v19 offset:16384
    ds_read_b64_tr_b16 v[78:79], v19 offset:20480
    ds_read_b64_tr_b16 v[80:81], v16 offset:24576
    ds_read_b64_tr_b16 v[82:83], v16 offset:28672
    ds_read_b64_tr_b16 v[84:85], v17 offset:24576
    ds_read_b64_tr_b16 v[86:87], v17 offset:28672
    ds_read_b64_tr_b16 v[88:89], v18 offset:24576
    ds_read_b64_tr_b16 v[90:91], v18 offset:28672
    v_mfma_f32_16x16x32_bf16 v[136:139], v[140:143], v[240:243], v[136:139]
    s_add_u32 m0, s62, 98304
    s_add_u32 s65, s35, 147712
    buffer_load_dwordx4 v6, s[24:27], s65 offen lds
    v_mfma_f32_16x16x32_bf16 v[136:139], v[140:143], v[244:247], v[136:139]
    s_waitcnt lgkmcnt(10)
    v_mfma_f32_16x16x32_bf16 v[32:35], v[64:67], v[240:243], v[32:35]
    ds_read_b64_tr_b16 v[92:93], v19 offset:24576
    ds_read_b64_tr_b16 v[94:95], v19 offset:28672
    ds_read_b64_tr_b16 v[96:97], v20 offset:16384
    ds_read_b64_tr_b16 v[98:99], v20 offset:20480
    v_mfma_f32_16x16x32_bf16 v[36:39], v[68:71], v[240:243], v[36:39]
    buffer_load_dwordx4 v7, s[24:27], s65 offen offset:1024 lds
    s_waitcnt lgkmcnt(10)
    v_mfma_f32_16x16x32_bf16 v[40:43], v[72:75], v[240:243], v[40:43]
    ds_read_b64_tr_b16 v[100:101], v21 offset:16384
    ds_read_b64_tr_b16 v[102:103], v21 offset:20480
    ds_read_b64_tr_b16 v[104:105], v22 offset:16384
    ds_read_b64_tr_b16 v[106:107], v22 offset:20480
    v_mfma_f32_16x16x32_bf16 v[44:47], v[76:79], v[240:243], v[44:47]
    s_waitcnt lgkmcnt(10)
    v_mfma_f32_16x16x32_bf16 v[32:35], v[80:83], v[244:247], v[32:35]
    ds_read_b64_tr_b16 v[108:109], v23 offset:16384
    ds_read_b64_tr_b16 v[110:111], v23 offset:20480
    ds_read_b64_tr_b16 v[112:113], v20 offset:24576
    ds_read_b64_tr_b16 v[114:115], v20 offset:28672
    s_add_u32 m0, s62, 114688
    s_add_u32 s65, s35, 221440
    buffer_load_dwordx4 v6, s[24:27], s65 offen lds
    v_rcp_f32 v2, v136
    v_mfma_f32_16x16x32_bf16 v[36:39], v[84:87], v[244:247], v[36:39]
    s_waitcnt lgkmcnt(10)
    v_mfma_f32_16x16x32_bf16 v[40:43], v[88:91], v[244:247], v[40:43]
    ds_read_b64_tr_b16 v[116:117], v21 offset:24576
    ds_read_b64_tr_b16 v[118:119], v21 offset:28672
    ds_read_b64_tr_b16 v[120:121], v22 offset:24576
    ds_read_b64_tr_b16 v[122:123], v22 offset:28672
    v_mfma_f32_16x16x32_bf16 v[44:47], v[92:95], v[244:247], v[44:47]
    buffer_load_dwordx4 v7, s[24:27], s65 offen offset:1024 lds
    s_waitcnt lgkmcnt(10)
    v_mfma_f32_16x16x32_bf16 v[48:51], v[96:99], v[240:243], v[48:51]
    ds_read_b64_tr_b16 v[124:125], v23 offset:24576
    ds_read_b64_tr_b16 v[126:127], v23 offset:28672
    v_mfma_f32_16x16x32_bf16 v[52:55], v[100:103], v[240:243], v[52:55]
    s_waitcnt lgkmcnt(8)
    v_mfma_f32_16x16x32_bf16 v[56:59], v[104:107], v[240:243], v[56:59]
    v_mul_f32 v32, v2, v32
    v_mul_f32 v33, v2, v33
    v_mul_f32 v34, v2, v34
    v_mul_f32 v35, v2, v35
    v_mfma_f32_16x16x32_bf16 v[60:63], v[108:111], v[240:243], v[60:63]
    v_mul_f32 v36, v2, v36
    v_mul_f32 v37, v2, v37
    v_mul_f32 v38, v2, v38
    v_mul_f32 v39, v2, v39
    s_waitcnt lgkmcnt(4)
    v_mfma_f32_16x16x32_bf16 v[48:51], v[112:115], v[244:247], v[48:51]
    v_cvt_pk_bf16_f32 v32, v32, v33
    v_cvt_pk_bf16_f32 v33, v34, v35
    v_cvt_pk_bf16_f32 v34, v36, v37
    v_cvt_pk_bf16_f32 v35, v38, v39
    ds_write_b128 v27, v[32:35] offset:0
    v_mfma_f32_16x16x32_bf16 v[52:55], v[116:119], v[244:247], v[52:55]
    v_mul_f32 v40, v2, v40
    v_mul_f32 v41, v2, v41
    v_mul_f32 v42, v2, v42
    v_mul_f32 v43, v2, v43
    s_waitcnt lgkmcnt(1)
    v_mfma_f32_16x16x32_bf16 v[56:59], v[120:123], v[244:247], v[56:59]
    v_mul_f32 v44, v2, v44
    v_mul_f32 v45, v2, v45
    v_mul_f32 v46, v2, v46
    v_mul_f32 v47, v2, v47
    v_mfma_f32_16x16x32_bf16 v[60:63], v[124:127], v[244:247], v[60:63]
    v_cvt_pk_bf16_f32 v40, v40, v41
    v_cvt_pk_bf16_f32 v41, v42, v43
    v_cvt_pk_bf16_f32 v42, v44, v45
    v_cvt_pk_bf16_f32 v43, v46, v47
    ds_write_b128 v27, v[40:43] offset:4096
    v_pk_mul_f32 v[48:49], v[48:49], v[2:3] op_sel_hi:[1,0]
    v_pk_mul_f32 v[50:51], v[50:51], v[2:3] op_sel_hi:[1,0]
    v_pk_mul_f32 v[52:53], v[52:53], v[2:3] op_sel_hi:[1,0]
    v_pk_mul_f32 v[54:55], v[54:55], v[2:3] op_sel_hi:[1,0]
    v_cvt_pk_bf16_f32 v48, v48, v49
    v_cvt_pk_bf16_f32 v49, v50, v51
    v_cvt_pk_bf16_f32 v50, v52, v53
    v_cvt_pk_bf16_f32 v51, v54, v55
    ds_write_b128 v27, v[48:51] offset:8192
    v_pk_mul_f32 v[56:57], v[56:57], v[2:3] op_sel_hi:[1,0]
    v_pk_mul_f32 v[58:59], v[58:59], v[2:3] op_sel_hi:[1,0]
    v_pk_mul_f32 v[60:61], v[60:61], v[2:3] op_sel_hi:[1,0]
    v_pk_mul_f32 v[62:63], v[62:63], v[2:3] op_sel_hi:[1,0]
    v_cvt_pk_bf16_f32 v56, v56, v57
    v_cvt_pk_bf16_f32 v57, v58, v59
    v_cvt_pk_bf16_f32 v58, v60, v61
    v_cvt_pk_bf16_f32 v59, v62, v63
    ds_write_b128 v27, v[56:59] offset:12288
    s_add_u32 m0, s62, 131072
    s_add_u32 s65, s35, 512
    buffer_load_dwordx4 v6, s[24:27], s65 offen lds
    buffer_load_dwordx4 v7, s[24:27], s65 offen offset:1024 lds
    s_add_u32 m0, s62, 147456
    s_add_u32 s65, s35, 74240
    buffer_load_dwordx4 v6, s[24:27], s65 offen lds
    buffer_load_dwordx4 v7, s[24:27], s65 offen offset:1024 lds
    s_waitcnt lgkmcnt(0)
    s_barrier
    ds_read_b128 v[208:211], v26 offset:0
    ds_read_b128 v[212:215], v26 offset:512
    ds_read_b128 v[216:219], v26 offset:4096
    ds_read_b128 v[220:223], v26 offset:4608
    ds_read_b128 v[224:227], v26 offset:8192
    ds_read_b128 v[228:231], v26 offset:8704
    ds_read_b128 v[232:235], v26 offset:12288
    ds_read_b128 v[236:239], v26 offset:12800
    v_mul_u32_u24 v14, 147328, v14
    v_add_u32 v4, v14, v6
    v_add_u32 v5, v14, v7
    v_bfe_u32 v1, v0, 2, 3
    s_waitcnt lgkmcnt(6)
    v_mfma_f32_32x32x16_bf16 v[32:47], v[144:147], v[208:211], 0
    ds_read_b128 v[240:243], v26 offset:16384
    ds_read_b128 v[244:247], v26 offset:16896
    s_add_u32 m0, s62, 0
    s_add_u32 s65, s35, 147968
    buffer_load_dwordx4 v6, s[24:27], s65 offen lds
    v_mfma_f32_32x32x16_bf16 v[32:47], v[148:151], v[212:215], v[32:47]
    ds_read_b128 v[248:251], v26 offset:20480
    v_mul_u32_u24 v1, 4608, v1
    s_waitcnt lgkmcnt(7)
    v_mfma_f32_32x32x16_bf16 v[32:47], v[152:155], v[216:219], v[32:47]
    ds_read_b128 v[252:255], v26 offset:20992
    buffer_load_dwordx4 v7, s[24:27], s65 offen offset:1024 lds
    v_mfma_f32_32x32x16_bf16 v[32:47], v[156:159], v[220:223], v[32:47]
    ds_read_b128 v[128:131], v26 offset:24576
    v_lshrrev_b32 v2, 5, v0
    s_waitcnt lgkmcnt(7)
    v_mfma_f32_32x32x16_bf16 v[32:47], v[160:163], v[224:227], v[32:47]
    ds_read_b128 v[132:135], v26 offset:25088
    s_add_u32 m0, s62, 16384
    s_add_u32 s65, s35, 221696
    buffer_load_dwordx4 v6, s[24:27], s65 offen lds
    v_lshl_add_u32 v1, v2, 6, v1
    v_mfma_f32_32x32x16_bf16 v[32:47], v[164:167], v[228:231], v[32:47]
    ds_read_b128 v[136:139], v26 offset:28672
    s_waitcnt lgkmcnt(7)
    v_mfma_f32_32x32x16_bf16 v[32:47], v[168:171], v[232:235], v[32:47]
    ds_read_b128 v[140:143], v26 offset:29184
    buffer_load_dwordx4 v7, s[24:27], s65 offen offset:1024 lds
    v_and_b32 v2, 3, v0
    v_mfma_f32_32x32x16_bf16 v[32:47], v[172:175], v[236:239], v[32:47]
    v_lshl_add_u32 v1, v2, 4, v1
    s_waitcnt lgkmcnt(0)
    s_waitcnt vmcnt(13)
    s_barrier
    v_add_u32 v24, 0xffff8000, v24
    v_add_u32 v25, 0xffff8000, v25
    v_mfma_f32_32x32x16_bf16 v[32:47], v[176:179], v[240:243], v[32:47]
    ds_read_b64_tr_b16 v[64:65], v24 offset:0
    ds_read_b64_tr_b16 v[66:67], v24 offset:4096
    ds_read_b64_tr_b16 v[68:69], v25 offset:0
    ds_read_b64_tr_b16 v[70:71], v25 offset:4096
    s_add_u32 m0, s62, 32768
    s_add_u32 s65, s35, 768
    buffer_load_dwordx4 v6, s[24:27], s65 offen lds
    v_mfma_f32_32x32x16_bf16 v[32:47], v[180:183], v[244:247], v[32:47]
    ds_read_b64_tr_b16 v[72:73], v24 offset:8192
    ds_read_b64_tr_b16 v[74:75], v24 offset:12288
    ds_read_b64_tr_b16 v[76:77], v25 offset:8192
    buffer_load_dwordx4 v7, s[24:27], s65 offen offset:1024 lds
    v_mfma_f32_32x32x16_bf16 v[32:47], v[184:187], v[248:251], v[32:47]
    ds_read_b64_tr_b16 v[78:79], v25 offset:12288
    ds_read_b64_tr_b16 v[80:81], v24 offset:16384
    ds_read_b64_tr_b16 v[82:83], v24 offset:20480
    v_mfma_f32_32x32x16_bf16 v[32:47], v[188:191], v[252:255], v[32:47]
    ds_read_b64_tr_b16 v[84:85], v25 offset:16384
    ds_read_b64_tr_b16 v[86:87], v25 offset:20480
    ds_read_b64_tr_b16 v[88:89], v24 offset:24576
    s_add_u32 m0, s62, 49152
    s_add_u32 s65, s35, 74496
    buffer_load_dwordx4 v6, s[24:27], s65 offen lds
    v_mfma_f32_32x32x16_bf16 v[32:47], v[192:195], v[128:131], v[32:47]
    ds_read_b64_tr_b16 v[90:91], v24 offset:28672
    ds_read_b64_tr_b16 v[92:93], v25 offset:24576
    s_waitcnt lgkmcnt(12)
    ds_read_b64_tr_b16 v[94:95], v25 offset:28672
    buffer_load_dwordx4 v7, s[24:27], s65 offen offset:1024 lds
    v_mfma_f32_32x32x16_bf16 v[32:47], v[196:199], v[132:135], v[32:47]
    v_mfma_f32_32x32x16_bf16 v[32:47], v[200:203], v[136:139], v[32:47]
    buffer_load_dword v8, off, s[84:87], s82 sc1
    v_mfma_f32_32x32x16_bf16 v[32:47], v[204:207], v[140:143], v[32:47]
    s_waitcnt lgkmcnt(0)
    s_waitcnt vmcnt(13)
    s_barrier
    v_mfma_f32_32x32x16_bf16 v[48:63], v[64:67], v[208:211], 0
    ds_read_b64_tr_b16 v[96:97], v24 offset:32768
    ds_read_b64_tr_b16 v[98:99], v24 offset:36864
    ds_read_b64_tr_b16 v[100:101], v25 offset:32768
    ds_read_b64_tr_b16 v[102:103], v25 offset:36864
    s_add_u32 m0, s62, 65536
    s_add_u32 s65, s35, 148224
    buffer_load_dwordx4 v6, s[24:27], s65 offen lds
    s_nop 0
    v_cvt_pk_bf16_f32 v144, v32, v33
    v_cvt_pk_bf16_f32 v145, v34, v35
    v_mfma_f32_32x32x16_bf16 v[48:63], v[68:71], v[212:215], v[48:63]
    ds_read_b64_tr_b16 v[104:105], v24 offset:40960
    ds_read_b64_tr_b16 v[106:107], v24 offset:45056
    ds_read_b64_tr_b16 v[108:109], v25 offset:40960
    buffer_load_dwordx4 v7, s[24:27], s65 offen offset:1024 lds
    v_cvt_pk_bf16_f32 v146, v36, v37
    v_cvt_pk_bf16_f32 v147, v38, v39
    v_mfma_f32_32x32x16_bf16 v[48:63], v[72:75], v[216:219], v[48:63]
    ds_read_b64_tr_b16 v[110:111], v25 offset:45056
    ds_read_b64_tr_b16 v[112:113], v24 offset:49152
    ds_read_b64_tr_b16 v[114:115], v24 offset:53248
    v_cvt_pk_bf16_f32 v148, v40, v41
    v_cvt_pk_bf16_f32 v149, v42, v43
    v_mfma_f32_32x32x16_bf16 v[48:63], v[76:79], v[220:223], v[48:63]
    ds_read_b64_tr_b16 v[116:117], v25 offset:49152
    ds_read_b64_tr_b16 v[118:119], v25 offset:53248
    ds_read_b64_tr_b16 v[120:121], v24 offset:57344
    s_add_u32 m0, s62, 81920
    s_add_u32 s65, s35, 221952
    buffer_load_dwordx4 v6, s[24:27], s65 offen lds
    v_cvt_pk_bf16_f32 v150, v44, v45
    v_cvt_pk_bf16_f32 v151, v46, v47
    v_mfma_f32_32x32x16_bf16 v[48:63], v[80:83], v[224:227], v[48:63]
    ds_read_b64_tr_b16 v[122:123], v24 offset:61440
    ds_read_b64_tr_b16 v[124:125], v25 offset:57344
    s_waitcnt lgkmcnt(12)
    ds_read_b64_tr_b16 v[126:127], v25 offset:61440
    buffer_load_dwordx4 v7, s[24:27], s65 offen offset:1024 lds
    v_permlane32_swap_b32 v144, v146
    v_permlane32_swap_b32 v145, v147
    v_mfma_f32_32x32x16_bf16 v[48:63], v[84:87], v[228:231], v[48:63]
    v_permlane32_swap_b32 v148, v150
    v_permlane32_swap_b32 v149, v151
    v_mfma_f32_32x32x16_bf16 v[48:63], v[88:91], v[232:235], v[48:63]
    buffer_store_dwordx4 v[144:147], v1, s[28:31], s64 offen offset:0 sc1
    v_mfma_f32_32x32x16_bf16 v[48:63], v[92:95], v[236:239], v[48:63]
    s_waitcnt lgkmcnt(0)
    s_waitcnt vmcnt(14)
    s_barrier
    v_add_u32 v24, 0x10000, v24
    v_add_u32 v25, 0x10000, v25
    v_mfma_f32_32x32x16_bf16 v[48:63], v[96:99], v[240:243], v[48:63]
    ds_read_b64_tr_b16 v[64:65], v24 offset:0
    ds_read_b64_tr_b16 v[66:67], v24 offset:4096
    ds_read_b64_tr_b16 v[68:69], v25 offset:0
    ds_read_b64_tr_b16 v[70:71], v25 offset:4096
    s_add_u32 m0, s62, 98304
    s_add_u32 s65, s35, 1024
    buffer_load_dwordx4 v4, s[24:27], s65 offen lds
    v_mfma_f32_32x32x16_bf16 v[48:63], v[100:103], v[244:247], v[48:63]
    ds_read_b64_tr_b16 v[72:73], v24 offset:8192
    ds_read_b64_tr_b16 v[74:75], v24 offset:12288
    ds_read_b64_tr_b16 v[76:77], v25 offset:8192
    buffer_load_dwordx4 v5, s[24:27], s65 offen offset:1024 lds
    v_mfma_f32_32x32x16_bf16 v[48:63], v[104:107], v[248:251], v[48:63]
    ds_read_b64_tr_b16 v[78:79], v25 offset:12288
    ds_read_b64_tr_b16 v[80:81], v24 offset:16384
    ds_read_b64_tr_b16 v[82:83], v24 offset:20480
    v_mfma_f32_32x32x16_bf16 v[48:63], v[108:111], v[252:255], v[48:63]
    ds_read_b64_tr_b16 v[84:85], v25 offset:16384
    ds_read_b64_tr_b16 v[86:87], v25 offset:20480
    ds_read_b64_tr_b16 v[88:89], v24 offset:24576
    s_add_u32 m0, s62, 114688
    s_add_u32 s65, s35, 74752
    buffer_load_dwordx4 v4, s[24:27], s65 offen lds
    v_mfma_f32_32x32x16_bf16 v[48:63], v[112:115], v[128:131], v[48:63]
    ds_read_b64_tr_b16 v[90:91], v24 offset:28672
    ds_read_b64_tr_b16 v[92:93], v25 offset:24576
    s_waitcnt lgkmcnt(12)
    ds_read_b64_tr_b16 v[94:95], v25 offset:28672
    buffer_load_dwordx4 v5, s[24:27], s65 offen offset:1024 lds
    v_mfma_f32_32x32x16_bf16 v[48:63], v[116:119], v[132:135], v[48:63]
    v_mfma_f32_32x32x16_bf16 v[48:63], v[120:123], v[136:139], v[48:63]
    buffer_store_dwordx4 v[148:151], v1, s[28:31], s64 offen offset:128 sc1
    v_mfma_f32_32x32x16_bf16 v[48:63], v[124:127], v[140:143], v[48:63]
    s_waitcnt lgkmcnt(0)
    s_waitcnt vmcnt(15)
    s_barrier
    v_add_u32 v24, 0xfffe0000, v24
    v_add_u32 v25, 0xfffe0000, v25
    v_mfma_f32_32x32x16_bf16 v[32:47], v[64:67], v[208:211], 0
    ds_read_b64_tr_b16 v[96:97], v24 offset:0
    ds_read_b64_tr_b16 v[98:99], v24 offset:4096
    ds_read_b64_tr_b16 v[100:101], v25 offset:0
    ds_read_b64_tr_b16 v[102:103], v25 offset:4096
    s_nop 1
    v_cvt_pk_bf16_f32 v152, v48, v49
    v_cvt_pk_bf16_f32 v153, v50, v51
    v_mfma_f32_32x32x16_bf16 v[32:47], v[68:71], v[212:215], v[32:47]
    ds_read_b64_tr_b16 v[104:105], v24 offset:8192
    ds_read_b64_tr_b16 v[106:107], v24 offset:12288
    ds_read_b64_tr_b16 v[108:109], v25 offset:8192
    v_cvt_pk_bf16_f32 v154, v52, v53
    v_cvt_pk_bf16_f32 v155, v54, v55
    v_mfma_f32_32x32x16_bf16 v[32:47], v[72:75], v[216:219], v[32:47]
    ds_read_b64_tr_b16 v[110:111], v25 offset:12288
    ds_read_b64_tr_b16 v[112:113], v24 offset:16384
    ds_read_b64_tr_b16 v[114:115], v24 offset:20480
    v_cvt_pk_bf16_f32 v156, v56, v57
    v_cvt_pk_bf16_f32 v157, v58, v59
    v_mfma_f32_32x32x16_bf16 v[32:47], v[76:79], v[220:223], v[32:47]
    ds_read_b64_tr_b16 v[116:117], v25 offset:16384
    ds_read_b64_tr_b16 v[118:119], v25 offset:20480
    ds_read_b64_tr_b16 v[120:121], v24 offset:24576
    v_cvt_pk_bf16_f32 v158, v60, v61
    v_cvt_pk_bf16_f32 v159, v62, v63
    v_mfma_f32_32x32x16_bf16 v[32:47], v[80:83], v[224:227], v[32:47]
    ds_read_b64_tr_b16 v[122:123], v24 offset:28672
    ds_read_b64_tr_b16 v[124:125], v25 offset:24576
    s_waitcnt lgkmcnt(12)
    ds_read_b64_tr_b16 v[126:127], v25 offset:28672
    v_permlane32_swap_b32 v152, v154
    v_permlane32_swap_b32 v153, v155
    v_mfma_f32_32x32x16_bf16 v[32:47], v[84:87], v[228:231], v[32:47]
    v_permlane32_swap_b32 v156, v158
    v_permlane32_swap_b32 v157, v159
    buffer_store_dwordx4 v[152:155], v1, s[28:31], s64 offen offset:1024 sc1
    v_mfma_f32_32x32x16_bf16 v[32:47], v[88:91], v[232:235], v[32:47]
    v_mfma_f32_32x32x16_bf16 v[32:47], v[92:95], v[236:239], v[32:47]
    s_waitcnt lgkmcnt(0)
    s_waitcnt vmcnt(12)
    s_barrier
    v_mfma_f32_32x32x16_bf16 v[32:47], v[96:99], v[240:243], v[32:47]
    ds_read_b64_tr_b16 v[64:65], v24 offset:32768
    ds_read_b64_tr_b16 v[66:67], v24 offset:36864
    ds_read_b64_tr_b16 v[68:69], v25 offset:32768
    ds_read_b64_tr_b16 v[70:71], v25 offset:36864
    buffer_store_dwordx4 v[156:159], v1, s[28:31], s64 offen offset:1152 sc1
    s_mov_b64 s[88:89], s[56:57]
    s_mov_b32 s90, 1179648
    s_mov_b32 s91, 0x20000
    v_mfma_f32_32x32x16_bf16 v[32:47], v[100:103], v[244:247], v[32:47]
    ds_read_b64_tr_b16 v[72:73], v24 offset:40960
    ds_read_b64_tr_b16 v[74:75], v24 offset:45056
    ds_read_b64_tr_b16 v[76:77], v25 offset:40960
    s_mul_i32 s81, s70, 1179648
    s_sub_u32 s3, 7, s4
    s_lshl_b32 s3, s3, 6
    v_add_u32 v4, s3, v0
    v_mfma_f32_32x32x16_bf16 v[32:47], v[104:107], v[248:251], v[32:47]
    ds_read_b64_tr_b16 v[78:79], v25 offset:45056
    ds_read_b64_tr_b16 v[80:81], v24 offset:49152
    ds_read_b64_tr_b16 v[82:83], v24 offset:53248
    v_cmp_gt_u32 vcc, 288, v4
    s_mul_i32 s3, s67, 288
    v_add_u32 v4, s3, v4
    v_lshlrev_b32 v5, 4, v4
    v_mfma_f32_32x32x16_bf16 v[32:47], v[108:111], v[252:255], v[32:47]
    ds_read_b64_tr_b16 v[84:85], v25 offset:49152
    ds_read_b64_tr_b16 v[86:87], v25 offset:53248
    ds_read_b64_tr_b16 v[88:89], v24 offset:57344
    v_mov_b32 v7, 0x40000000
    v_cndmask_b32 v5, v7, v5, vcc
    s_mul_i32 s83, s68, 147456
    s_mul_i32 s3, s7, 1152
    v_mfma_f32_32x32x16_bf16 v[32:47], v[112:115], v[128:131], v[32:47]
    ds_read_b64_tr_b16 v[90:91], v24 offset:61440
    ds_read_b64_tr_b16 v[92:93], v25 offset:57344
    s_waitcnt lgkmcnt(12)
    ds_read_b64_tr_b16 v[94:95], v25 offset:61440
    s_add_u32 s83, s83, s3
    v_lshrrev_b32 v6, 4, v0
    v_and_b32 v11, 15, v0
    v_lshl_or_b32 v4, v11, 2, v6
    v_mfma_f32_32x32x16_bf16 v[32:47], v[116:119], v[132:135], v[32:47]
    v_lshlrev_b32 v4, 2, v4
    v_mul_u32_u24 v6, 2304, v6
    s_sub_u32 s3, 7, s4
    s_lshl_b32 s3, s3, 4
    v_add_u32 v11, s3, v11
    v_mfma_f32_32x32x16_bf16 v[32:47], v[120:123], v[136:139], v[32:47]
    v_mfma_f32_32x32x16_bf16 v[32:47], v[124:127], v[140:143], v[32:47]
    s_waitcnt lgkmcnt(0)
    s_waitcnt vmcnt(8)
    s_barrier
    v_add_u32 v24, 0x10000, v24
    v_add_u32 v25, 0x10000, v25
    v_mfma_f32_32x32x16_bf16 v[48:63], v[64:67], v[208:211], 0
    ds_read_b64_tr_b16 v[96:97], v24 offset:0
    ds_read_b64_tr_b16 v[98:99], v24 offset:4096
    ds_read_b64_tr_b16 v[100:101], v25 offset:0
    ds_read_b64_tr_b16 v[102:103], v25 offset:4096
    s_nop 1
    v_cvt_pk_bf16_f32 v160, v32, v33
    v_cvt_pk_bf16_f32 v161, v34, v35
    v_mfma_f32_32x32x16_bf16 v[48:63], v[68:71], v[212:215], v[48:63]
    ds_read_b64_tr_b16 v[104:105], v24 offset:8192
    ds_read_b64_tr_b16 v[106:107], v24 offset:12288
    ds_read_b64_tr_b16 v[108:109], v25 offset:8192
    v_cvt_pk_bf16_f32 v162, v36, v37
    v_cvt_pk_bf16_f32 v163, v38, v39
    v_cvt_pk_bf16_f32 v164, v40, v41
    v_mfma_f32_32x32x16_bf16 v[48:63], v[72:75], v[216:219], v[48:63]
    ds_read_b64_tr_b16 v[110:111], v25 offset:12288
    ds_read_b64_tr_b16 v[112:113], v24 offset:16384
    ds_read_b64_tr_b16 v[114:115], v24 offset:20480
    v_cvt_pk_bf16_f32 v165, v42, v43
    v_cvt_pk_bf16_f32 v166, v44, v45
    v_cvt_pk_bf16_f32 v167, v46, v47
    v_mfma_f32_32x32x16_bf16 v[48:63], v[76:79], v[220:223], v[48:63]
    ds_read_b64_tr_b16 v[116:117], v25 offset:16384
    ds_read_b64_tr_b16 v[118:119], v25 offset:20480
    ds_read_b64_tr_b16 v[120:121], v24 offset:24576
    v_permlane32_swap_b32 v160, v162
    v_permlane32_swap_b32 v161, v163
    v_permlane32_swap_b32 v164, v166
    v_mfma_f32_32x32x16_bf16 v[48:63], v[80:83], v[224:227], v[48:63]
    ds_read_b64_tr_b16 v[122:123], v24 offset:28672
    ds_read_b64_tr_b16 v[124:125], v25 offset:24576
    s_waitcnt lgkmcnt(12)
    ds_read_b64_tr_b16 v[126:127], v25 offset:28672
    v_permlane32_swap_b32 v165, v167
    buffer_store_dwordx4 v[160:163], v1, s[28:31], s64 offen offset:2048 sc1
    v_mov_b32 v15, 32768
    v_mfma_f32_32x32x16_bf16 v[48:63], v[84:87], v[228:231], v[48:63]
    v_mov_b32 v14, 0
    ds_write_b32 v15, v14
    ds_write_b32 v15, v14 offset:4
    v_mfma_f32_32x32x16_bf16 v[48:63], v[88:91], v[232:235], v[48:63]
    v_mfma_f32_32x32x16_bf16 v[48:63], v[92:95], v[236:239], v[48:63]
    s_waitcnt lgkmcnt(0)
    s_waitcnt vmcnt(4)
    s_barrier
    v_mfma_f32_32x32x16_bf16 v[48:63], v[96:99], v[240:243], v[48:63]
    ds_read_b64_tr_b16 v[64:65], v24 offset:32768
    ds_read_b64_tr_b16 v[66:67], v24 offset:36864
    ds_read_b64_tr_b16 v[68:69], v25 offset:32768
    ds_read_b64_tr_b16 v[70:71], v25 offset:36864
    v_mov_b32 v12, 0
    buffer_atomic_add v12, v29, s[28:31], s71 offen sc0 sc1
    buffer_store_dwordx4 v[164:167], v1, s[28:31], s64 offen offset:2176 sc1
    v_xor_b32 v30, 128, v24
    v_mfma_f32_32x32x16_bf16 v[48:63], v[100:103], v[244:247], v[48:63]
    ds_read_b64_tr_b16 v[72:73], v24 offset:40960
    ds_read_b64_tr_b16 v[74:75], v24 offset:45056
    ds_read_b64_tr_b16 v[76:77], v25 offset:40960
    v_xor_b32 v31, 128, v25
    v_cmp_gt_u32 vcc, 72, v11
    v_lshl_add_u32 v6, v11, 4, v6
    v_mfma_f32_32x32x16_bf16 v[48:63], v[104:107], v[248:251], v[48:63]
    ds_read_b64_tr_b16 v[78:79], v25 offset:45056
    ds_read_b64_tr_b16 v[80:81], v24 offset:49152
    ds_read_b64_tr_b16 v[82:83], v24 offset:53248
    s_mul_i32 s3, s67, 9216
    s_add_u32 s83, s83, s3
    v_mfma_f32_32x32x16_bf16 v[48:63], v[108:111], v[252:255], v[48:63]
    ds_read_b64_tr_b16 v[84:85], v25 offset:49152
    ds_read_b64_tr_b16 v[86:87], v25 offset:53248
    ds_read_b64_tr_b16 v[88:89], v24 offset:57344
    v_cndmask_b32 v6, v7, v6, vcc
    v_cmp_gt_u32 vcc, 16, v0
    v_lshlrev_b32 v11, 8, v0
    v_mfma_f32_32x32x16_bf16 v[48:63], v[112:115], v[128:131], v[48:63]
    ds_read_b64_tr_b16 v[90:91], v24 offset:61440
    ds_read_b64_tr_b16 v[92:93], v25 offset:57344
    s_waitcnt lgkmcnt(12)
    ds_read_b64_tr_b16 v[94:95], v25 offset:61440
    s_lshl_b32 s3, 1, s67
    v_mov_b32 v13, s3
    v_mfma_f32_32x32x16_bf16 v[48:63], v[116:119], v[132:135], v[48:63]
    v_cndmask_b32 v11, v7, v11, vcc
    v_readfirstlane_b32 s76, v28
    v_mov_b32 v14, 1
    v_mfma_f32_32x32x16_bf16 v[48:63], v[120:123], v[136:139], v[48:63]
    v_mfma_f32_32x32x16_bf16 v[48:63], v[124:127], v[140:143], v[48:63]
    s_waitcnt lgkmcnt(0)
    s_cmp_ge_u32 s4, 4
    s_cbranch_scc1 L_hiA
    v_mfma_f32_32x32x16_bf16 v[32:47], v[64:67], v[208:211], 0
    ds_read_b64_tr_b16 v[176:177], v30 offset:32768
    ds_read_b64_tr_b16 v[178:179], v30 offset:36864
    ds_read_b64_tr_b16 v[180:181], v31 offset:32768
    ds_read_b64_tr_b16 v[182:183], v31 offset:36864
    s_nop 3
    v_cvt_pk_bf16_f32 v168, v48, v49
    v_mfma_f32_32x32x16_bf16 v[32:47], v[68:71], v[212:215], v[32:47]
    ds_read_b64_tr_b16 v[184:185], v30 offset:40960
    ds_read_b64_tr_b16 v[186:187], v30 offset:45056
    ds_read_b64_tr_b16 v[188:189], v31 offset:40960
    ds_read_b64_tr_b16 v[190:191], v31 offset:45056
    v_cvt_pk_bf16_f32 v169, v50, v51
    v_cvt_pk_bf16_f32 v170, v52, v53
    v_mfma_f32_32x32x16_bf16 v[32:47], v[72:75], v[216:219], v[32:47]
    ds_read_b64_tr_b16 v[192:193], v30 offset:49152
    ds_read_b64_tr_b16 v[194:195], v30 offset:53248
    ds_read_b64_tr_b16 v[196:197], v31 offset:49152
    ds_read_b64_tr_b16 v[198:199], v31 offset:53248
    v_cvt_pk_bf16_f32 v171, v54, v55
    v_mfma_f32_32x32x16_bf16 v[32:47], v[76:79], v[220:223], v[32:47]
    ds_read_b64_tr_b16 v[200:201], v30 offset:57344
    ds_read_b64_tr_b16 v[202:203], v30 offset:61440
    ds_read_b64_tr_b16 v[204:205], v31 offset:57344
    s_waitcnt lgkmcnt(12)
    ds_read_b64_tr_b16 v[206:207], v31 offset:61440
    v_cvt_pk_bf16_f32 v172, v56, v57
    v_cvt_pk_bf16_f32 v173, v58, v59
    v_mfma_f32_32x32x16_bf16 v[32:47], v[80:83], v[224:227], v[32:47]
    v_cvt_pk_bf16_f32 v174, v60, v61
    v_mfma_f32_32x32x16_bf16 v[32:47], v[84:87], v[228:231], v[32:47]
    v_cvt_pk_bf16_f32 v175, v62, v63
    v_permlane32_swap_b32 v168, v170
    v_mfma_f32_32x32x16_bf16 v[32:47], v[88:91], v[232:235], v[32:47]
    v_permlane32_swap_b32 v169, v171
    v_mfma_f32_32x32x16_bf16 v[32:47], v[92:95], v[236:239], v[32:47]
    v_permlane32_swap_b32 v172, v174
    v_permlane32_swap_b32 v173, v175
    s_waitcnt lgkmcnt(0)
    v_mfma_f32_32x32x16_bf16 v[32:47], v[176:179], v[240:243], v[32:47]
    v_mfma_f32_32x32x16_bf16 v[32:47], v[180:183], v[244:247], v[32:47]
    v_mfma_f32_32x32x16_bf16 v[32:47], v[184:187], v[248:251], v[32:47]
    buffer_store_dwordx4 v[168:171], v1, s[28:31], s64 offen offset:3072 sc1
    v_mfma_f32_32x32x16_bf16 v[32:47], v[188:191], v[252:255], v[32:47]
    v_mfma_f32_32x32x16_bf16 v[32:47], v[192:195], v[128:131], v[32:47]
    v_mfma_f32_32x32x16_bf16 v[32:47], v[196:199], v[132:135], v[32:47]
    buffer_store_dwordx4 v[172:175], v1, s[28:31], s64 offen offset:3200 sc1
    v_mfma_f32_32x32x16_bf16 v[32:47], v[200:203], v[136:139], v[32:47]
    v_mfma_f32_32x32x16_bf16 v[32:47], v[204:207], v[140:143], v[32:47]
    s_nop 11
    v_cvt_pk_bf16_f32 v16, v32, v33
    v_cvt_pk_bf16_f32 v17, v34, v35
    v_cvt_pk_bf16_f32 v18, v36, v37
    v_cvt_pk_bf16_f32 v19, v38, v39
    v_cvt_pk_bf16_f32 v20, v40, v41
    v_cvt_pk_bf16_f32 v21, v42, v43
    v_cvt_pk_bf16_f32 v22, v44, v45
    v_cvt_pk_bf16_f32 v23, v46, v47
    v_permlane32_swap_b32 v16, v18
    v_permlane32_swap_b32 v17, v19
    v_permlane32_swap_b32 v20, v22
    v_permlane32_swap_b32 v21, v23
    s_add_u32 s66, s64, 4096
    buffer_store_dwordx4 v[16:19], v1, s[28:31], s66 offen offset:0 sc1
    s_add_u32 s66, s64, 4096
    buffer_store_dwordx4 v[20:23], v1, s[28:31], s66 offen offset:128 sc1
    s_branch L_joinA
L_hiA:
    s_nop 11
    v_cvt_pk_bf16_f32 v168, v48, v49
    v_cvt_pk_bf16_f32 v169, v50, v51
    v_cvt_pk_bf16_f32 v170, v52, v53
    v_cvt_pk_bf16_f32 v171, v54, v55
    v_cvt_pk_bf16_f32 v172, v56, v57
    v_cvt_pk_bf16_f32 v173, v58, v59
    v_cvt_pk_bf16_f32 v174, v60, v61
    v_cvt_pk_bf16_f32 v175, v62, v63
    v_permlane32_swap_b32 v168, v170
    v_permlane32_swap_b32 v169, v171
    v_permlane32_swap_b32 v172, v174
    v_permlane32_swap_b32 v173, v175
    buffer_store_dwordx4 v[168:171], v1, s[28:31], s64 offen offset:3072 sc1
    buffer_store_dwordx4 v[172:175], v1, s[28:31], s64 offen offset:3200 sc1
L_joinA:
    s_mov_b32 s72, 0x800000
    s_waitcnt vmcnt(0)
    s_mov_b64 exec, 1
    ds_add_rtn_u32 v14, v15, v14
    s_mov_b64 exec, -1
    v_mov_b32 v64, 0
    v_mov_b32 v65, 0
    v_mov_b32 v66, 0
    v_mov_b32 v67, 0
    v_mov_b32 v68, 0
    v_mov_b32 v69, 0
    v_mov_b32 v70, 0
    v_mov_b32 v71, 0
    s_waitcnt lgkmcnt(0)
    v_readfirstlane_b32 s3, v14
    s_nop 1
    s_cmp_eq_u32 s3, 7
    s_cbranch_scc0 L_nosigA
L_chkA:
    v_readfirstlane_b32 s3, v8
    s_nop 1
    s_cmp_ge_u32 s3, 16
    s_cbranch_scc1 L_okA
    s_sleep 16
    buffer_load_dword v8, off, s[84:87], s82 sc1
    s_waitcnt vmcnt(0)
    s_sub_u32 s72, s72, 16
    s_cmp_lg_u32 s72, 0
    s_cbranch_scc1 L_chkA
    s_mov_b32 s72, 1
L_okA:
    buffer_atomic_add v13, v11, s[28:31], s73 offen sc1
    s_mov_b64 exec, 1
    ds_or_b32 v15, v13 offset:4
    s_mov_b64 exec, -1
L_nosigA:
    s_cmp_ge_u32 s4, 3
    s_cbranch_scc1 L_workA
    s_cmp_eq_u32 s4, 0
    s_cbranch_scc0 L_doneA
    s_mov_b64 exec, 1
    v_mov_b32 v64, 0
    buffer_atomic_add v64, v29, s[28:31], s71 offen sc0 sc1
    s_sleep 2
    v_mov_b32 v65, 0
    buffer_atomic_add v65, v29, s[28:31], s71 offen sc0 sc1
    s_sleep 2
L_ploopA:
    v_mov_b32 v66, 0
    buffer_atomic_add v66, v29, s[28:31], s71 offen sc0 sc1
    s_waitcnt vmcnt(2)
    v_readfirstlane_b32 s3, v64
    s_nop 1
    s_sub_u32 s3, s3, s76
    v_mov_b32 v13, s3
    ds_or_b32 v15, v13 offset:4
    s_cmp_eq_u32 s3, 0xffff
    s_cbranch_scc1 L_doneA
    v_mov_b32 v64, 0
    buffer_atomic_add v64, v29, s[28:31], s71 offen sc0 sc1
    s_waitcnt vmcnt(2)
    v_readfirstlane_b32 s3, v65
    s_nop 1
    s_sub_u32 s3, s3, s76
    v_mov_b32 v13, s3
    ds_or_b32 v15, v13 offset:4
    s_cmp_eq_u32 s3, 0xffff
    s_cbranch_scc1 L_doneA
    v_mov_b32 v65, 0
    buffer_atomic_add v65, v29, s[28:31], s71 offen sc0 sc1
    s_waitcnt vmcnt(2)
    v_readfirstlane_b32 s3, v66
    s_nop 1
    s_sub_u32 s3, s3, s76
    v_mov_b32 v13, s3
    ds_or_b32 v15, v13 offset:4
    s_cmp_eq_u32 s3, 0xffff
    s_cbranch_scc1 L_doneA
    s_sub_u32 s72, s72, 16
    s_cmp_gt_i32 s72, 0
    s_cbranch_scc1 L_ploopA
    s_branch L_doneA
L_workA:
    s_mov_b32 s74, 0xffff
    s_mov_b32 s80, 0
    s_mov_b32 s77, 0
    v_readfirstlane_b32 s3, v12
    s_nop 1
    s_sub_u32 s75, s3, s76
L_loopA:
    s_and_b32 s75, s75, s74
    s_cbranch_scc0 L_noldA
    s_cmp_eq_u32 s75, s74
    s_cbranch_scc1 all_50
    s_cmp_eq_u32 s77, s80
    s_cbranch_scc0 L_noldA
    s_mov_b32 s3, s75
    s_sub_u32 s65, s3, 1
    s_and_b32 s3, s3, s65
    s_sub_u32 s65, s3, 1
    s_and_b32 s3, s3, s65
    s_sub_u32 s65, s3, 1
    s_and_b32 s3, s3, s65
    s_xor_b32 s75, s75, s3
all_50:
    s_andn2_b32 s74, s74, s75
    s_cmp_ge_u32 s80, 8
    s_cbranch_scc1 t_67
    s_cmp_ge_u32 s80, 4
    s_cbranch_scc1 t_68
    s_cmp_ge_u32 s80, 2
    s_cbranch_scc1 t_69
    s_cmp_ge_u32 s80, 1
    s_cbranch_scc1 ld_52
    s_branch ld_51
t_69:
    s_cmp_ge_u32 s80, 3
    s_cbranch_scc1 ld_54
    s_branch ld_53
t_68:
    s_cmp_ge_u32 s80, 6
    s_cbranch_scc1 t_70
    s_cmp_ge_u32 s80, 5
    s_cbranch_scc1 ld_56
    s_branch ld_55
t_70:
    s_cmp_ge_u32 s80, 7
    s_cbranch_scc1 ld_58
    s_branch ld_57
t_67:
    s_cmp_ge_u32 s80, 12
    s_cbranch_scc1 t_71
    s_cmp_ge_u32 s80, 10
    s_cbranch_scc1 t_72
    s_cmp_ge_u32 s80, 9
    s_cbranch_scc1 ld_60
    s_branch ld_59
t_72:
    s_cmp_ge_u32 s80, 11
    s_cbranch_scc1 ld_62
    s_branch ld_61
t_71:
    s_cmp_ge_u32 s80, 14
    s_cbranch_scc1 t_73
    s_cmp_ge_u32 s80, 13
    s_cbranch_scc1 ld_64
    s_branch ld_63
t_73:
    s_cmp_ge_u32 s80, 15
    s_cbranch_scc1 ld_66
    s_branch ld_65
ld_51:
    s_ff1_i32_b32 s3, s75
    s_bitset0_b32 s75, s3
    s_mul_i32 s3, s3, 73728
    s_add_u32 s3, s3, s81
    buffer_load_dwordx4 v[192:195], v5, s[28:31], s3 offen sc1
    s_mov_b32 s80, 1
    s_cmp_eq_u32 s75, 0
    s_cbranch_scc1 L_noldA
ld_52:
    s_ff1_i32_b32 s3, s75
    s_bitset0_b32 s75, s3
    s_mul_i32 s3, s3, 73728
    s_add_u32 s3, s3, s81
    buffer_load_dwordx4 v[196:199], v5, s[28:31], s3 offen sc1
    s_mov_b32 s80, 2
    s_cmp_eq_u32 s75, 0
    s_cbranch_scc1 L_noldA
ld_53:
    s_ff1_i32_b32 s3, s75
    s_bitset0_b32 s75, s3
    s_mul_i32 s3, s3, 73728
    s_add_u32 s3, s3, s81
    buffer_load_dwordx4 v[200:203], v5, s[28:31], s3 offen sc1
    s_mov_b32 s80, 3
    s_cmp_eq_u32 s75, 0
    s_cbranch_scc1 L_noldA
ld_54:
    s_ff1_i32_b32 s3, s75
    s_bitset0_b32 s75, s3
    s_mul_i32 s3, s3, 73728
    s_add_u32 s3, s3, s81
    buffer_load_dwordx4 v[204:207], v5, s[28:31], s3 offen sc1
    s_mov_b32 s80, 4
    s_cmp_eq_u32 s75, 0
    s_cbranch_scc1 L_noldA
ld_55:
    s_ff1_i32_b32 s3, s75
    s_bitset0_b32 s75, s3
    s_mul_i32 s3, s3, 73728
    s_add_u32 s3, s3, s81
    buffer_load_dwordx4 v[208:211], v5, s[28:31], s3 offen sc1
    s_mov_b32 s80, 5
    s_cmp_eq_u32 s75, 0
    s_cbranch_scc1 L_noldA
ld_56:
    s_ff1_i32_b32 s3, s75
    s_bitset0_b32 s75, s3
    s_mul_i32 s3, s3, 73728
    s_add_u32 s3, s3, s81
    buffer_load_dwordx4 v[212:215], v5, s[28:31], s3 offen sc1
    s_mov_b32 s80, 6
    s_cmp_eq_u32 s75, 0
    s_cbranch_scc1 L_noldA
ld_57:
    s_ff1_i32_b32 s3, s75
    s_bitset0_b32 s75, s3
    s_mul_i32 s3, s3, 73728
    s_add_u32 s3, s3, s81
    buffer_load_dwordx4 v[216:219], v5, s[28:31], s3 offen sc1
    s_mov_b32 s80, 7
    s_cmp_eq_u32 s75, 0
    s_cbranch_scc1 L_noldA
ld_58:
    s_ff1_i32_b32 s3, s75
    s_bitset0_b32 s75, s3
    s_mul_i32 s3, s3, 73728
    s_add_u32 s3, s3, s81
    buffer_load_dwordx4 v[220:223], v5, s[28:31], s3 offen sc1
    s_mov_b32 s80, 8
    s_cmp_eq_u32 s75, 0
    s_cbranch_scc1 L_noldA
ld_59:
    s_ff1_i32_b32 s3, s75
    s_bitset0_b32 s75, s3
    s_mul_i32 s3, s3, 73728
    s_add_u32 s3, s3, s81
    buffer_load_dwordx4 v[224:227], v5, s[28:31], s3 offen sc1
    s_mov_b32 s80, 9
    s_cmp_eq_u32 s75, 0
    s_cbranch_scc1 L_noldA
ld_60:
    s_ff1_i32_b32 s3, s75
    s_bitset0_b32 s75, s3
    s_mul_i32 s3, s3, 73728
    s_add_u32 s3, s3, s81
    buffer_load_dwordx4 v[228:231], v5, s[28:31], s3 offen sc1
    s_mov_b32 s80, 10
    s_cmp_eq_u32 s75, 0
    s_cbranch_scc1 L_noldA
ld_61:
    s_ff1_i32_b32 s3, s75
    s_bitset0_b32 s75, s3
    s_mul_i32 s3, s3, 73728
    s_add_u32 s3, s3, s81
    buffer_load_dwordx4 v[232:235], v5, s[28:31], s3 offen sc1
    s_mov_b32 s80, 11
    s_cmp_eq_u32 s75, 0
    s_cbranch_scc1 L_noldA
ld_62:
    s_ff1_i32_b32 s3, s75
    s_bitset0_b32 s75, s3
    s_mul_i32 s3, s3, 73728
    s_add_u32 s3, s3, s81
    buffer_load_dwordx4 v[236:239], v5, s[28:31], s3 offen sc1
    s_mov_b32 s80, 12
    s_cmp_eq_u32 s75, 0
    s_cbranch_scc1 L_noldA
ld_63:
    s_ff1_i32_b32 s3, s75
    s_bitset0_b32 s75, s3
    s_mul_i32 s3, s3, 73728
    s_add_u32 s3, s3, s81
    buffer_load_dwordx4 v[240:243], v5, s[28:31], s3 offen sc1
    s_mov_b32 s80, 13
    s_cmp_eq_u32 s75, 0
    s_cbranch_scc1 L_noldA
ld_64:
    s_ff1_i32_b32 s3, s75
    s_bitset0_b32 s75, s3
    s_mul_i32 s3, s3, 73728
    s_add_u32 s3, s3, s81
    buffer_load_dwordx4 v[244:247], v5, s[28:31], s3 offen sc1
    s_mov_b32 s80, 14
    s_cmp_eq_u32 s75, 0
    s_cbranch_scc1 L_noldA
ld_65:
    s_ff1_i32_b32 s3, s75
    s_bitset0_b32 s75, s3
    s_mul_i32 s3, s3, 73728
    s_add_u32 s3, s3, s81
    buffer_load_dwordx4 v[248:251], v5, s[28:31], s3 offen sc1
    s_mov_b32 s80, 15
    s_cmp_eq_u32 s75, 0
    s_cbranch_scc1 L_noldA
ld_66:
    s_ff1_i32_b32 s3, s75
    s_bitset0_b32 s75, s3
    s_mul_i32 s3, s3, 73728
    s_add_u32 s3, s3, s81
    buffer_load_dwordx4 v[252:255], v5, s[28:31], s3 offen sc1
    s_mov_b32 s80, 16
    s_branch L_ldoutA
L_noldA:
    ds_read_b32 v14, v15 offset:4
    s_sub_u32 s72, s72, 1
    s_cmp_gt_i32 s72, 0
    s_cbranch_scc0 L_finA
    s_getreg_b32 s3, hwreg(HW_REG_IB_STS)
    s_and_b32 s3, s3, 0xc0000f
    s_cselect_b32 s3, s80, s77
    s_waitcnt lgkmcnt(0)
    v_readfirstlane_b32 s75, v14
    s_cmp_eq_u32 s3, s80
    s_cbranch_scc1 L_loopA
    s_and_b32 s3, s75, s74
    s_cmp_eq_u32 s3, s74
    s_cbranch_scc1 L_loopA
    s_waitcnt vmcnt(0)
L_ldoutA:
    s_cmp_ge_u32 s77, 8
    s_cbranch_scc1 t_90
    s_cmp_ge_u32 s77, 4
    s_cbranch_scc1 t_91
    s_cmp_ge_u32 s77, 2
    s_cbranch_scc1 t_92
    s_cmp_ge_u32 s77, 1
    s_cbranch_scc1 ac_75
    s_branch ac_74
t_92:
    s_cmp_ge_u32 s77, 3
    s_cbranch_scc1 ac_77
    s_branch ac_76
t_91:
    s_cmp_ge_u32 s77, 6
    s_cbranch_scc1 t_93
    s_cmp_ge_u32 s77, 5
    s_cbranch_scc1 ac_79
    s_branch ac_78
t_93:
    s_cmp_ge_u32 s77, 7
    s_cbranch_scc1 ac_81
    s_branch ac_80
t_90:
    s_cmp_ge_u32 s77, 12
    s_cbranch_scc1 t_94
    s_cmp_ge_u32 s77, 10
    s_cbranch_scc1 t_95
    s_cmp_ge_u32 s77, 9
    s_cbranch_scc1 ac_83
    s_branch ac_82
t_95:
    s_cmp_ge_u32 s77, 11
    s_cbranch_scc1 ac_85
    s_branch ac_84
t_94:
    s_cmp_ge_u32 s77, 14
    s_cbranch_scc1 t_96
    s_cmp_ge_u32 s77, 13
    s_cbranch_scc1 ac_87
    s_branch ac_86
t_96:
    s_cmp_ge_u32 s77, 15
    s_cbranch_scc1 ac_89
    s_branch ac_88
ac_74:
    s_waitcnt vmcnt(15)
    v_lshlrev_b32 v72, 16, v192
    v_and_b32 v73, 0xffff0000, v192
    v_lshlrev_b32 v74, 16, v193
    v_and_b32 v75, 0xffff0000, v193
    v_lshlrev_b32 v76, 16, v194
    v_and_b32 v77, 0xffff0000, v194
    v_lshlrev_b32 v78, 16, v195
    v_and_b32 v79, 0xffff0000, v195
    v_pk_add_f32 v[64:65], v[64:65], v[72:73]
    v_pk_add_f32 v[66:67], v[66:67], v[74:75]
    v_pk_add_f32 v[68:69], v[68:69], v[76:77]
    v_pk_add_f32 v[70:71], v[70:71], v[78:79]
    s_cmp_eq_u32 s80, 1
    s_cbranch_scc1 L_acoutA
ac_75:
    s_waitcnt vmcnt(14)
    v_lshlrev_b32 v72, 16, v196
    v_and_b32 v73, 0xffff0000, v196
    v_lshlrev_b32 v74, 16, v197
    v_and_b32 v75, 0xffff0000, v197
    v_lshlrev_b32 v76, 16, v198
    v_and_b32 v77, 0xffff0000, v198
    v_lshlrev_b32 v78, 16, v199
    v_and_b32 v79, 0xffff0000, v199
    v_pk_add_f32 v[64:65], v[64:65], v[72:73]
    v_pk_add_f32 v[66:67], v[66:67], v[74:75]
    v_pk_add_f32 v[68:69], v[68:69], v[76:77]
    v_pk_add_f32 v[70:71], v[70:71], v[78:79]
    s_cmp_eq_u32 s80, 2
    s_cbranch_scc1 L_acoutA
ac_76:
    s_waitcnt vmcnt(13)
    v_lshlrev_b32 v72, 16, v200
    v_and_b32 v73, 0xffff0000, v200
    v_lshlrev_b32 v74, 16, v201
    v_and_b32 v75, 0xffff0000, v201
    v_lshlrev_b32 v76, 16, v202
    v_and_b32 v77, 0xffff0000, v202
    v_lshlrev_b32 v78, 16, v203
    v_and_b32 v79, 0xffff0000, v203
    v_pk_add_f32 v[64:65], v[64:65], v[72:73]
    v_pk_add_f32 v[66:67], v[66:67], v[74:75]
    v_pk_add_f32 v[68:69], v[68:69], v[76:77]
    v_pk_add_f32 v[70:71], v[70:71], v[78:79]
    s_cmp_eq_u32 s80, 3
    s_cbranch_scc1 L_acoutA
ac_77:
    s_waitcnt vmcnt(12)
    v_lshlrev_b32 v72, 16, v204
    v_and_b32 v73, 0xffff0000, v204
    v_lshlrev_b32 v74, 16, v205
    v_and_b32 v75, 0xffff0000, v205
    v_lshlrev_b32 v76, 16, v206
    v_and_b32 v77, 0xffff0000, v206
    v_lshlrev_b32 v78, 16, v207
    v_and_b32 v79, 0xffff0000, v207
    v_pk_add_f32 v[64:65], v[64:65], v[72:73]
    v_pk_add_f32 v[66:67], v[66:67], v[74:75]
    v_pk_add_f32 v[68:69], v[68:69], v[76:77]
    v_pk_add_f32 v[70:71], v[70:71], v[78:79]
    s_cmp_eq_u32 s80, 4
    s_cbranch_scc1 L_acoutA
ac_78:
    s_waitcnt vmcnt(11)
    v_lshlrev_b32 v72, 16, v208
    v_and_b32 v73, 0xffff0000, v208
    v_lshlrev_b32 v74, 16, v209
    v_and_b32 v75, 0xffff0000, v209
    v_lshlrev_b32 v76, 16, v210
    v_and_b32 v77, 0xffff0000, v210
    v_lshlrev_b32 v78, 16, v211
    v_and_b32 v79, 0xffff0000, v211
    v_pk_add_f32 v[64:65], v[64:65], v[72:73]
    v_pk_add_f32 v[66:67], v[66:67], v[74:75]
    v_pk_add_f32 v[68:69], v[68:69], v[76:77]
    v_pk_add_f32 v[70:71], v[70:71], v[78:79]
    s_cmp_eq_u32 s80, 5
    s_cbranch_scc1 L_acoutA
ac_79:
    s_waitcnt vmcnt(10)
    v_lshlrev_b32 v72, 16, v212
    v_and_b32 v73, 0xffff0000, v212
    v_lshlrev_b32 v74, 16, v213
    v_and_b32 v75, 0xffff0000, v213
    v_lshlrev_b32 v76, 16, v214
    v_and_b32 v77, 0xffff0000, v214
    v_lshlrev_b32 v78, 16, v215
    v_and_b32 v79, 0xffff0000, v215
    v_pk_add_f32 v[64:65], v[64:65], v[72:73]
    v_pk_add_f32 v[66:67], v[66:67], v[74:75]
    v_pk_add_f32 v[68:69], v[68:69], v[76:77]
    v_pk_add_f32 v[70:71], v[70:71], v[78:79]
    s_cmp_eq_u32 s80, 6
    s_cbranch_scc1 L_acoutA
ac_80:
    s_waitcnt vmcnt(9)
    v_lshlrev_b32 v72, 16, v216
    v_and_b32 v73, 0xffff0000, v216
    v_lshlrev_b32 v74, 16, v217
    v_and_b32 v75, 0xffff0000, v217
    v_lshlrev_b32 v76, 16, v218
    v_and_b32 v77, 0xffff0000, v218
    v_lshlrev_b32 v78, 16, v219
    v_and_b32 v79, 0xffff0000, v219
    v_pk_add_f32 v[64:65], v[64:65], v[72:73]
    v_pk_add_f32 v[66:67], v[66:67], v[74:75]
    v_pk_add_f32 v[68:69], v[68:69], v[76:77]
    v_pk_add_f32 v[70:71], v[70:71], v[78:79]
    s_cmp_eq_u32 s80, 7
    s_cbranch_scc1 L_acoutA
ac_81:
    s_waitcnt vmcnt(8)
    v_lshlrev_b32 v72, 16, v220
    v_and_b32 v73, 0xffff0000, v220
    v_lshlrev_b32 v74, 16, v221
    v_and_b32 v75, 0xffff0000, v221
    v_lshlrev_b32 v76, 16, v222
    v_and_b32 v77, 0xffff0000, v222
    v_lshlrev_b32 v78, 16, v223
    v_and_b32 v79, 0xffff0000, v223
    v_pk_add_f32 v[64:65], v[64:65], v[72:73]
    v_pk_add_f32 v[66:67], v[66:67], v[74:75]
    v_pk_add_f32 v[68:69], v[68:69], v[76:77]
    v_pk_add_f32 v[70:71], v[70:71], v[78:79]
    s_cmp_eq_u32 s80, 8
    s_cbranch_scc1 L_acoutA
ac_82:
    s_waitcnt vmcnt(7)
    v_lshlrev_b32 v72, 16, v224
    v_and_b32 v73, 0xffff0000, v224
    v_lshlrev_b32 v74, 16, v225
    v_and_b32 v75, 0xffff0000, v225
    v_lshlrev_b32 v76, 16, v226
    v_and_b32 v77, 0xffff0000, v226
    v_lshlrev_b32 v78, 16, v227
    v_and_b32 v79, 0xffff0000, v227
    v_pk_add_f32 v[64:65], v[64:65], v[72:73]
    v_pk_add_f32 v[66:67], v[66:67], v[74:75]
    v_pk_add_f32 v[68:69], v[68:69], v[76:77]
    v_pk_add_f32 v[70:71], v[70:71], v[78:79]
    s_cmp_eq_u32 s80, 9
    s_cbranch_scc1 L_acoutA
ac_83:
    s_waitcnt vmcnt(6)
    v_lshlrev_b32 v72, 16, v228
    v_and_b32 v73, 0xffff0000, v228
    v_lshlrev_b32 v74, 16, v229
    v_and_b32 v75, 0xffff0000, v229
    v_lshlrev_b32 v76, 16, v230
    v_and_b32 v77, 0xffff0000, v230
    v_lshlrev_b32 v78, 16, v231
    v_and_b32 v79, 0xffff0000, v231
    v_pk_add_f32 v[64:65], v[64:65], v[72:73]
    v_pk_add_f32 v[66:67], v[66:67], v[74:75]
    v_pk_add_f32 v[68:69], v[68:69], v[76:77]
    v_pk_add_f32 v[70:71], v[70:71], v[78:79]
    s_cmp_eq_u32 s80, 10
    s_cbranch_scc1 L_acoutA
ac_84:
    s_waitcnt vmcnt(5)
    v_lshlrev_b32 v72, 16, v232
    v_and_b32 v73, 0xffff0000, v232
    v_lshlrev_b32 v74, 16, v233
    v_and_b32 v75, 0xffff0000, v233
    v_lshlrev_b32 v76, 16, v234
    v_and_b32 v77, 0xffff0000, v234
    v_lshlrev_b32 v78, 16, v235
    v_and_b32 v79, 0xffff0000, v235
    v_pk_add_f32 v[64:65], v[64:65], v[72:73]
    v_pk_add_f32 v[66:67], v[66:67], v[74:75]
    v_pk_add_f32 v[68:69], v[68:69], v[76:77]
    v_pk_add_f32 v[70:71], v[70:71], v[78:79]
    s_cmp_eq_u32 s80, 11
    s_cbranch_scc1 L_acoutA
ac_85:
    s_waitcnt vmcnt(4)
    v_lshlrev_b32 v72, 16, v236
    v_and_b32 v73, 0xffff0000, v236
    v_lshlrev_b32 v74, 16, v237
    v_and_b32 v75, 0xffff0000, v237
    v_lshlrev_b32 v76, 16, v238
    v_and_b32 v77, 0xffff0000, v238
    v_lshlrev_b32 v78, 16, v239
    v_and_b32 v79, 0xffff0000, v239
    v_pk_add_f32 v[64:65], v[64:65], v[72:73]
    v_pk_add_f32 v[66:67], v[66:67], v[74:75]
    v_pk_add_f32 v[68:69], v[68:69], v[76:77]
    v_pk_add_f32 v[70:71], v[70:71], v[78:79]
    s_cmp_eq_u32 s80, 12
    s_cbranch_scc1 L_acoutA
ac_86:
    s_waitcnt vmcnt(3)
    v_lshlrev_b32 v72, 16, v240
    v_and_b32 v73, 0xffff0000, v240
    v_lshlrev_b32 v74, 16, v241
    v_and_b32 v75, 0xffff0000, v241
    v_lshlrev_b32 v76, 16, v242
    v_and_b32 v77, 0xffff0000, v242
    v_lshlrev_b32 v78, 16, v243
    v_and_b32 v79, 0xffff0000, v243
    v_pk_add_f32 v[64:65], v[64:65], v[72:73]
    v_pk_add_f32 v[66:67], v[66:67], v[74:75]
    v_pk_add_f32 v[68:69], v[68:69], v[76:77]
    v_pk_add_f32 v[70:71], v[70:71], v[78:79]
    s_cmp_eq_u32 s80, 13
    s_cbranch_scc1 L_acoutA
ac_87:
    s_waitcnt vmcnt(2)
    v_lshlrev_b32 v72, 16, v244
    v_and_b32 v73, 0xffff0000, v244
    v_lshlrev_b32 v74, 16, v245
    v_and_b32 v75, 0xffff0000, v245
    v_lshlrev_b32 v76, 16, v246
    v_and_b32 v77, 0xffff0000, v246
    v_lshlrev_b32 v78, 16, v247
    v_and_b32 v79, 0xffff0000, v247
    v_pk_add_f32 v[64:65], v[64:65], v[72:73]
    v_pk_add_f32 v[66:67], v[66:67], v[74:75]
    v_pk_add_f32 v[68:69], v[68:69], v[76:77]
    v_pk_add_f32 v[70:71], v[70:71], v[78:79]
    s_cmp_eq_u32 s80, 14
    s_cbranch_scc1 L_acoutA
ac_88:
    s_waitcnt vmcnt(1)
    v_lshlrev_b32 v72, 16, v248
    v_and_b32 v73, 0xffff0000, v248
    v_lshlrev_b32 v74, 16, v249
    v_and_b32 v75, 0xffff0000, v249
    v_lshlrev_b32 v76, 16, v250
    v_and_b32 v77, 0xffff0000, v250
    v_lshlrev_b32 v78, 16, v251
    v_and_b32 v79, 0xffff0000, v251
    v_pk_add_f32 v[64:65], v[64:65], v[72:73]
    v_pk_add_f32 v[66:67], v[66:67], v[74:75]
    v_pk_add_f32 v[68:69], v[68:69], v[76:77]
    v_pk_add_f32 v[70:71], v[70:71], v[78:79]
    s_cmp_eq_u32 s80, 15
    s_cbranch_scc1 L_acoutA
ac_89:
    s_waitcnt vmcnt(0)
    v_lshlrev_b32 v72, 16, v252
    v_and_b32 v73, 0xffff0000, v252
    v_lshlrev_b32 v74, 16, v253
    v_and_b32 v75, 0xffff0000, v253
    v_lshlrev_b32 v76, 16, v254
    v_and_b32 v77, 0xffff0000, v254
    v_lshlrev_b32 v78, 16, v255
    v_and_b32 v79, 0xffff0000, v255
    v_pk_add_f32 v[64:65], v[64:65], v[72:73]
    v_pk_add_f32 v[66:67], v[66:67], v[74:75]
    v_pk_add_f32 v[68:69], v[68:69], v[76:77]
    v_pk_add_f32 v[70:71], v[70:71], v[78:79]
L_finA:
    v_cvt_pk_bf16_f32 v192, v64, v65
    v_cvt_pk_bf16_f32 v193, v66, v67
    v_cvt_pk_bf16_f32 v194, v68, v69
    v_cvt_pk_bf16_f32 v195, v70, v71
    ds_bpermute_b32 v196, v4, v192
    ds_bpermute_b32 v197, v4, v193
    ds_bpermute_b32 v198, v4, v194
    ds_bpermute_b32 v199, v4, v195
    s_waitcnt lgkmcnt(0)
    buffer_store_dwordx4 v[196:199], v6, s[88:91], s83 offen
    s_branch L_doneA
L_acoutA:
    s_mov_b32 s77, s80
    s_branch L_noldA
L_doneA:
    s_endpgm
L_exit:
    s_endpgm
L_end:
.section .rodata,"a"
.p2align 6
.amdhsa_kernel concat_heads__gqa_block_cached__mha_block_cached__near_ridge_kernel
  .amdhsa_next_free_vgpr 256
  .amdhsa_next_free_sgpr 102
  .amdhsa_accum_offset 256
  .amdhsa_group_segment_fixed_size 0
  .amdhsa_kernarg_size 104
  .amdhsa_user_sgpr_count 2
  .amdhsa_user_sgpr_kernarg_segment_ptr 1
  .amdhsa_system_sgpr_workgroup_id_x 1
.end_amdhsa_kernel
```
